```python
import torch

def _softmax(x, axis=-1):
    return torch.softmax(x, dim=axis)
def _gelu(x):
    return torch.nn.functional.gelu(x, approximate="tanh")
def _silu(x):
    return torch.nn.functional.silu(x)
def _sigmoid(x):
    return torch.sigmoid(x)
def _layernorm(x, axis=-1, eps=1e-5):
    m = x.mean(dim=axis, keepdim=True)
    v = x.var(dim=axis, keepdim=True, unbiased=False)
    return (x - m) / torch.sqrt(v + eps)
def _scatter_add(tgt, idx, src, axis=0):
    return tgt.clone().index_add_(axis, idx, src)
def _segment_sum(src, seg, n):
    out = torch.zeros((n,) + src.shape[1:], dtype=src.dtype)
    return out.index_add_(0, seg, src)
def _pad(x, pw):
    flat = tuple(v for pair in reversed(pw) for v in pair)
    return torch.nn.functional.pad(x, flat)

kernel_name = 'recurrent_scan__linear_kernel_hedgehog__glu_gated_swiglu__prompt'

def setup_inputs():

    _w = (lambda a: (lambda t: t.to(torch.bfloat16) if t.is_floating_point() else t)(torch.as_tensor(a)))
    def _A_setup():
        B, S, D, H = 1, 2048, 448, 16
        Dh = D // H
        return {
            "x": _w((lambda *s: torch.randn(*s, dtype=torch.bfloat16) * 0.05)(B, S, D)),
            "wqkv": _w((lambda *s: torch.randn(*s, dtype=torch.bfloat16) * 0.8)(D, 3 * D)),
            "w_phi": _w((lambda *s: torch.randn(*s, dtype=torch.bfloat16) * 0.8)(H, Dh, Dh) * (Dh ** -0.5)),
            "wo": _w((lambda *s: torch.randn(*s, dtype=torch.bfloat16) * 0.8)(D, D)),
        }
    _A_in = _A_setup()

    def _B_setup():
        B, S, D, F = 1, 2048, 448, 1792
        return {
            "x": _w((lambda *s: torch.randn(*s, dtype=torch.bfloat16) * 0.05)(B, S, D)),
            "w1": _w((lambda *s: torch.randn(*s, dtype=torch.bfloat16) * 0.2)(D, F) * (2.0 / D) ** 0.5),
            "w3": _w((lambda *s: torch.randn(*s, dtype=torch.bfloat16) * 0.2)(D, F) * (2.0 / D) ** 0.5),
            "w2": _w((lambda *s: torch.randn(*s, dtype=torch.bfloat16) * 0.2)(F, D) * (2.0 / F) ** 0.5),
        }
    _B_in = _B_setup()

    return {
        "A_x": _A_in["x"],
        "A_wqkv": _A_in["wqkv"],
        "A_w_phi": _A_in["w_phi"],
        "A_wo": _A_in["wo"],
        "B_x": _B_in["x"],
        "B_w1": _B_in["w1"],
        "B_w3": _B_in["w3"],
        "B_w2": _B_in["w2"],
    }

def reference(A_x, A_wqkv, A_w_phi, A_wo, B_x, B_w1, B_w3, B_w2):
    def _A_ref(x, wqkv, w_phi, wo):
        B, S, D = x.shape
        H = 16; Dh = D // H
        qkv = (lambda x, *d: x.permute(*d))((x @ wqkv).reshape(B, S, 3, H, Dh), 2, 0, 3, 1, 4)
        q, k, v = qkv[0], qkv[1], qkv[2]
        pq = torch.einsum("bhsd,hdf->bhsf", q, w_phi)
        pk = torch.einsum("bhsd,hdf->bhsf", k, w_phi)
        phi_q = torch.concatenate([_softmax(pq, axis=-1), _softmax(-pq, axis=-1)], axis=-1)
        phi_k = torch.concatenate([_softmax(pk, axis=-1), _softmax(-pk, axis=-1)], axis=-1)
        kv = torch.einsum("bhsf,bhsd->bhfd", phi_k, v)
        z  = torch.einsum("bhsf->bhf", phi_k)
        num = torch.einsum("bhqf,bhfd->bhqd", phi_q, kv)
        den = torch.einsum("bhqf,bhf->bhq", phi_q, z)[..., None] + 1e-6
        o = num / den
        return (lambda x, *d: x.permute(*d))(o, 0, 2, 1, 3).reshape(B, S, D) @ wo

    def _B_ref(x, w1, w3, w2):
        gate = torch.einsum("bsd,df->bsf", x, w1)
        up = torch.einsum("bsd,df->bsf", x, w3)
        h = _silu(gate) * up
        out = torch.einsum("bsf,fd->bsd", h, w2)
        return out

    x = A_x
    xn = _layernorm(x, axis=-1)
    s = _A_ref(xn, A_wqkv, A_w_phi, A_wo)
    g = _silu(_B_ref(xn, B_w1, B_w3, B_w2))
    return x + s * g
```

```asm
; @launch grid=(256,1,1) block=(256,1,1) lds=163840
.amdgcn_target "amdgcn-amd-amdhsa--gfx950"
.text
.globl recurrent_scan__linear_kernel_hedgehog__glu_gated_swiglu__prompt_kernel
.p2align 8
.type recurrent_scan__linear_kernel_hedgehog__glu_gated_swiglu__prompt_kernel,@function
recurrent_scan__linear_kernel_hedgehog__glu_gated_swiglu__prompt_kernel:
    s_cmp_ge_u32 s2, 256
    s_cbranch_scc1 L_exit
    s_load_dwordx2 s[4:5], s[0:1], 0
    s_load_dwordx2 s[8:9], s[0:1], 8
    s_load_dwordx2 s[20:21], s[0:1], 40
    s_load_dwordx2 s[24:25], s[0:1], 48
    s_load_dwordx2 s[12:13], s[0:1], 16
    s_load_dwordx2 s[16:17], s[0:1], 24
    s_load_dwordx2 s[28:29], s[0:1], 56
    s_load_dwordx2 s[32:33], s[0:1], 64
    s_load_dwordx2 s[36:37], s[0:1], 72
    s_load_dwordx2 s[40:41], s[0:1], 80
    v_and_b32 v1, 63, v0
    v_lshrrev_b32 v15, 6, v0
    s_nop 0
    v_readfirstlane_b32 s44, v15
    s_nop 1
    s_getpc_b64 s[50:51]
L_pcref_0:
    s_lshr_b32 s52, s2, 3
    s_and_b32 s52, s52, 7
    s_lshl_b32 s52, s52, 2
    s_add_u32 s52, s52, s44
    s_lshl_b32 s52, s52, 11
    s_sub_u32 s50, s50, L_pcref_0-recurrent_scan__linear_kernel_hedgehog__glu_gated_swiglu__prompt_kernel
    s_subb_u32 s51, s51, 0
    v_and_b32 v251, 15, v1
    v_lshlrev_b32 v251, 7, v251
    v_add_u32 v251, s52, v251
    v_min_u32 v251, L_exit-recurrent_scan__linear_kernel_hedgehog__glu_gated_swiglu__prompt_kernel, v251
    global_load_dword v252, v251, s[50:51]
    s_and_b32 s49, s2, 7
    s_lshr_b32 s50, s2, 3
    s_and_b32 s47, s49, 1
    s_lshr_b32 s49, s49, 1
    s_lshl_b32 s49, s49, 2
    s_lshr_b32 s45, s50, 3
    s_add_u32 s45, s45, s49
    s_and_b32 s46, s50, 7
    s_and_b32 s48, s46, 3
    s_lshl_b32 s49, s47, 2
    s_add_u32 s48, s48, s49
    v_lshrrev_b32 v220, 3, v1
    v_and_b32 v221, 7, v1
    v_mul_u32_u24 v141, 896, v220
    v_lshl_add_u32 v141, v221, 4, v141
    s_lshl_b32 s49, s45, 7
    s_lshl_b32 s50, s44, 5
    s_add_u32 s49, s49, s50
    s_mul_i32 s49, s49, 896
    s_add_u32 s94, s46, 0
    s_and_b32 s94, s94, 3
    s_mul_i32 s98, s94, 7168
    s_add_u32 s98, s98, s49
    s_add_u32 s95, s46, 1
    s_and_b32 s95, s95, 3
    s_mul_i32 s99, s95, 7168
    s_add_u32 s99, s99, s49
    s_add_u32 s96, s46, 2
    s_and_b32 s96, s96, 3
    s_mul_i32 s100, s96, 7168
    s_add_u32 s100, s100, s49
    s_add_u32 s97, s46, 3
    s_and_b32 s97, s97, 3
    s_mul_i32 s101, s97, 7168
    s_add_u32 s101, s101, s49
    s_mov_b32 s6, 1835008
    s_mov_b32 s7, 0x20000
    s_mov_b32 s10, 1204224
    s_mov_b32 s11, 0x20000
    s_mov_b32 s14, 25088
    s_mov_b32 s15, 0x20000
    s_mov_b32 s18, 401408
    s_mov_b32 s19, 0x20000
    s_mov_b32 s22, 1605632
    s_mov_b32 s23, 0x20000
    s_mov_b32 s26, 1605632
    s_mov_b32 s27, 0x20000
    s_mov_b32 s30, 1605632
    s_mov_b32 s31, 0x20000
    s_mov_b32 s34, 1835008
    s_mov_b32 s35, 0x20000
    s_mov_b32 s38, 256
    s_mov_b32 s39, 0x20000
    s_mov_b32 s42, 9715712
    s_mov_b32 s43, 0x20000
    s_mov_b32 s53, 0x3f803f80
    s_mov_b32 s54, 0x00003f80
    s_mov_b32 s55, 0x3f800000
    s_mov_b32 s60, 0
    s_mov_b32 s61, -1
    s_lshl_b32 s56, s44, 11
    s_lshl_b32 s57, s44, 12
    s_lshl_b32 s58, s44, 10
    v_lshlrev_b32 v11, 4, v1
    v_lshlrev_b32 v12, 2, v1
    v_lshrrev_b32 v220, 3, v1
    v_and_b32 v221, 7, v1
    v_bfe_u32 v223, v220, 1, 1
    v_lshlrev_b32 v223, 2, v223
    v_xor_b32 v223, v223, v221
    v_lshlrev_b32 v236, 4, v223
    v_mul_u32_u24 v237, 2688, v220
    v_add_u32 v2, v237, v236
    v_mul_u32_u24 v237, 3584, v220
    v_add_u32 v3, v237, v236
    v_xor_b32 v236, 32, v236
    v_add_u32 v4, v237, v236
    v_lshrrev_b32 v237, 2, v1
    v_mul_u32_u24 v237, 3584, v237
    v_and_b32 v236, 3, v1
    v_lshlrev_b32 v236, 4, v236
    v_add_u32 v5, v237, v236
    v_xor_b32 v236, 32, v236
    v_add_u32 v6, v237, v236
    v_mov_b32 v10, 1.0
    v_cndmask_b32 v10, v10, 0, s[60:61]
    s_lshl_b32 s86, s48, 2
    s_lshl_b32 s87, s45, 2
    s_add_u32 s87, s87, 32
    s_lshl_b32 s74, s48, 8
    s_add_u32 s74, s74, 9568256
    s_lshl_b32 s75, s45, 8
    s_add_u32 s88, s75, 9574400
    s_add_u32 s76, s75, 9578496
    s_add_u32 s75, s75, 9570304
    s_lshl_b32 s50, s45, 2
    s_add_u32 s50, s50, s44
    s_mul_i32 s68, s50, 114688
    s_lshl_b32 s73, s50, 15
    s_add_u32 s73, s73, 7340032
    s_mul_i32 s50, s44, 29184
    s_add_u32 s50, s50, 32768
    v_lshrrev_b32 v220, 3, v1
    v_and_b32 v221, 7, v1
    v_mul_u32_u24 v128, 912, v220
    v_lshl_add_u32 v128, v221, 4, v128
    v_add_u32 v128, s50, v128
    s_lshl_b32 s51, s44, 7
    s_add_u32 s51, s51, 163328
    v_lshlrev_b32 v129, 2, v220
    v_add_u32 v129, s51, v129
    v_and_b32 v220, 31, v1
    v_lshrrev_b32 v221, 5, v1
    v_mul_u32_u24 v130, 912, v220
    v_lshl_add_u32 v130, v221, 4, v130
    v_add_u32 v130, s50, v130
    v_lshlrev_b32 v131, 2, v220
    v_add_u32 v131, s51, v131
    s_waitcnt lgkmcnt(0)
    s_cmp_ge_u32 s46, 4
    s_cbranch_scc1 L_typeF
    buffer_load_dwordx4 v[16:19], v141, s[4:7], s98 offen offset:0
    s_mul_i32 s50, s48, 112
    s_mul_i32 s66, s44, 86016
    s_add_u32 s66, s66, s50
    s_mul_i32 s67, s44, 43008
    s_add_u32 s67, s67, s50
    s_lshl_b32 s50, s48, 6
    s_add_u32 s50, s50, 3072
    s_mul_i32 s63, s44, 57344
    buffer_load_dwordx4 v[32:35], v141, s[4:7], s98 offen offset:128
    s_lshl_b32 s62, s63, 1
    s_add_u32 s62, s62, s50
    s_add_u32 s63, s63, s50
    s_lshl_b32 s50, s48, 11
    s_add_u32 s68, s68, s50
    s_add_u32 s68, s68, 98304
    s_lshl_b32 s72, s48, 14
    s_add_u32 s72, s72, s57
    buffer_load_dwordx4 v[48:51], v141, s[4:7], s98 offen offset:256
    s_add_u32 s72, s72, 9437184
    s_lshl_b32 s50, s48, 12
    s_add_u32 s73, s73, s50
    v_lshrrev_b32 v220, 5, v1
    v_bfe_u32 v222, v1, 2, 2
    v_lshl_add_u32 v220, v220, 3, v222
    v_bfe_u32 v221, v1, 4, 1
    v_and_b32 v223, 3, v1
    v_bfe_u32 v222, v1, 3, 1
    buffer_load_dwordx4 v[64:67], v141, s[4:7], s98 offen offset:384
    v_lshlrev_b32 v236, 7, v220
    v_lshlrev_b32 v237, 5, v221
    v_lshl_add_u32 v237, v223, 3, v237
    v_lshlrev_b32 v222, 6, v222
    v_add_u32 v220, 0, v237
    v_xor_b32 v220, v220, v222
    v_add_u32 v192, v220, v236
    v_add_u32 v220, 56, v237
    buffer_load_dwordx4 v[80:83], v141, s[4:7], s98 offen offset:512
    v_xor_b32 v220, v220, v222
    v_add_u32 v193, v220, v236
    v_add_u32 v196, 0x4000, v192
    v_add_u32 v197, 0x4000, v193
    v_lshrrev_b32 v220, 5, v1
    v_bfe_u32 v222, v1, 2, 2
    v_lshl_add_u32 v220, v220, 3, v222
    v_bfe_u32 v221, v1, 4, 1
    v_and_b32 v223, 3, v1
    buffer_load_dwordx4 v[96:99], v141, s[4:7], s98 offen offset:640
    v_bfe_u32 v222, v1, 3, 1
    v_lshlrev_b32 v236, 6, v220
    v_lshl_add_u32 v236, v221, 13, v236
    v_lshl_add_u32 v236, v223, 3, v236
    v_xor_b32 v220, 0, v221
    v_lshl_add_u32 v200, v220, 5, v236
    v_xor_b32 v220, 1, v221
    v_lshl_add_u32 v201, v220, 5, v236
    buffer_load_dwordx4 v[112:115], v141, s[4:7], s98 offen offset:768
    v_add_u32 v204, 0x4000, v200
    v_add_u32 v205, 0x4000, v201
    v_bfe_u32 v220, v1, 4, 1
    v_and_b32 v221, 3, v1
    v_lshl_or_b32 v220, v220, 2, v221
    v_cmp_eq_u32 vcc, 7, v220
    v_lshlrev_b32 v220, 3, v220
    v_lshrrev_b32 v221, 5, v1
    v_cndmask_b32 v220, v220, 0, vcc
    buffer_load_dwordx4 v[20:23], v141, s[4:7], s99 offen offset:0
    v_bfe_u32 v222, v1, 2, 2
    v_lshl_or_b32 v221, v221, 2, v222
    v_mul_u32_u24 v221, 56, v221
    v_add_u32 v220, v220, v221
    v_add_u32 v142, 149504, v220
    v_and_b32_e64 v220, 1, v1
    v_bfe_u32 v221, v1, 2, 2
    v_lshl_or_b32 v220, v221, 1, v220
    buffer_load_dwordx4 v[36:39], v141, s[4:7], s99 offen offset:128
    v_bfe_u32 v221, v1, 1, 1
    v_lshl_or_b32 v220, v221, 3, v220
    v_lshrrev_b32 v221, 5, v1
    v_xor_b32 v220, v220, v221
    v_lshlrev_b32_e64 v220, 3, v220
    v_and_b32 v221, 31, v1
    v_lshl_add_u32 v220, v221, 7, v220
    s_lshl_b32 s50, s44, 12
    buffer_load_dwordx4 v[52:55], v141, s[4:7], s99 offen offset:256
    s_add_u32 s50, s50, 81920
    v_add_u32 v220, s50, v220
    v_xor_b32 v208, 0, v220
    v_xor_b32 v209, 16, v220
    v_xor_b32 v210, 32, v220
    v_xor_b32 v211, 48, v220
    v_xor_b32 v212, 64, v220
    v_xor_b32 v213, 80, v220
    v_xor_b32 v214, 96, v220
    buffer_load_dwordx4 v[68:71], v141, s[4:7], s99 offen offset:384
    v_xor_b32 v215, 112, v220
    v_bfe_u32 v220, v1, 2, 1
    v_bfe_u32 v221, v1, 3, 1
    v_lshl_or_b32 v220, v221, 3, v220
    v_lshrrev_b32 v221, 5, v1
    v_lshl_or_b32 v220, v221, 2, v220
    v_bfe_u32 v222, v1, 4, 1
    v_and_b32 v223, 3, v1
    buffer_load_dwordx4 v[84:87], v141, s[4:7], s99 offen offset:512
    v_lshl_or_b32 v222, v222, 2, v223
    v_bfe_u32 v223, v1, 2, 2
    v_lshl_or_b32 v223, v221, 3, v223
    v_lshlrev_b32 v223, 7, v223
    s_and_b32 s50, s44, 1
    s_lshl_b32 s50, s50, 3
    s_lshr_b32 s51, s44, 1
    s_lshl_b32 s52, s51, 3
    s_lshl_b32 s51, s51, 14
    buffer_load_dwordx4 v[100:103], v141, s[4:7], s99 offen offset:640
    s_add_u32 s51, s51, 81920
    v_xor_b32 v236, 0, v220
    v_or_b32 v237, s50, v222
    v_xor_b32 v237, v237, v236
    v_lshl_add_u32 v237, v237, 3, v223
    v_add_u32 v237, 0, v237
    v_add_u32 v216, s51, v237
    v_or_b32 v237, s52, v222
    buffer_load_dwordx4 v[116:119], v141, s[4:7], s99 offen offset:768
    v_xor_b32 v237, v237, v236
    v_lshl_add_u32 v237, v237, 3, v223
    v_add_u32 v218, 114688, v237
    v_xor_b32 v236, 2, v220
    v_or_b32 v237, s50, v222
    v_xor_b32 v237, v237, v236
    v_lshl_add_u32 v237, v237, 3, v223
    v_add_u32 v237, 512, v237
    v_add_u32_e64 v217, s51, v237
    buffer_load_dwordx4 v[24:27], v141, s[4:7], s100 offen offset:0
    v_or_b32 v237, s52, v222
    v_xor_b32 v237, v237, v236
    v_lshl_add_u32 v237, v237, 3, v223
    v_add_u32 v219, 115200, v237
    s_sub_u32 s92, s46, 1
    s_max_i32 s92, s92, 0
    s_lshl_b32 s92, s92, 7
    s_lshl_b32 s91, s45, 7
    buffer_load_dwordx4 v[40:43], v141, s[4:7], s100 offen offset:128
    s_lshl_b32 s50, s47, 6
    s_add_u32 s91, s91, s50
    v_lshrrev_b32 v220, 3, v1
    v_and_b32 v221, 7, v1
    v_mul_u32_u24 v222, 896, v220
    v_bfe_u32 v223, v220, 1, 1
    v_lshlrev_b32 v223, 2, v223
    v_xor_b32 v223, v223, v221
    buffer_load_dwordx4 v[56:59], v141, s[4:7], s100 offen offset:256
    v_lshl_add_u32 v238, v223, 4, v222
    v_xor_b32 v223, v220, v221
    v_lshl_add_u32 v239, v223, 4, v222
    v_lshl_add_u32 v243, v221, 4, v222
    v_lshlrev_b32 v234, 7, v220
    v_lshl_add_u32 v234, v223, 4, v234
    s_add_u32 s50, s56, 123904
    v_add_u32 v248, s50, v234
    s_mul_i32 s3, s44, 344064
    buffer_load_dwordx4 v[72:75], v141, s[4:7], s100 offen offset:384
    s_add_u32 s3, s3, s92
    s_mul_i32 s49, s44, 57344
    s_add_u32 s49, s49, s92
    s_mul_i32 s59, s44, 7168
    s_add_u32 s59, s59, s92
    s_lshl_b32 s50, s44, 4
    s_add_u32 s50, s50, s91
    s_mul_i32 s93, s50, 896
    buffer_load_dwordx4 v[88:91], v141, s[4:7], s100 offen offset:512
    s_add_u32 s93, s93, s92
    v_lshrrev_b32 v220, 5, v1
    v_bfe_u32 v221, v1, 2, 2
    v_lshl_or_b32 v220, v220, 2, v221
    v_lshlrev_b32 v220, 7, v220
    v_bfe_u32 v221, v1, 4, 1
    v_lshl_add_u32 v220, v221, 5, v220
    v_and_b32 v221, 3, v1
    v_lshl_add_u32 v220, v221, 3, v220
    buffer_load_dwordx4 v[104:107], v141, s[4:7], s100 offen offset:640
    v_bfe_u32 v221, v1, 3, 1
    s_and_b32 s50, s44, 1
    v_xor_b32 v221, s50, v221
    v_lshl_add_u32 v222, v221, 6, v220
    v_add_u32_e64 v240, s57, v222
    s_mul_i32 s51, s50, 28672
    s_add_u32 s51, s51, 0
    v_add_u32 v242, s51, v222
    buffer_load_dwordx4 v[120:123], v141, s[4:7], s100 offen offset:768
    v_xor_b32 v221, 1, v221
    v_lshl_add_u32 v222, v221, 6, v220
    v_add_u32 v241, s57, v222
    v_add_u32 v244, 0x4000, v240
    v_add_u32 v245, 0x4000, v241
    s_mul_i32 s82, s44, 14336
    s_add_u32 s82, s82, 81920
    s_sub_u32 s50, s82, s57
    v_add_u32 v246, s50, v240
    buffer_load_dwordx4 v[28:31], v141, s[4:7], s101 offen offset:0
    v_add_u32 v247, s50, v241
    s_lshr_b32 s50, s44, 1
    s_lshl_b32 s51, s45, 2
    s_lshl_b32 s52, s47, 1
    s_add_u32 s51, s51, s52
    s_add_u32 s52, s51, s50
    s_mul_i32 s89, s52, 114688
    s_lshl_b32 s83, s52, 15
    buffer_load_dwordx4 v[44:47], v141, s[4:7], s101 offen offset:128
    s_add_u32 s83, s83, 7340032
    s_and_b32 s80, s44, 1
    s_lshl_b32 s80, s80, 14
    s_add_u32 s83, s83, s80
    s_xor_b32 s50, s50, 1
    s_add_u32 s52, s51, s50
    s_mul_i32 s90, s52, 114688
    s_lshl_b32 s50, s44, 12
    buffer_load_dwordx4 v[60:63], v141, s[4:7], s101 offen offset:256
    s_add_u32 s84, s89, s50
    s_add_u32 s85, s90, s50
    s_mul_i32 s50, s44, 24576
    s_add_u32 s89, s89, s50
    s_add_u32 s90, s90, s50
    s_xor_b32 s50, s44, 1
    s_mul_i32 s50, s50, 12288
    s_add_u32 s50, s50, 58368
    v_add_u32 v224, s50, v11
    buffer_load_dwordx4 v[76:79], v141, s[4:7], s101 offen offset:384
    s_xor_b32 s50, s44, 2
    s_mul_i32 s50, s50, 12288
    s_add_u32 s50, s50, 62464
    v_add_u32 v225, s50, v11
    s_xor_b32 s50, s44, 3
    s_mul_i32 s50, s50, 12288
    s_add_u32 s50, s50, 66560
    v_add_u32 v226, s50, v11
    buffer_load_dwordx4 v[92:95], v141, s[4:7], s101 offen offset:512
    s_mul_i32 s50, s44, 12288
    s_add_u32 s50, s50, 58368
    v_add_u32 v227, s50, v11
    v_and_b32 v220, 31, v1
    s_lshr_b32 s50, s44, 1
    s_lshl_b32 s50, s50, 5
    v_add_u32 v221, s50, v220
    v_lshlrev_b32 v222, 7, v221
    s_and_b32 s51, s44, 1
    buffer_load_dwordx4 v[108:111], v141, s[4:7], s101 offen offset:640
    s_lshl_b32 s51, s51, 2
    v_and_b32 v223, 7, v220
    v_xor_b32 v223, s51, v223
    v_lshl_add_u32 v222, v223, 4, v222
    v_lshrrev_b32 v223, 5, v1
    v_lshl_add_u32 v222, v223, 3, v222
    v_add_u32 v222, 123904, v222
    v_xor_b32 v228, 0, v222
    buffer_load_dwordx4 v[124:127], v141, s[4:7], s101 offen offset:768
    v_xor_b32 v229, 16, v222
    v_xor_b32 v230, 32, v222
    v_xor_b32 v231, 48, v222
    s_lshl_b32 s50, s47, 8
    s_add_u32 s50, s50, 163328
    v_lshlrev_b32 v221, 2, v221
    v_add_u32 v15, s50, v221
    s_mov_b32 s80, 0x20000000
    s_mov_b32 s81, 0x20000000
    s_waitcnt vmcnt(27)
    v_dot2_f32_bf16 v144, v16, s53, 0
    v_dot2_f32_bf16 v146, v16, v16, 0
    v_dot2_f32_bf16 v145, v17, s53, 0
    v_dot2_f32_bf16 v147, v17, v17, 0
    v_dot2_f32_bf16 v144, v18, s53, v144
    v_dot2_f32_bf16 v146, v18, v18, v146
    v_dot2_f32_bf16 v145, v19, s53, v145
    v_dot2_f32_bf16 v147, v19, v19, v147
    s_waitcnt vmcnt(26)
    v_dot2_f32_bf16 v144, v32, s53, v144
    v_dot2_f32_bf16 v146, v32, v32, v146
    v_dot2_f32_bf16 v145, v33, s53, v145
    v_dot2_f32_bf16 v147, v33, v33, v147
    v_dot2_f32_bf16 v144, v34, s53, v144
    v_dot2_f32_bf16 v146, v34, v34, v146
    v_dot2_f32_bf16 v145, v35, s53, v145
    v_dot2_f32_bf16 v147, v35, v35, v147
    s_waitcnt vmcnt(25)
    v_dot2_f32_bf16 v144, v48, s53, v144
    v_dot2_f32_bf16 v146, v48, v48, v146
    v_dot2_f32_bf16 v145, v49, s53, v145
    v_dot2_f32_bf16 v147, v49, v49, v147
    v_dot2_f32_bf16 v144, v50, s53, v144
    v_dot2_f32_bf16 v146, v50, v50, v146
    v_dot2_f32_bf16 v145, v51, s53, v145
    v_dot2_f32_bf16 v147, v51, v51, v147
    s_waitcnt vmcnt(24)
    v_dot2_f32_bf16 v144, v64, s53, v144
    v_dot2_f32_bf16 v146, v64, v64, v146
    v_dot2_f32_bf16 v145, v65, s53, v145
    v_dot2_f32_bf16 v147, v65, v65, v147
    v_dot2_f32_bf16 v144, v66, s53, v144
    v_dot2_f32_bf16 v146, v66, v66, v146
    v_dot2_f32_bf16 v145, v67, s53, v145
    v_dot2_f32_bf16 v147, v67, v67, v147
    s_waitcnt vmcnt(23)
    v_dot2_f32_bf16 v144, v80, s53, v144
    v_dot2_f32_bf16 v146, v80, v80, v146
    v_dot2_f32_bf16 v145, v81, s53, v145
    v_dot2_f32_bf16 v147, v81, v81, v147
    v_dot2_f32_bf16 v144, v82, s53, v144
    v_dot2_f32_bf16 v146, v82, v82, v146
    v_dot2_f32_bf16 v145, v83, s53, v145
    v_dot2_f32_bf16 v147, v83, v83, v147
    s_waitcnt vmcnt(22)
    v_dot2_f32_bf16 v144, v96, s53, v144
    v_dot2_f32_bf16 v146, v96, v96, v146
    v_dot2_f32_bf16 v145, v97, s53, v145
    v_dot2_f32_bf16 v147, v97, v97, v147
    v_dot2_f32_bf16 v144, v98, s53, v144
    v_dot2_f32_bf16 v146, v98, v98, v146
    v_dot2_f32_bf16 v145, v99, s53, v145
    v_dot2_f32_bf16 v147, v99, v99, v147
    s_waitcnt vmcnt(21)
    v_dot2_f32_bf16 v144, v112, s53, v144
    v_dot2_f32_bf16 v146, v112, v112, v146
    v_dot2_f32_bf16 v145, v113, s53, v145
    v_dot2_f32_bf16 v147, v113, v113, v147
    v_dot2_f32_bf16 v144, v114, s53, v144
    v_dot2_f32_bf16 v146, v114, v114, v146
    v_dot2_f32_bf16 v145, v115, s53, v145
    v_dot2_f32_bf16 v147, v115, v115, v147
    s_lshl_b32 s51, s48, 1
    s_cmp_lg_u32 s51, s45
    s_cbranch_scc1 L_nz_2
    v_mov_b32 v138, 0
    v_mov_b32 v139, 0
    v_mov_b32 v140, 0
    v_mov_b32 v141, 0
    s_lshl_b32 s51, s48, 14
    s_add_u32 s51, s51, s57
    s_add_u32 s51, s51, 9437184
    buffer_store_dwordx4 v[138:141], v11, s[40:43], s51 offen offset:0 sc1
    buffer_store_dwordx4 v[138:141], v11, s[40:43], s51 offen offset:1024 sc1
    buffer_store_dwordx4 v[138:141], v11, s[40:43], s51 offen offset:2048 sc1
    buffer_store_dwordx4 v[138:141], v11, s[40:43], s51 offen offset:3072 sc1
    buffer_store_dword v138, off, s[40:43], s74 sc1
L_nz_2:
    s_mul_i32 s51, s48, 3136
    s_add_u32 s51, s51, s58
    s_add_u32 m0, s58, 149504
    s_mov_b32 s71, s51
    buffer_load_dwordx4 v11, s[12:15], s71 offen lds
    s_add_u32 m0, s57, 0
    s_add_u32 s71, s66, 896
    buffer_load_dwordx4 v2, s[8:11], s71 offen lds
    s_add_u32 m0, s57, 1024
    s_add_u32 s71, s66, 22400
    buffer_load_dwordx4 v2, s[8:11], s71 offen lds
    s_add_u32 m0, s57, 2048
    s_add_u32 s71, s66, 43904
    buffer_load_dwordx4 v2, s[8:11], s71 offen lds
    s_add_u32 m0, s57, 3072
    s_add_u32 s71, s66, 65408
    buffer_load_dwordx4 v2, s[8:11], s71 offen lds
    s_waitcnt vmcnt(25)
    v_dot2_f32_bf16 v148, v20, s53, 0
    v_dot2_f32_bf16 v150, v20, v20, 0
    v_dot2_f32_bf16 v149, v21, s53, 0
    v_add_f32 v144, v144, v145
    v_dot2_f32_bf16 v151, v21, v21, 0
    v_dot2_f32_bf16 v148, v22, s53, v148
    v_add_f32 v146, v146, v147
    v_dot2_f32_bf16 v150, v22, v22, v150
    v_dot2_f32_bf16 v149, v23, s53, v149
    v_add_f32_dpp v144, v144, v144 quad_perm:[1,0,3,2] row_mask:0xf bank_mask:0xf
    v_dot2_f32_bf16 v151, v23, v23, v151
    s_waitcnt vmcnt(24)
    v_dot2_f32_bf16 v148, v36, s53, v148
    v_add_f32_dpp v146, v146, v146 quad_perm:[1,0,3,2] row_mask:0xf bank_mask:0xf
    v_dot2_f32_bf16 v150, v36, v36, v150
    v_dot2_f32_bf16 v149, v37, s53, v149
    v_add_f32_dpp v144, v144, v144 quad_perm:[2,3,0,1] row_mask:0xf bank_mask:0xf
    v_dot2_f32_bf16 v151, v37, v37, v151
    v_dot2_f32_bf16 v148, v38, s53, v148
    v_add_f32_dpp v146, v146, v146 quad_perm:[2,3,0,1] row_mask:0xf bank_mask:0xf
    v_dot2_f32_bf16 v150, v38, v38, v150
    v_dot2_f32_bf16 v149, v39, s53, v149
    v_add_f32_dpp v144, v144, v144 row_half_mirror row_mask:0xf bank_mask:0xf
    v_dot2_f32_bf16 v151, v39, v39, v151
    s_waitcnt vmcnt(23)
    v_dot2_f32_bf16 v148, v52, s53, v148
    v_add_f32_dpp v146, v146, v146 row_half_mirror row_mask:0xf bank_mask:0xf
    v_dot2_f32_bf16 v150, v52, v52, v150
    v_dot2_f32_bf16 v149, v53, s53, v149
    v_mul_f32 v145, 0x3b124925, v144
    v_dot2_f32_bf16 v151, v53, v53, v151
    v_dot2_f32_bf16 v148, v54, s53, v148
    v_mul_f32 v146, 0x3b124925, v146
    v_dot2_f32_bf16 v150, v54, v54, v150
    v_dot2_f32_bf16 v149, v55, s53, v149
    v_fmamk_f32 v144, v145, 0xc3e00000, v144
    v_dot2_f32_bf16 v151, v55, v55, v151
    s_waitcnt vmcnt(22)
    v_dot2_f32_bf16 v148, v68, s53, v148
    v_fmamk_f32 v144, v144, 0x3b124925, v145
    v_dot2_f32_bf16 v150, v68, v68, v150
    v_dot2_f32_bf16 v149, v69, s53, v149
    v_fma_f32 v146, -v144, v144, v146
    v_dot2_f32_bf16 v151, v69, v69, v151
    v_dot2_f32_bf16 v148, v70, s53, v148
    v_dot2_f32_bf16 v150, v70, v70, v150
    v_cvt_pk_bf16_f32 v144, 0, v144
    v_dot2_f32_bf16 v149, v71, s53, v149
    v_dot2_f32_bf16 v151, v71, v71, v151
    v_max_f32 v146, 0, v146
    s_waitcnt vmcnt(21)
    v_dot2_f32_bf16 v148, v84, s53, v148
    v_dot2_f32_bf16 v150, v84, v84, v150
    v_sub_f32_e64 v145, 0, v144
    v_dot2_f32_bf16 v149, v85, s53, v149
    v_dot2_f32_bf16 v151, v85, v85, v151
    v_cvt_pk_bf16_f32 v146, 0, v146
    v_dot2_f32_bf16 v148, v86, s53, v148
    v_dot2_f32_bf16 v150, v86, v86, v150
    v_add_f32 v146, 0x3727c5ac, v146
    v_dot2_f32_bf16 v149, v87, s53, v149
    v_dot2_f32_bf16 v151, v87, v87, v151
    v_cvt_pk_bf16_f32 v146, 0, v146
    s_waitcnt vmcnt(20)
    v_dot2_f32_bf16 v148, v100, s53, v148
    v_dot2_f32_bf16 v150, v100, v100, v150
    v_sqrt_f32_e64 v146, v146
    v_dot2_f32_bf16 v149, v101, s53, v149
    v_dot2_f32_bf16 v151, v101, v101, v151
    s_lshl_b32 s50, s94, 5
    v_dot2_f32_bf16 v148, v102, s53, v148
    v_dot2_f32_bf16 v150, v102, v102, v150
    v_cvt_pk_bf16_f32 v146, 0, v146
    v_dot2_f32_bf16 v149, v103, s53, v149
    v_dot2_f32_bf16 v151, v103, v103, v151
    v_add_u32 v136, s50, v129
    s_waitcnt vmcnt(19)
    v_dot2_f32_bf16 v148, v116, s53, v148
    v_dot2_f32_bf16 v150, v116, v116, v150
    v_rcp_f32_e64 v146, v146
    v_dot2_f32_bf16 v149, v117, s53, v149
    v_dot2_f32_bf16 v151, v117, v117, v151
    s_mul_i32 s50, s94, 7296
    v_dot2_f32_bf16 v148, v118, s53, v148
    v_dot2_f32_bf16 v150, v118, v118, v150
    v_add_u32_e64 v132, s50, v128
    v_dot2_f32_bf16 v149, v119, s53, v149
    v_dot2_f32_bf16 v151, v119, v119, v151
    ds_write_b32 v136, v146
    v_dot2_f32_bf16 v152, v16, s54, v145
    v_dot2_f32_bf16 v153, v16, s55, v145
    v_dot2_f32_bf16 v154, v17, s54, v145
    v_dot2_f32_bf16 v155, v17, s55, v145
    v_dot2_f32_bf16 v156, v18, s54, v145
    v_dot2_f32_bf16 v157, v18, s55, v145
    v_dot2_f32_bf16 v158, v19, s54, v145
    v_dot2_f32_bf16 v159, v19, s55, v145
    v_cvt_pk_bf16_f32 v16, v152, v153
    v_cvt_pk_bf16_f32 v17, v154, v155
    v_cvt_pk_bf16_f32 v18, v156, v157
    v_cvt_pk_bf16_f32 v19, v158, v159
    ds_write_b128 v132, v[16:19] offset:0
    v_dot2_f32_bf16 v152, v32, s54, v145
    v_dot2_f32_bf16 v153, v32, s55, v145
    v_dot2_f32_bf16 v154, v33, s54, v145
    v_dot2_f32_bf16 v155, v33, s55, v145
    v_dot2_f32_bf16 v156, v34, s54, v145
    v_dot2_f32_bf16 v157, v34, s55, v145
    s_add_u32 m0, s57, 16384
    s_add_u32 s71, s66, 344960
    buffer_load_dwordx4 v2, s[8:11], s71 offen lds
    v_dot2_f32_bf16 v158, v35, s54, v145
    v_dot2_f32_bf16 v159, v35, s55, v145
    v_cvt_pk_bf16_f32 v32, v152, v153
    v_cvt_pk_bf16_f32 v33, v154, v155
    v_cvt_pk_bf16_f32 v34, v156, v157
    v_cvt_pk_bf16_f32 v35, v158, v159
    ds_write_b128 v132, v[32:35] offset:128
    v_dot2_f32_bf16 v152, v48, s54, v145
    v_dot2_f32_bf16 v153, v48, s55, v145
    v_dot2_f32_bf16 v154, v49, s54, v145
    v_dot2_f32_bf16 v155, v49, s55, v145
    v_dot2_f32_bf16 v156, v50, s54, v145
    v_dot2_f32_bf16 v157, v50, s55, v145
    v_dot2_f32_bf16 v158, v51, s54, v145
    v_dot2_f32_bf16 v159, v51, s55, v145
    v_cvt_pk_bf16_f32 v48, v152, v153
    v_cvt_pk_bf16_f32 v49, v154, v155
    v_cvt_pk_bf16_f32 v50, v156, v157
    s_add_u32 m0, s57, 17408
    s_add_u32 s71, s66, 366464
    buffer_load_dwordx4 v2, s[8:11], s71 offen lds
    v_cvt_pk_bf16_f32 v51, v158, v159
    ds_write_b128 v132, v[48:51] offset:256
    v_dot2_f32_bf16 v152, v64, s54, v145
    v_dot2_f32_bf16 v153, v64, s55, v145
    v_dot2_f32_bf16 v154, v65, s54, v145
    v_dot2_f32_bf16 v155, v65, s55, v145
    v_dot2_f32_bf16 v156, v66, s54, v145
    v_dot2_f32_bf16 v157, v66, s55, v145
    v_dot2_f32_bf16 v158, v67, s54, v145
    v_dot2_f32_bf16 v159, v67, s55, v145
    v_cvt_pk_bf16_f32 v64, v152, v153
    v_cvt_pk_bf16_f32 v65, v154, v155
    v_cvt_pk_bf16_f32 v66, v156, v157
    v_cvt_pk_bf16_f32 v67, v158, v159
    ds_write_b128 v132, v[64:67] offset:384
    v_dot2_f32_bf16 v152, v80, s54, v145
    v_dot2_f32_bf16 v153, v80, s55, v145
    v_dot2_f32_bf16 v154, v81, s54, v145
    s_add_u32 m0, s57, 18432
    s_add_u32 s71, s66, 387968
    buffer_load_dwordx4 v2, s[8:11], s71 offen lds
    v_dot2_f32_bf16 v155, v81, s55, v145
    v_dot2_f32_bf16 v156, v82, s54, v145
    v_dot2_f32_bf16 v157, v82, s55, v145
    v_dot2_f32_bf16 v158, v83, s54, v145
    v_dot2_f32_bf16 v159, v83, s55, v145
    v_cvt_pk_bf16_f32 v80, v152, v153
    v_cvt_pk_bf16_f32 v81, v154, v155
    v_cvt_pk_bf16_f32 v82, v156, v157
    v_cvt_pk_bf16_f32 v83, v158, v159
    ds_write_b128 v132, v[80:83] offset:512
    v_dot2_f32_bf16 v152, v96, s54, v145
    v_dot2_f32_bf16 v153, v96, s55, v145
    v_dot2_f32_bf16 v154, v97, s54, v145
    v_dot2_f32_bf16 v155, v97, s55, v145
    v_dot2_f32_bf16 v156, v98, s54, v145
    v_dot2_f32_bf16 v157, v98, s55, v145
    v_dot2_f32_bf16 v158, v99, s54, v145
    v_dot2_f32_bf16 v159, v99, s55, v145
    s_add_u32 m0, s57, 19456
    s_add_u32 s71, s66, 409472
    buffer_load_dwordx4 v2, s[8:11], s71 offen lds
    v_cvt_pk_bf16_f32 v96, v152, v153
    v_cvt_pk_bf16_f32 v97, v154, v155
    v_cvt_pk_bf16_f32 v98, v156, v157
    v_cvt_pk_bf16_f32 v99, v158, v159
    ds_write_b128 v132, v[96:99] offset:640
    v_dot2_f32_bf16 v152, v112, s54, v145
    v_dot2_f32_bf16 v153, v112, s55, v145
    v_dot2_f32_bf16 v154, v113, s54, v145
    v_dot2_f32_bf16 v155, v113, s55, v145
    v_dot2_f32_bf16 v156, v114, s54, v145
    v_dot2_f32_bf16 v157, v114, s55, v145
    v_dot2_f32_bf16 v158, v115, s54, v145
    v_dot2_f32_bf16 v159, v115, s55, v145
    v_cvt_pk_bf16_f32 v112, v152, v153
    v_cvt_pk_bf16_f32 v113, v154, v155
    v_cvt_pk_bf16_f32 v114, v156, v157
    v_cvt_pk_bf16_f32 v115, v158, v159
    ds_write_b128 v132, v[112:115] offset:768
    s_cmp_lg_u32 s44, 0
    s_cbranch_scc1 L_wu_8
    v_min_u32 v143, 36, v1
    s_mul_i32 s51, s2, 37
    v_add_u32 v143, s51, v143
    v_lshlrev_b32 v143, 7, v143
    buffer_load_dword v252, v143, s[8:11], 0 offen
L_wu_8:
    s_cmp_lg_u32 s44, 1
    s_cbranch_scc1 L_wu_9
    v_min_u32 v143, 48, v1
    s_mul_i32 s51, s2, 49
    v_add_u32 v143, s51, v143
    v_lshlrev_b32 v143, 7, v143
    buffer_load_dword v252, v143, s[20:23], 0 offen
L_wu_9:
    s_cmp_lg_u32 s44, 2
    s_cbranch_scc1 L_wu_10
    v_min_u32 v143, 48, v1
    s_mul_i32 s51, s2, 49
    v_add_u32 v143, s51, v143
    v_lshlrev_b32 v143, 7, v143
    buffer_load_dword v252, v143, s[24:27], 0 offen
L_wu_10:
    s_waitcnt vmcnt(22)
    v_dot2_f32_bf16 v144, v24, s53, 0
    v_dot2_f32_bf16 v146, v24, v24, 0
    v_dot2_f32_bf16 v145, v25, s53, 0
    v_add_f32 v148, v148, v149
    v_dot2_f32_bf16 v147, v25, v25, 0
    v_dot2_f32_bf16 v144, v26, s53, v144
    v_add_f32 v150, v150, v151
    v_dot2_f32_bf16 v146, v26, v26, v146
    v_dot2_f32_bf16 v145, v27, s53, v145
    v_add_f32_dpp v148, v148, v148 quad_perm:[1,0,3,2] row_mask:0xf bank_mask:0xf
    v_dot2_f32_bf16 v147, v27, v27, v147
    s_waitcnt vmcnt(21)
    v_dot2_f32_bf16 v144, v40, s53, v144
    v_add_f32_dpp v150, v150, v150 quad_perm:[1,0,3,2] row_mask:0xf bank_mask:0xf
    v_dot2_f32_bf16 v146, v40, v40, v146
    v_dot2_f32_bf16 v145, v41, s53, v145
    v_add_f32_dpp v148, v148, v148 quad_perm:[2,3,0,1] row_mask:0xf bank_mask:0xf
    v_dot2_f32_bf16 v147, v41, v41, v147
    v_dot2_f32_bf16 v144, v42, s53, v144
    v_add_f32_dpp v150, v150, v150 quad_perm:[2,3,0,1] row_mask:0xf bank_mask:0xf
    v_dot2_f32_bf16 v146, v42, v42, v146
    v_dot2_f32_bf16 v145, v43, s53, v145
    v_add_f32_dpp v148, v148, v148 row_half_mirror row_mask:0xf bank_mask:0xf
    v_dot2_f32_bf16 v147, v43, v43, v147
    s_waitcnt vmcnt(20)
    v_dot2_f32_bf16 v144, v56, s53, v144
    v_add_f32_dpp v150, v150, v150 row_half_mirror row_mask:0xf bank_mask:0xf
    v_dot2_f32_bf16 v146, v56, v56, v146
    v_dot2_f32_bf16 v145, v57, s53, v145
    v_mul_f32 v149, 0x3b124925, v148
    v_dot2_f32_bf16 v147, v57, v57, v147
    v_dot2_f32_bf16 v144, v58, s53, v144
    v_mul_f32 v150, 0x3b124925, v150
    v_dot2_f32_bf16 v146, v58, v58, v146
    v_dot2_f32_bf16 v145, v59, s53, v145
    v_fmamk_f32 v148, v149, 0xc3e00000, v148
    v_dot2_f32_bf16 v147, v59, v59, v147
    s_waitcnt vmcnt(19)
    v_dot2_f32_bf16 v144, v72, s53, v144
    v_fmamk_f32 v148, v148, 0x3b124925, v149
    v_dot2_f32_bf16 v146, v72, v72, v146
    v_dot2_f32_bf16 v145, v73, s53, v145
    v_fma_f32 v150, -v148, v148, v150
    v_dot2_f32_bf16 v147, v73, v73, v147
    v_dot2_f32_bf16 v144, v74, s53, v144
    v_dot2_f32_bf16 v146, v74, v74, v146
    v_cvt_pk_bf16_f32 v148, 0, v148
    v_dot2_f32_bf16 v145, v75, s53, v145
    v_dot2_f32_bf16 v147, v75, v75, v147
    v_max_f32 v150, 0, v150
    s_waitcnt vmcnt(18)
    v_dot2_f32_bf16 v144, v88, s53, v144
    v_dot2_f32_bf16 v146, v88, v88, v146
    v_sub_f32_e64 v149, 0, v148
    v_dot2_f32_bf16 v145, v89, s53, v145
    v_dot2_f32_bf16 v147, v89, v89, v147
    v_cvt_pk_bf16_f32 v150, 0, v150
    v_dot2_f32_bf16 v144, v90, s53, v144
    v_dot2_f32_bf16 v146, v90, v90, v146
    v_add_f32 v150, 0x3727c5ac, v150
    v_dot2_f32_bf16 v145, v91, s53, v145
    v_dot2_f32_bf16 v147, v91, v91, v147
    v_cvt_pk_bf16_f32 v150, 0, v150
    s_waitcnt vmcnt(17)
    v_dot2_f32_bf16 v144, v104, s53, v144
    v_dot2_f32_bf16 v146, v104, v104, v146
    v_sqrt_f32_e64 v150, v150
    v_dot2_f32_bf16 v145, v105, s53, v145
    v_dot2_f32_bf16 v147, v105, v105, v147
    s_lshl_b32 s50, s95, 5
    v_dot2_f32_bf16 v144, v106, s53, v144
    v_dot2_f32_bf16 v146, v106, v106, v146
    v_cvt_pk_bf16_f32 v150, 0, v150
    v_dot2_f32_bf16 v145, v107, s53, v145
    v_dot2_f32_bf16 v147, v107, v107, v147
    v_add_u32 v136, s50, v129
    s_waitcnt vmcnt(16)
    v_dot2_f32_bf16 v144, v120, s53, v144
    v_dot2_f32_bf16 v146, v120, v120, v146
    v_rcp_f32_e64 v150, v150
    v_dot2_f32_bf16 v145, v121, s53, v145
    v_dot2_f32_bf16 v147, v121, v121, v147
    s_mul_i32 s50, s95, 7296
    v_dot2_f32_bf16 v144, v122, s53, v144
    v_dot2_f32_bf16 v146, v122, v122, v146
    v_add_u32_e64 v133, s50, v128
    v_dot2_f32_bf16 v145, v123, s53, v145
    v_dot2_f32_bf16 v147, v123, v123, v147
    ds_write_b32 v136, v150
    v_dot2_f32_bf16 v152, v20, s54, v149
    v_dot2_f32_bf16 v153, v20, s55, v149
    v_dot2_f32_bf16 v154, v21, s54, v149
    v_dot2_f32_bf16 v155, v21, s55, v149
    v_dot2_f32_bf16 v156, v22, s54, v149
    v_dot2_f32_bf16 v157, v22, s55, v149
    v_dot2_f32_bf16 v158, v23, s54, v149
    v_dot2_f32_bf16 v159, v23, s55, v149
    v_cvt_pk_bf16_f32 v20, v152, v153
    v_cvt_pk_bf16_f32 v21, v154, v155
    v_cvt_pk_bf16_f32 v22, v156, v157
    v_cvt_pk_bf16_f32 v23, v158, v159
    ds_write_b128 v133, v[20:23] offset:0
    v_dot2_f32_bf16 v152, v36, s54, v149
    v_dot2_f32_bf16 v153, v36, s55, v149
    v_dot2_f32_bf16 v154, v37, s54, v149
    v_dot2_f32_bf16 v155, v37, s55, v149
    v_dot2_f32_bf16 v156, v38, s54, v149
    v_dot2_f32_bf16 v157, v38, s55, v149
    v_dot2_f32_bf16 v158, v39, s54, v149
    v_dot2_f32_bf16 v159, v39, s55, v149
    v_cvt_pk_bf16_f32 v36, v152, v153
    v_cvt_pk_bf16_f32 v37, v154, v155
    v_cvt_pk_bf16_f32 v38, v156, v157
    v_cvt_pk_bf16_f32 v39, v158, v159
    ds_write_b128 v133, v[36:39] offset:128
    v_dot2_f32_bf16 v152, v52, s54, v149
    v_dot2_f32_bf16 v153, v52, s55, v149
    v_dot2_f32_bf16 v154, v53, s54, v149
    v_dot2_f32_bf16 v155, v53, s55, v149
    v_dot2_f32_bf16 v156, v54, s54, v149
    v_dot2_f32_bf16 v157, v54, s55, v149
    v_dot2_f32_bf16 v158, v55, s54, v149
    v_dot2_f32_bf16 v159, v55, s55, v149
    v_cvt_pk_bf16_f32 v52, v152, v153
    v_cvt_pk_bf16_f32 v53, v154, v155
    v_cvt_pk_bf16_f32 v54, v156, v157
    v_cvt_pk_bf16_f32 v55, v158, v159
    ds_write_b128 v133, v[52:55] offset:256
    v_dot2_f32_bf16 v152, v68, s54, v149
    v_dot2_f32_bf16 v153, v68, s55, v149
    v_dot2_f32_bf16 v154, v69, s54, v149
    v_dot2_f32_bf16 v155, v69, s55, v149
    v_dot2_f32_bf16 v156, v70, s54, v149
    v_dot2_f32_bf16 v157, v70, s55, v149
    v_dot2_f32_bf16 v158, v71, s54, v149
    v_dot2_f32_bf16 v159, v71, s55, v149
    v_cvt_pk_bf16_f32 v68, v152, v153
    v_cvt_pk_bf16_f32 v69, v154, v155
    v_cvt_pk_bf16_f32 v70, v156, v157
    v_cvt_pk_bf16_f32 v71, v158, v159
    ds_write_b128 v133, v[68:71] offset:384
    v_dot2_f32_bf16 v152, v84, s54, v149
    v_dot2_f32_bf16 v153, v84, s55, v149
    v_dot2_f32_bf16 v154, v85, s54, v149
    v_dot2_f32_bf16 v155, v85, s55, v149
    v_dot2_f32_bf16 v156, v86, s54, v149
    v_dot2_f32_bf16 v157, v86, s55, v149
    v_dot2_f32_bf16 v158, v87, s54, v149
    v_dot2_f32_bf16 v159, v87, s55, v149
    v_cvt_pk_bf16_f32 v84, v152, v153
    v_cvt_pk_bf16_f32 v85, v154, v155
    v_cvt_pk_bf16_f32 v86, v156, v157
    v_cvt_pk_bf16_f32 v87, v158, v159
    ds_write_b128 v133, v[84:87] offset:512
    v_dot2_f32_bf16 v152, v100, s54, v149
    v_dot2_f32_bf16 v153, v100, s55, v149
    v_dot2_f32_bf16 v154, v101, s54, v149
    v_dot2_f32_bf16 v155, v101, s55, v149
    v_dot2_f32_bf16 v156, v102, s54, v149
    v_dot2_f32_bf16 v157, v102, s55, v149
    v_dot2_f32_bf16 v158, v103, s54, v149
    v_dot2_f32_bf16 v159, v103, s55, v149
    v_cvt_pk_bf16_f32 v100, v152, v153
    v_cvt_pk_bf16_f32 v101, v154, v155
    v_cvt_pk_bf16_f32 v102, v156, v157
    v_cvt_pk_bf16_f32 v103, v158, v159
    ds_write_b128 v133, v[100:103] offset:640
    v_dot2_f32_bf16 v152, v116, s54, v149
    v_dot2_f32_bf16 v153, v116, s55, v149
    v_dot2_f32_bf16 v154, v117, s54, v149
    v_dot2_f32_bf16 v155, v117, s55, v149
    v_dot2_f32_bf16 v156, v118, s54, v149
    v_dot2_f32_bf16 v157, v118, s55, v149
    v_dot2_f32_bf16 v158, v119, s54, v149
    v_dot2_f32_bf16 v159, v119, s55, v149
    v_cvt_pk_bf16_f32 v116, v152, v153
    v_cvt_pk_bf16_f32 v117, v154, v155
    v_cvt_pk_bf16_f32 v118, v156, v157
    v_cvt_pk_bf16_f32 v119, v158, v159
    ds_write_b128 v133, v[116:119] offset:768
    s_waitcnt vmcnt(15)
    v_dot2_f32_bf16 v148, v28, s53, 0
    v_dot2_f32_bf16 v150, v28, v28, 0
    v_dot2_f32_bf16 v149, v29, s53, 0
    v_add_f32 v144, v144, v145
    v_dot2_f32_bf16 v151, v29, v29, 0
    v_dot2_f32_bf16 v148, v30, s53, v148
    v_add_f32 v146, v146, v147
    v_dot2_f32_bf16 v150, v30, v30, v150
    v_dot2_f32_bf16 v149, v31, s53, v149
    v_add_f32_dpp v144, v144, v144 quad_perm:[1,0,3,2] row_mask:0xf bank_mask:0xf
    v_dot2_f32_bf16 v151, v31, v31, v151
    s_waitcnt vmcnt(14)
    v_dot2_f32_bf16 v148, v44, s53, v148
    v_add_f32_dpp v146, v146, v146 quad_perm:[1,0,3,2] row_mask:0xf bank_mask:0xf
    v_dot2_f32_bf16 v150, v44, v44, v150
    v_dot2_f32_bf16 v149, v45, s53, v149
    v_add_f32_dpp v144, v144, v144 quad_perm:[2,3,0,1] row_mask:0xf bank_mask:0xf
    v_dot2_f32_bf16 v151, v45, v45, v151
    v_dot2_f32_bf16 v148, v46, s53, v148
    v_add_f32_dpp v146, v146, v146 quad_perm:[2,3,0,1] row_mask:0xf bank_mask:0xf
    v_dot2_f32_bf16 v150, v46, v46, v150
    v_dot2_f32_bf16 v149, v47, s53, v149
    v_add_f32_dpp v144, v144, v144 row_half_mirror row_mask:0xf bank_mask:0xf
    v_dot2_f32_bf16 v151, v47, v47, v151
    s_waitcnt vmcnt(13)
    v_dot2_f32_bf16 v148, v60, s53, v148
    v_add_f32_dpp v146, v146, v146 row_half_mirror row_mask:0xf bank_mask:0xf
    v_dot2_f32_bf16 v150, v60, v60, v150
    v_dot2_f32_bf16 v149, v61, s53, v149
    v_mul_f32 v145, 0x3b124925, v144
    v_dot2_f32_bf16 v151, v61, v61, v151
    v_dot2_f32_bf16 v148, v62, s53, v148
    v_mul_f32 v146, 0x3b124925, v146
    v_dot2_f32_bf16 v150, v62, v62, v150
    v_dot2_f32_bf16 v149, v63, s53, v149
    v_fmamk_f32 v144, v145, 0xc3e00000, v144
    v_dot2_f32_bf16 v151, v63, v63, v151
    s_waitcnt vmcnt(12)
    v_dot2_f32_bf16 v148, v76, s53, v148
    v_fmamk_f32 v144, v144, 0x3b124925, v145
    v_dot2_f32_bf16 v150, v76, v76, v150
    v_dot2_f32_bf16 v149, v77, s53, v149
    v_fma_f32 v146, -v144, v144, v146
    v_dot2_f32_bf16 v151, v77, v77, v151
    v_dot2_f32_bf16 v148, v78, s53, v148
    v_dot2_f32_bf16 v150, v78, v78, v150
    v_cvt_pk_bf16_f32 v144, 0, v144
    v_dot2_f32_bf16 v149, v79, s53, v149
    v_dot2_f32_bf16 v151, v79, v79, v151
    v_max_f32 v146, 0, v146
    s_waitcnt vmcnt(11)
    v_dot2_f32_bf16 v148, v92, s53, v148
    v_dot2_f32_bf16 v150, v92, v92, v150
    v_sub_f32_e64 v145, 0, v144
    v_dot2_f32_bf16 v149, v93, s53, v149
    v_dot2_f32_bf16 v151, v93, v93, v151
    v_cvt_pk_bf16_f32 v146, 0, v146
    v_dot2_f32_bf16 v148, v94, s53, v148
    v_dot2_f32_bf16 v150, v94, v94, v150
    v_add_f32 v146, 0x3727c5ac, v146
    v_dot2_f32_bf16 v149, v95, s53, v149
    v_dot2_f32_bf16 v151, v95, v95, v151
    v_cvt_pk_bf16_f32 v146, 0, v146
    s_waitcnt vmcnt(10)
    v_dot2_f32_bf16 v148, v108, s53, v148
    v_dot2_f32_bf16 v150, v108, v108, v150
    v_sqrt_f32_e64 v146, v146
    v_dot2_f32_bf16 v149, v109, s53, v149
    v_dot2_f32_bf16 v151, v109, v109, v151
    s_lshl_b32 s50, s96, 5
    v_dot2_f32_bf16 v148, v110, s53, v148
    v_dot2_f32_bf16 v150, v110, v110, v150
    v_cvt_pk_bf16_f32 v146, 0, v146
    v_dot2_f32_bf16 v149, v111, s53, v149
    v_dot2_f32_bf16 v151, v111, v111, v151
    v_add_u32 v136, s50, v129
    s_waitcnt vmcnt(9)
    v_dot2_f32_bf16 v148, v124, s53, v148
    v_dot2_f32_bf16 v150, v124, v124, v150
    v_rcp_f32_e64 v146, v146
    v_dot2_f32_bf16 v149, v125, s53, v149
    v_dot2_f32_bf16 v151, v125, v125, v151
    s_mul_i32 s50, s96, 7296
    v_dot2_f32_bf16 v148, v126, s53, v148
    v_dot2_f32_bf16 v150, v126, v126, v150
    v_add_u32_e64 v134, s50, v128
    v_dot2_f32_bf16 v149, v127, s53, v149
    v_dot2_f32_bf16 v151, v127, v127, v151
    ds_write_b32 v136, v146
    v_dot2_f32_bf16 v152, v24, s54, v145
    v_dot2_f32_bf16 v153, v24, s55, v145
    v_dot2_f32_bf16 v154, v25, s54, v145
    v_dot2_f32_bf16 v155, v25, s55, v145
    v_dot2_f32_bf16 v156, v26, s54, v145
    v_dot2_f32_bf16 v157, v26, s55, v145
    v_dot2_f32_bf16 v158, v27, s54, v145
    v_dot2_f32_bf16 v159, v27, s55, v145
    v_cvt_pk_bf16_f32 v24, v152, v153
    v_cvt_pk_bf16_f32 v25, v154, v155
    v_cvt_pk_bf16_f32 v26, v156, v157
    v_cvt_pk_bf16_f32 v27, v158, v159
    ds_write_b128 v134, v[24:27] offset:0
    v_dot2_f32_bf16 v152, v40, s54, v145
    v_dot2_f32_bf16 v153, v40, s55, v145
    v_dot2_f32_bf16 v154, v41, s54, v145
    v_dot2_f32_bf16 v155, v41, s55, v145
    v_dot2_f32_bf16 v156, v42, s54, v145
    v_dot2_f32_bf16 v157, v42, s55, v145
    v_dot2_f32_bf16 v158, v43, s54, v145
    v_dot2_f32_bf16 v159, v43, s55, v145
    v_cvt_pk_bf16_f32 v40, v152, v153
    v_cvt_pk_bf16_f32 v41, v154, v155
    v_cvt_pk_bf16_f32 v42, v156, v157
    v_cvt_pk_bf16_f32 v43, v158, v159
    ds_write_b128 v134, v[40:43] offset:128
    v_dot2_f32_bf16 v152, v56, s54, v145
    v_dot2_f32_bf16 v153, v56, s55, v145
    v_dot2_f32_bf16 v154, v57, s54, v145
    v_dot2_f32_bf16 v155, v57, s55, v145
    v_dot2_f32_bf16 v156, v58, s54, v145
    v_dot2_f32_bf16 v157, v58, s55, v145
    v_dot2_f32_bf16 v158, v59, s54, v145
    v_dot2_f32_bf16 v159, v59, s55, v145
    v_cvt_pk_bf16_f32 v56, v152, v153
    v_cvt_pk_bf16_f32 v57, v154, v155
    v_cvt_pk_bf16_f32 v58, v156, v157
    v_cvt_pk_bf16_f32 v59, v158, v159
    ds_write_b128 v134, v[56:59] offset:256
    v_dot2_f32_bf16 v152, v72, s54, v145
    v_dot2_f32_bf16 v153, v72, s55, v145
    v_dot2_f32_bf16 v154, v73, s54, v145
    v_dot2_f32_bf16 v155, v73, s55, v145
    v_dot2_f32_bf16 v156, v74, s54, v145
    v_dot2_f32_bf16 v157, v74, s55, v145
    v_dot2_f32_bf16 v158, v75, s54, v145
    v_dot2_f32_bf16 v159, v75, s55, v145
    v_cvt_pk_bf16_f32 v72, v152, v153
    v_cvt_pk_bf16_f32 v73, v154, v155
    v_cvt_pk_bf16_f32 v74, v156, v157
    v_cvt_pk_bf16_f32 v75, v158, v159
    ds_write_b128 v134, v[72:75] offset:384
    v_dot2_f32_bf16 v152, v88, s54, v145
    v_dot2_f32_bf16 v153, v88, s55, v145
    v_dot2_f32_bf16 v154, v89, s54, v145
    v_dot2_f32_bf16 v155, v89, s55, v145
    v_dot2_f32_bf16 v156, v90, s54, v145
    v_dot2_f32_bf16 v157, v90, s55, v145
    v_dot2_f32_bf16 v158, v91, s54, v145
    v_dot2_f32_bf16 v159, v91, s55, v145
    v_cvt_pk_bf16_f32 v88, v152, v153
    v_cvt_pk_bf16_f32 v89, v154, v155
    v_cvt_pk_bf16_f32 v90, v156, v157
    v_cvt_pk_bf16_f32 v91, v158, v159
    ds_write_b128 v134, v[88:91] offset:512
    v_dot2_f32_bf16 v152, v104, s54, v145
    v_dot2_f32_bf16 v153, v104, s55, v145
    v_dot2_f32_bf16 v154, v105, s54, v145
    v_dot2_f32_bf16 v155, v105, s55, v145
    v_dot2_f32_bf16 v156, v106, s54, v145
    v_dot2_f32_bf16 v157, v106, s55, v145
    v_dot2_f32_bf16 v158, v107, s54, v145
    v_dot2_f32_bf16 v159, v107, s55, v145
    v_cvt_pk_bf16_f32 v104, v152, v153
    v_cvt_pk_bf16_f32 v105, v154, v155
    v_cvt_pk_bf16_f32 v106, v156, v157
    v_cvt_pk_bf16_f32 v107, v158, v159
    ds_write_b128 v134, v[104:107] offset:640
    v_dot2_f32_bf16 v152, v120, s54, v145
    v_dot2_f32_bf16 v153, v120, s55, v145
    v_dot2_f32_bf16 v154, v121, s54, v145
    v_dot2_f32_bf16 v155, v121, s55, v145
    v_dot2_f32_bf16 v156, v122, s54, v145
    v_dot2_f32_bf16 v157, v122, s55, v145
    v_dot2_f32_bf16 v158, v123, s54, v145
    v_dot2_f32_bf16 v159, v123, s55, v145
    v_cvt_pk_bf16_f32 v120, v152, v153
    v_cvt_pk_bf16_f32 v121, v154, v155
    v_cvt_pk_bf16_f32 v122, v156, v157
    v_cvt_pk_bf16_f32 v123, v158, v159
    ds_write_b128 v134, v[120:123] offset:768
    s_cmp_lg_u32 s44, 3
    s_cbranch_scc1 L_wu_11
    v_min_u32 v143, 48, v1
    s_mul_i32 s51, s2, 49
    v_add_u32 v143, s51, v143
    v_lshlrev_b32 v143, 7, v143
    buffer_load_dword v252, v143, s[28:31], 0 offen
L_wu_11:
    s_cmp_lg_u32 s44, 0
    s_cbranch_scc1 L_wu_12
    v_min_u32 v143, 12, v1
    s_mul_i32 s51, s2, 13
    v_add_u32 v143, s51, v143
    v_lshlrev_b32 v143, 7, v143
    buffer_load_dword v252, v143, s[16:19], 0 offen
L_wu_12:
    v_add_f32_e64 v148, v148, v149
    v_add_f32 v150, v150, v151
    s_nop 0
    v_add_f32_dpp v148, v148, v148 quad_perm:[1,0,3,2] row_mask:0xf bank_mask:0xf
    v_add_f32_dpp v150, v150, v150 quad_perm:[1,0,3,2] row_mask:0xf bank_mask:0xf
    s_nop 0
    v_add_f32_dpp v148, v148, v148 quad_perm:[2,3,0,1] row_mask:0xf bank_mask:0xf
    v_add_f32_dpp v150, v150, v150 quad_perm:[2,3,0,1] row_mask:0xf bank_mask:0xf
    s_nop 0
    v_add_f32_dpp v148, v148, v148 row_half_mirror row_mask:0xf bank_mask:0xf
    v_add_f32_dpp v150, v150, v150 row_half_mirror row_mask:0xf bank_mask:0xf
    v_mul_f32 v149, 0x3b124925, v148
    v_mul_f32 v150, 0x3b124925, v150
    v_fmamk_f32 v148, v149, 0xc3e00000, v148
    v_fmamk_f32 v148, v148, 0x3b124925, v149
    v_fma_f32 v150, -v148, v148, v150
    v_cvt_pk_bf16_f32 v148, 0, v148
    v_max_f32 v150, 0, v150
    v_sub_f32 v149, 0, v148
    v_cvt_pk_bf16_f32 v150, 0, v150
    v_add_f32 v150, 0x3727c5ac, v150
    v_cvt_pk_bf16_f32 v150, 0, v150
    v_sqrt_f32 v150, v150
    s_lshl_b32 s50, s97, 5
    v_cvt_pk_bf16_f32 v150, 0, v150
    v_add_u32 v136, s50, v129
    v_rcp_f32 v150, v150
    s_mul_i32 s50, s97, 7296
    v_add_u32_e64 v135, s50, v128
    ds_write_b32 v136, v150
    v_dot2_f32_bf16 v152, v28, s54, v149
    v_dot2_f32_bf16 v153, v28, s55, v149
    v_dot2_f32_bf16 v154, v29, s54, v149
    v_dot2_f32_bf16 v155, v29, s55, v149
    v_dot2_f32_bf16 v156, v30, s54, v149
    v_dot2_f32_bf16 v157, v30, s55, v149
    v_dot2_f32_bf16 v158, v31, s54, v149
    v_dot2_f32_bf16 v159, v31, s55, v149
    v_cvt_pk_bf16_f32 v28, v152, v153
    v_cvt_pk_bf16_f32 v29, v154, v155
    v_cvt_pk_bf16_f32 v30, v156, v157
    v_cvt_pk_bf16_f32 v31, v158, v159
    ds_write_b128 v135, v[28:31] offset:0
    v_dot2_f32_bf16 v152, v44, s54, v149
    v_dot2_f32_bf16 v153, v44, s55, v149
    v_dot2_f32_bf16 v154, v45, s54, v149
    v_dot2_f32_bf16 v155, v45, s55, v149
    v_dot2_f32_bf16 v156, v46, s54, v149
    v_dot2_f32_bf16 v157, v46, s55, v149
    v_dot2_f32_bf16 v158, v47, s54, v149
    v_dot2_f32_bf16 v159, v47, s55, v149
    v_cvt_pk_bf16_f32 v44, v152, v153
    v_cvt_pk_bf16_f32 v45, v154, v155
    v_cvt_pk_bf16_f32 v46, v156, v157
    v_cvt_pk_bf16_f32 v47, v158, v159
    ds_write_b128 v135, v[44:47] offset:128
    v_dot2_f32_bf16 v152, v60, s54, v149
    v_dot2_f32_bf16 v153, v60, s55, v149
    v_dot2_f32_bf16 v154, v61, s54, v149
    v_dot2_f32_bf16 v155, v61, s55, v149
    v_dot2_f32_bf16 v156, v62, s54, v149
    v_dot2_f32_bf16 v157, v62, s55, v149
    v_dot2_f32_bf16 v158, v63, s54, v149
    v_dot2_f32_bf16 v159, v63, s55, v149
    v_cvt_pk_bf16_f32 v60, v152, v153
    v_cvt_pk_bf16_f32 v61, v154, v155
    v_cvt_pk_bf16_f32 v62, v156, v157
    v_cvt_pk_bf16_f32 v63, v158, v159
    ds_write_b128 v135, v[60:63] offset:256
    v_dot2_f32_bf16 v152, v76, s54, v149
    v_dot2_f32_bf16 v153, v76, s55, v149
    v_dot2_f32_bf16 v154, v77, s54, v149
    v_dot2_f32_bf16 v155, v77, s55, v149
    v_dot2_f32_bf16 v156, v78, s54, v149
    v_dot2_f32_bf16 v157, v78, s55, v149
    v_dot2_f32_bf16 v158, v79, s54, v149
    v_dot2_f32_bf16 v159, v79, s55, v149
    v_cvt_pk_bf16_f32 v76, v152, v153
    v_cvt_pk_bf16_f32 v77, v154, v155
    v_cvt_pk_bf16_f32 v78, v156, v157
    v_cvt_pk_bf16_f32 v79, v158, v159
    ds_write_b128 v135, v[76:79] offset:384
    v_dot2_f32_bf16 v152, v92, s54, v149
    v_dot2_f32_bf16 v153, v92, s55, v149
    v_dot2_f32_bf16 v154, v93, s54, v149
    v_dot2_f32_bf16 v155, v93, s55, v149
    v_dot2_f32_bf16 v156, v94, s54, v149
    v_dot2_f32_bf16 v157, v94, s55, v149
    v_dot2_f32_bf16 v158, v95, s54, v149
    v_dot2_f32_bf16 v159, v95, s55, v149
    v_cvt_pk_bf16_f32 v92, v152, v153
    v_cvt_pk_bf16_f32 v93, v154, v155
    v_cvt_pk_bf16_f32 v94, v156, v157
    v_cvt_pk_bf16_f32 v95, v158, v159
    ds_write_b128 v135, v[92:95] offset:512
    v_dot2_f32_bf16 v152, v108, s54, v149
    v_dot2_f32_bf16 v153, v108, s55, v149
    v_dot2_f32_bf16 v154, v109, s54, v149
    v_dot2_f32_bf16 v155, v109, s55, v149
    v_dot2_f32_bf16 v156, v110, s54, v149
    v_dot2_f32_bf16 v157, v110, s55, v149
    v_dot2_f32_bf16 v158, v111, s54, v149
    v_dot2_f32_bf16 v159, v111, s55, v149
    v_cvt_pk_bf16_f32 v108, v152, v153
    v_cvt_pk_bf16_f32 v109, v154, v155
    v_cvt_pk_bf16_f32 v110, v156, v157
    v_cvt_pk_bf16_f32 v111, v158, v159
    ds_write_b128 v135, v[108:111] offset:640
    v_dot2_f32_bf16 v152, v124, s54, v149
    v_dot2_f32_bf16 v153, v124, s55, v149
    v_dot2_f32_bf16 v154, v125, s54, v149
    v_dot2_f32_bf16 v155, v125, s55, v149
    v_dot2_f32_bf16 v156, v126, s54, v149
    v_dot2_f32_bf16 v157, v126, s55, v149
    v_dot2_f32_bf16 v158, v127, s54, v149
    v_dot2_f32_bf16 v159, v127, s55, v149
    v_cvt_pk_bf16_f32 v124, v152, v153
    v_cvt_pk_bf16_f32 v125, v154, v155
    v_cvt_pk_bf16_f32 v126, v156, v157
    v_cvt_pk_bf16_f32 v127, v158, v159
    ds_write_b128 v135, v[124:127] offset:768
    ds_read_b128 a[0:3], v130 offset:0
    ds_read_b128 a[4:7], v130 offset:32
    ds_read_b128 a[8:11], v130 offset:64
    ds_read_b128 a[12:15], v130 offset:96
    ds_read_b128 a[16:19], v130 offset:128
    ds_read_b128 a[20:23], v130 offset:160
    ds_read_b128 a[24:27], v130 offset:192
    ds_read_b128 a[28:31], v130 offset:224
    ds_read_b128 a[32:35], v130 offset:256
    ds_read_b128 a[36:39], v130 offset:288
    ds_read_b128 a[40:43], v130 offset:320
    ds_read_b128 a[44:47], v130 offset:352
    ds_read_b128 a[48:51], v130 offset:384
    ds_read_b128 a[52:55], v130 offset:416
    ds_read_b128 a[56:59], v130 offset:448
    ds_read_b128 a[60:63], v130 offset:480
    ds_read_b128 a[64:67], v130 offset:512
    ds_read_b128 a[68:71], v130 offset:544
    ds_read_b128 a[72:75], v130 offset:576
    ds_read_b128 a[76:79], v130 offset:608
    ds_read_b128 a[80:83], v130 offset:640
    ds_read_b128 a[84:87], v130 offset:672
    ds_read_b128 a[88:91], v130 offset:704
    ds_read_b128 a[92:95], v130 offset:736
    ds_read_b128 a[96:99], v130 offset:768
    ds_read_b128 a[100:103], v130 offset:800
    ds_read_b128 a[104:107], v130 offset:832
    ds_read_b128 a[108:111], v130 offset:864
    ds_read_b32 v7, v131
    s_waitcnt lgkmcnt(0)
    v_mul_f32 v8, 0xbfb8aa3b, v7
    v_mul_f32 v9, 0x3fb8aa3b, v7
    s_waitcnt vmcnt(8)
    s_waitcnt vmcnt(4)
    s_barrier
    s_lshl_b32 s50, s48, 1
    s_cmp_lg_u32 s50, s45
    s_cbranch_scc1 L_nzf_17
    s_cmp_lg_u32 s44, 0
    s_cbranch_scc1 L_nzf_17
    v_mov_b32 v138, 1
    buffer_store_dword v138, off, s[36:39], s86 sc1
L_nzf_17:
    ds_read_b64_tr_b16 a[112:113], v192 offset:0
    ds_read_b64_tr_b16 a[114:115], v192 offset:512
    ds_read_b64_tr_b16 a[116:117], v193 offset:0
    ds_read_b64_tr_b16 a[118:119], v193 offset:512
    ds_read_b64_tr_b16 a[120:121], v192 offset:2048
    ds_read_b64_tr_b16 a[122:123], v192 offset:2560
    ds_read_b64_tr_b16 a[124:125], v193 offset:2048
    ds_read_b64_tr_b16 a[126:127], v193 offset:2560
    ds_read_b64_tr_b16 a[128:129], v192 offset:4096
    ds_read_b64_tr_b16 a[130:131], v192 offset:4608
    ds_read_b64_tr_b16 a[132:133], v193 offset:4096
    ds_read_b64_tr_b16 a[134:135], v193 offset:4608
    s_waitcnt lgkmcnt(8)
    v_mfma_f32_32x32x16_bf16 v[16:31], a[112:115], a[0:3], 0
    ds_read_b64_tr_b16 a[136:137], v192 offset:6144
    ds_read_b64_tr_b16 a[138:139], v192 offset:6656
    s_add_u32 m0, s57, 32768
    s_add_u32 s71, s66, 689024
    buffer_load_dwordx4 v2, s[8:11], s71 offen lds
    v_mfma_f32_32x32x16_bf16 v[32:47], a[116:119], a[0:3], 0
    ds_read_b64_tr_b16 a[140:141], v193 offset:6144
    ds_read_b64_tr_b16 a[142:143], v193 offset:6656
    s_add_u32 m0, s57, 33792
    s_add_u32 s71, s66, 710528
    buffer_load_dwordx4 v2, s[8:11], s71 offen lds
    s_waitcnt lgkmcnt(8)
    v_mfma_f32_32x32x16_bf16 v[16:31], a[120:123], a[4:7], v[16:31]
    ds_read_b64_tr_b16 a[224:225], v192 offset:8192
    ds_read_b64_tr_b16 a[226:227], v192 offset:8704
    s_add_u32 m0, s57, 34816
    s_add_u32 s71, s66, 732032
    buffer_load_dwordx4 v2, s[8:11], s71 offen lds
    v_mfma_f32_32x32x16_bf16 v[32:47], a[124:127], a[4:7], v[32:47]
    ds_read_b64_tr_b16 a[228:229], v193 offset:8192
    ds_read_b64_tr_b16 a[230:231], v193 offset:8704
    s_add_u32 m0, s57, 35840
    s_add_u32 s71, s66, 753536
    buffer_load_dwordx4 v2, s[8:11], s71 offen lds
    s_waitcnt lgkmcnt(8)
    v_mfma_f32_32x32x16_bf16 v[16:31], a[128:131], a[8:11], v[16:31]
    ds_read_b64_tr_b16 a[232:233], v192 offset:10240
    ds_read_b64_tr_b16 a[234:235], v192 offset:10752
    s_add_u32 m0, s56, 49152
    s_add_u32 s71, s67, 1033088
    buffer_load_dwordx4 v2, s[8:11], s71 offen lds
    v_mfma_f32_32x32x16_bf16 v[32:47], a[132:135], a[8:11], v[32:47]
    ds_read_b64_tr_b16 a[236:237], v193 offset:10240
    ds_read_b64_tr_b16 a[238:239], v193 offset:10752
    s_add_u32 m0, s56, 50176
    s_add_u32 s71, s67, 1054592
    buffer_load_dwordx4 v2, s[8:11], s71 offen lds
    s_waitcnt lgkmcnt(8)
    v_mfma_f32_32x32x16_bf16 v[16:31], a[136:139], a[12:15], v[16:31]
    ds_read_b64_tr_b16 a[112:113], v192 offset:12288
    ds_read_b64_tr_b16 a[114:115], v192 offset:12800
    s_add_u32 m0, s57, 65536
    s_add_u32 s71, s66, 1792
    buffer_load_dwordx4 v2, s[8:11], s71 offen lds
    v_mfma_f32_32x32x16_bf16 v[32:47], a[140:143], a[12:15], v[32:47]
    ds_read_b64_tr_b16 a[116:117], v193 offset:12288
    ds_read_b64_tr_b16 a[118:119], v193 offset:12800
    s_add_u32 m0, s57, 66560
    s_add_u32 s71, s66, 23296
    buffer_load_dwordx4 v2, s[8:11], s71 offen lds
    s_waitcnt lgkmcnt(8)
    v_mfma_f32_32x32x16_bf16 v[16:31], a[224:227], a[16:19], v[16:31]
    ds_read_b64_tr_b16 a[120:121], v192 offset:14336
    ds_read_b64_tr_b16 a[122:123], v192 offset:14848
    s_add_u32 m0, s57, 67584
    s_add_u32 s71, s66, 44800
    buffer_load_dwordx4 v2, s[8:11], s71 offen lds
    v_mfma_f32_32x32x16_bf16 v[32:47], a[228:231], a[16:19], v[32:47]
    ds_read_b64_tr_b16 a[124:125], v193 offset:14336
    ds_read_b64_tr_b16 a[126:127], v193 offset:14848
    s_add_u32 m0, s57, 68608
    s_add_u32 s71, s66, 66304
    buffer_load_dwordx4 v2, s[8:11], s71 offen lds
    s_waitcnt lgkmcnt(8)
    v_mfma_f32_32x32x16_bf16 v[16:31], a[232:235], a[20:23], v[16:31]
    s_waitcnt vmcnt(10)
    s_barrier
    ds_read_b64_tr_b16 a[128:129], v192 offset:16384
    ds_read_b64_tr_b16 a[130:131], v192 offset:16896
    v_mfma_f32_32x32x16_bf16 v[32:47], a[236:239], a[20:23], v[32:47]
    ds_read_b64_tr_b16 a[132:133], v193 offset:16384
    ds_read_b64_tr_b16 a[134:135], v193 offset:16896
    s_waitcnt lgkmcnt(8)
    v_mfma_f32_32x32x16_bf16 v[16:31], a[112:115], a[24:27], v[16:31]
    ds_read_b64_tr_b16 a[136:137], v192 offset:18432
    ds_read_b64_tr_b16 a[138:139], v192 offset:18944
    v_mfma_f32_32x32x16_bf16 v[32:47], a[116:119], a[24:27], v[32:47]
    ds_read_b64_tr_b16 a[140:141], v193 offset:18432
    ds_read_b64_tr_b16 a[142:143], v193 offset:18944
    s_waitcnt lgkmcnt(8)
    v_mfma_f32_32x32x16_bf16 v[16:31], a[120:123], a[28:31], v[16:31]
    ds_read_b64_tr_b16 a[224:225], v192 offset:20480
    ds_read_b64_tr_b16 a[226:227], v192 offset:20992
    v_mfma_f32_32x32x16_bf16 v[32:47], a[124:127], a[28:31], v[32:47]
    ds_read_b64_tr_b16 a[228:229], v193 offset:20480
    ds_read_b64_tr_b16 a[230:231], v193 offset:20992
    ds_read_b64_tr_b16 a[144:145], v142 offset:0
    s_waitcnt lgkmcnt(9)
    v_mfma_f32_32x32x16_bf16 v[16:31], a[128:131], a[32:35], v[16:31]
    ds_read_b64_tr_b16 a[232:233], v192 offset:22528
    ds_read_b64_tr_b16 a[234:235], v192 offset:23040
    v_mfma_f32_32x32x16_bf16 v[32:47], a[132:135], a[32:35], v[32:47]
    ds_read_b64_tr_b16 a[236:237], v193 offset:22528
    ds_read_b64_tr_b16 a[238:239], v193 offset:23040
    s_waitcnt lgkmcnt(9)
    v_mfma_f32_32x32x16_bf16 v[16:31], a[136:139], a[36:39], v[16:31]
    ds_read_b64_tr_b16 a[112:113], v192 offset:24576
    ds_read_b64_tr_b16 a[114:115], v192 offset:25088
    v_mfma_f32_32x32x16_bf16 v[32:47], a[140:143], a[36:39], v[32:47]
    ds_read_b64_tr_b16 a[116:117], v193 offset:24576
    ds_read_b64_tr_b16 a[118:119], v193 offset:25088
    ds_read_b64_tr_b16 a[146:147], v142 offset:448
    s_waitcnt lgkmcnt(10)
    v_mfma_f32_32x32x16_bf16 v[16:31], a[224:227], a[40:43], v[16:31]
    ds_read_b64_tr_b16 a[120:121], v192 offset:26624
    ds_read_b64_tr_b16 a[122:123], v192 offset:27136
    v_mfma_f32_32x32x16_bf16 v[32:47], a[228:231], a[40:43], v[32:47]
    ds_read_b64_tr_b16 a[124:125], v193 offset:26624
    ds_read_b64_tr_b16 a[126:127], v193 offset:27136
    s_waitcnt lgkmcnt(9)
    v_mfma_f32_32x32x16_bf16 v[16:31], a[232:235], a[44:47], v[16:31]
    ds_read_b64_tr_b16 a[128:129], v192 offset:28672
    ds_read_b64_tr_b16 a[130:131], v192 offset:29184
    v_mfma_f32_32x32x16_bf16 v[32:47], a[236:239], a[44:47], v[32:47]
    ds_read_b64_tr_b16 a[132:133], v193 offset:28672
    ds_read_b64_tr_b16 a[134:135], v193 offset:29184
    ds_read_b64_tr_b16 a[148:149], v142 offset:896
    s_waitcnt lgkmcnt(10)
    v_mfma_f32_32x32x16_bf16 v[16:31], a[112:115], a[48:51], v[16:31]
    ds_read_b64_tr_b16 a[136:137], v192 offset:30720
    ds_read_b64_tr_b16 a[138:139], v192 offset:31232
    v_mfma_f32_32x32x16_bf16 v[32:47], a[116:119], a[48:51], v[32:47]
    ds_read_b64_tr_b16 a[140:141], v193 offset:30720
    ds_read_b64_tr_b16 a[142:143], v193 offset:31232
    ds_read_b64_tr_b16 a[150:151], v142 offset:1344
    s_waitcnt lgkmcnt(10)
    v_mfma_f32_32x32x16_bf16 v[16:31], a[120:123], a[52:55], v[16:31]
    s_waitcnt vmcnt(6)
    s_barrier
    ds_read_b64_tr_b16 a[224:225], v192 offset:32768
    ds_read_b64_tr_b16 a[226:227], v192 offset:33280
    s_add_u32 m0, s57, 0
    s_add_u32 s71, s66, 345856
    buffer_load_dwordx4 v2, s[8:11], s71 offen lds
    v_mfma_f32_32x32x16_bf16 v[32:47], a[124:127], a[52:55], v[32:47]
    ds_read_b64_tr_b16 a[228:229], v193 offset:32768
    ds_read_b64_tr_b16 a[230:231], v193 offset:33280
    s_waitcnt lgkmcnt(10)
    v_mfma_f32_32x32x16_bf16 v[16:31], a[128:131], a[56:59], v[16:31]
    ds_read_b64_tr_b16 a[232:233], v192 offset:34816
    ds_read_b64_tr_b16 a[234:235], v192 offset:35328
    v_mfma_f32_32x32x16_bf16 v[32:47], a[132:135], a[56:59], v[32:47]
    ds_read_b64_tr_b16 a[236:237], v193 offset:34816
    ds_read_b64_tr_b16 a[238:239], v193 offset:35328
    s_add_u32 m0, s57, 1024
    s_add_u32 s71, s66, 367360
    buffer_load_dwordx4 v2, s[8:11], s71 offen lds
    s_waitcnt lgkmcnt(9)
    v_mfma_f32_32x32x16_bf16 v[16:31], a[136:139], a[60:63], v[16:31]
    ds_read_b64_tr_b16 a[112:113], v192 offset:36864
    ds_read_b64_tr_b16 a[114:115], v192 offset:37376
    v_mfma_f32_32x32x16_bf16 v[32:47], a[140:143], a[60:63], v[32:47]
    ds_read_b64_tr_b16 a[116:117], v193 offset:36864
    ds_read_b64_tr_b16 a[118:119], v193 offset:37376
    ds_read_b64_tr_b16 a[152:153], v142 offset:1568
    s_waitcnt lgkmcnt(9)
    v_mfma_f32_32x32x16_bf16 v[16:31], a[224:227], a[64:67], v[16:31]
    ds_read_b64_tr_b16 a[120:121], v192 offset:38912
    ds_read_b64_tr_b16 a[122:123], v192 offset:39424
    s_add_u32 m0, s57, 2048
    s_add_u32 s71, s66, 388864
    buffer_load_dwordx4 v2, s[8:11], s71 offen lds
    v_mfma_f32_32x32x16_bf16 v[32:47], a[228:231], a[64:67], v[32:47]
    ds_read_b64_tr_b16 a[124:125], v193 offset:38912
    ds_read_b64_tr_b16 a[126:127], v193 offset:39424
    s_waitcnt lgkmcnt(9)
    v_mfma_f32_32x32x16_bf16 v[16:31], a[232:235], a[68:71], v[16:31]
    ds_read_b64_tr_b16 a[128:129], v192 offset:40960
    ds_read_b64_tr_b16 a[130:131], v192 offset:41472
    v_mfma_f32_32x32x16_bf16 v[32:47], a[236:239], a[68:71], v[32:47]
    ds_read_b64_tr_b16 a[132:133], v193 offset:40960
    ds_read_b64_tr_b16 a[134:135], v193 offset:41472
    s_add_u32 m0, s57, 3072
    s_add_u32 s71, s66, 410368
    buffer_load_dwordx4 v2, s[8:11], s71 offen lds
    s_waitcnt lgkmcnt(9)
    v_mfma_f32_32x32x16_bf16 v[16:31], a[112:115], a[72:75], v[16:31]
    ds_read_b64_tr_b16 a[136:137], v192 offset:43008
    ds_read_b64_tr_b16 a[138:139], v192 offset:43520
    v_mfma_f32_32x32x16_bf16 v[32:47], a[116:119], a[72:75], v[32:47]
    ds_read_b64_tr_b16 a[140:141], v193 offset:43008
    ds_read_b64_tr_b16 a[142:143], v193 offset:43520
    ds_read_b64_tr_b16 a[154:155], v142 offset:2016
    s_waitcnt lgkmcnt(9)
    v_mfma_f32_32x32x16_bf16 v[16:31], a[120:123], a[76:79], v[16:31]
    ds_read_b64_tr_b16 a[224:225], v192 offset:45056
    ds_read_b64_tr_b16 a[226:227], v192 offset:45568
    v_mfma_f32_32x32x16_bf16 v[32:47], a[124:127], a[76:79], v[32:47]
    ds_read_b64_tr_b16 a[228:229], v193 offset:45056
    ds_read_b64_tr_b16 a[230:231], v193 offset:45568
    s_waitcnt lgkmcnt(9)
    v_mfma_f32_32x32x16_bf16 v[16:31], a[128:131], a[80:83], v[16:31]
    ds_read_b64_tr_b16 a[232:233], v192 offset:47104
    ds_read_b64_tr_b16 a[234:235], v192 offset:47616
    v_mfma_f32_32x32x16_bf16 v[32:47], a[132:135], a[80:83], v[32:47]
    ds_read_b64_tr_b16 a[236:237], v193 offset:47104
    ds_read_b64_tr_b16 a[238:239], v193 offset:47616
    ds_read_b64_tr_b16 a[156:157], v142 offset:2464
    s_waitcnt lgkmcnt(10)
    v_mfma_f32_32x32x16_bf16 v[16:31], a[136:139], a[84:87], v[16:31]
    s_waitcnt vmcnt(8)
    s_barrier
    ds_read_b64_tr_b16 a[112:113], v192 offset:49152
    ds_read_b64_tr_b16 a[114:115], v192 offset:49664
    s_add_u32 m0, s57, 16384
    s_add_u32 s71, s66, 689920
    buffer_load_dwordx4 v2, s[8:11], s71 offen lds
    v_mfma_f32_32x32x16_bf16 v[32:47], a[140:143], a[84:87], v[32:47]
    ds_read_b64_tr_b16 a[116:117], v193 offset:49152
    ds_read_b64_tr_b16 a[118:119], v193 offset:49664
    ds_read_b64_tr_b16 a[158:159], v142 offset:2912
    s_waitcnt lgkmcnt(10)
    v_mfma_f32_32x32x16_bf16 v[16:31], a[224:227], a[88:91], v[16:31]
    ds_read_b64_tr_b16 a[120:121], v192 offset:51200
    ds_read_b64_tr_b16 a[122:123], v192 offset:51712
    v_mfma_f32_32x32x16_bf16 v[32:47], a[228:231], a[88:91], v[32:47]
    ds_read_b64_tr_b16 a[124:125], v193 offset:51200
    ds_read_b64_tr_b16 a[126:127], v193 offset:51712
    s_add_u32 m0, s57, 17408
    s_add_u32 s71, s66, 711424
    buffer_load_dwordx4 v2, s[8:11], s71 offen lds
    s_waitcnt lgkmcnt(10)
    v_mfma_f32_32x32x16_bf16 v[16:31], a[232:235], a[92:95], v[16:31]
    ds_read_b64_tr_b16 a[128:129], v192 offset:53248
    ds_read_b64_tr_b16 a[130:131], v192 offset:53760
    v_mfma_f32_32x32x16_bf16 v[32:47], a[236:239], a[92:95], v[32:47]
    ds_read_b64_tr_b16 a[132:133], v193 offset:53248
    ds_read_b64_tr_b16 a[134:135], v193 offset:53760
    s_waitcnt lgkmcnt(9)
    v_mfma_f32_32x32x16_bf16 v[16:31], a[112:115], a[96:99], v[16:31]
    ds_read_b64_tr_b16 a[136:137], v192 offset:55296
    ds_read_b64_tr_b16 a[138:139], v192 offset:55808
    s_add_u32 m0, s57, 18432
    s_add_u32 s71, s66, 732928
    buffer_load_dwordx4 v2, s[8:11], s71 offen lds
    v_mfma_f32_32x32x16_bf16 v[32:47], a[116:119], a[96:99], v[32:47]
    ds_read_b64_tr_b16 a[140:141], v193 offset:55296
    ds_read_b64_tr_b16 a[142:143], v193 offset:55808
    ds_read_b32 v15, v15
    s_waitcnt lgkmcnt(9)
    v_mfma_f32_32x32x16_bf16 v[16:31], a[120:123], a[100:103], v[16:31]
    s_waitcnt vmcnt(7)
    s_barrier
    ds_read_b64_tr_b16 a[224:225], v196 offset:49152
    ds_read_b64_tr_b16 a[226:227], v196 offset:49664
    v_mfma_f32_32x32x16_bf16 v[32:47], a[124:127], a[100:103], v[32:47]
    ds_read_b64_tr_b16 a[228:229], v197 offset:49152
    ds_read_b64_tr_b16 a[230:231], v197 offset:49664
    s_add_u32 m0, s57, 19456
    s_add_u32 s71, s66, 754432
    buffer_load_dwordx4 v2, s[8:11], s71 offen lds
    s_waitcnt lgkmcnt(9)
    v_mfma_f32_32x32x16_bf16 v[16:31], a[128:131], a[104:107], v[16:31]
    ds_read_b64_tr_b16 a[232:233], v196 offset:51200
    ds_read_b64_tr_b16 a[234:235], v196 offset:51712
    v_mfma_f32_32x32x16_bf16 v[32:47], a[132:135], a[104:107], v[32:47]
    ds_read_b64_tr_b16 a[236:237], v197 offset:51200
    ds_read_b64_tr_b16 a[238:239], v197 offset:51712
    s_waitcnt lgkmcnt(9)
    v_mfma_f32_32x32x16_bf16 v[16:31], a[136:139], a[108:111], v[16:31]
    ds_read_b64_tr_b16 a[112:113], v196 offset:53248
    ds_read_b64_tr_b16 a[114:115], v196 offset:53760
    s_add_u32 m0, s56, 32768
    s_add_u32 s71, s67, 1033984
    buffer_load_dwordx4 v2, s[8:11], s71 offen lds
    v_mfma_f32_32x32x16_bf16 v[32:47], a[140:143], a[108:111], v[32:47]
    ds_read_b64_tr_b16 a[116:117], v197 offset:53248
    ds_read_b64_tr_b16 a[118:119], v197 offset:53760
    s_waitcnt lgkmcnt(12)
    v_mul_f32 v15, v15, v15
    s_waitcnt lgkmcnt(8)
    v_mfma_f32_32x32x16_bf16 v[48:63], a[224:227], a[0:3], 0
    ds_read_b64_tr_b16 a[120:121], v196 offset:55296
    ds_read_b64_tr_b16 a[122:123], v196 offset:55808
    v_mfma_f32_32x32x16_bf16 v[64:79], a[228:231], a[0:3], 0
    ds_read_b64_tr_b16 a[124:125], v197 offset:55296
    ds_read_b64_tr_b16 a[126:127], v197 offset:55808
    s_add_u32 m0, s56, 33792
    s_add_u32 s71, s67, 1055488
    buffer_load_dwordx4 v2, s[8:11], s71 offen lds
    v_cvt_pk_bf16_f32 v176, v16, v17
    v_cvt_pk_bf16_f32 v177, v18, v19
    v_cvt_pk_bf16_f32 v178, v20, v21
    v_cvt_pk_bf16_f32 v179, v22, v23
    s_waitcnt lgkmcnt(8)
    v_mfma_f32_32x32x16_bf16 v[48:63], a[232:235], a[4:7], v[48:63]
    ds_read_b64_tr_b16 a[128:129], v196 offset:57344
    ds_read_b64_tr_b16 a[130:131], v196 offset:57856
    v_cvt_pk_bf16_f32 v180, v24, v25
    v_cvt_pk_bf16_f32 v181, v26, v27
    v_cvt_pk_bf16_f32 v182, v28, v29
    v_cvt_pk_bf16_f32 v183, v30, v31
    v_cndmask_b32 v182, v182, 0, s[60:61]
    v_cndmask_b32 v183, v183, 0, s[60:61]
    v_mfma_f32_32x32x16_bf16 v[64:79], a[236:239], a[4:7], v[64:79]
    ds_read_b64_tr_b16 a[132:133], v197 offset:57344
    ds_read_b64_tr_b16 a[134:135], v197 offset:57856
    v_mfma_f32_32x32x16_bf16 v[80:95], a[144:147], v[176:179], 0
    v_mfma_f32_32x32x16_bf16 v[80:95], a[148:151], v[180:183], v[80:95]
    s_waitcnt lgkmcnt(8)
    v_mfma_f32_32x32x16_bf16 v[48:63], a[112:115], a[8:11], v[48:63]
    ds_read_b64_tr_b16 a[136:137], v196 offset:59392
    ds_read_b64_tr_b16 a[138:139], v196 offset:59904
    v_cvt_pk_bf16_f32 v184, v32, v33
    v_cvt_pk_bf16_f32 v185, v34, v35
    v_cvt_pk_bf16_f32 v186, v36, v37
    v_cvt_pk_bf16_f32 v187, v38, v39
    v_cvt_pk_bf16_f32 v188, v40, v41
    v_cvt_pk_bf16_f32 v189, v42, v43
    v_cvt_pk_bf16_f32 v190, v44, v45
    v_mfma_f32_32x32x16_bf16 v[64:79], a[116:119], a[8:11], v[64:79]
    ds_read_b64_tr_b16 a[140:141], v197 offset:59392
    ds_read_b64_tr_b16 a[142:143], v197 offset:59904
    v_cvt_pk_bf16_f32 v191, v46, v47
    v_cndmask_b32 v190, v190, 0, s[60:61]
    v_cndmask_b32 v191, v191, 0, s[60:61]
    v_mfma_f32_32x32x16_bf16 v[96:111], a[152:155], v[184:187], 0
    s_waitcnt lgkmcnt(8)
    v_mfma_f32_32x32x16_bf16 v[48:63], a[120:123], a[12:15], v[48:63]
    ds_read_b64_tr_b16 a[224:225], v196 offset:61440
    ds_read_b64_tr_b16 a[226:227], v196 offset:61952
    v_mfma_f32_32x32x16_bf16 v[96:111], a[156:159], v[188:191], v[96:111]
    v_mfma_f32_32x32x16_bf16 v[64:79], a[124:127], a[12:15], v[64:79]
    ds_read_b64_tr_b16 a[228:229], v197 offset:61440
    ds_read_b64_tr_b16 a[230:231], v197 offset:61952
    v_max3_f32 v160, v80, v81, v82
    v_min3_f32 v161, v80, v81, v82
    v_max3_f32 v160, v160, v83, v84
    v_min3_f32 v161, v161, v83, v84
    v_max3_f32 v160, v160, v85, v86
    v_min3_f32 v161, v161, v85, v86
    v_max3_f32 v160, v160, v87, v88
    v_min3_f32 v161, v161, v87, v88
    v_max3_f32 v160, v160, v89, v90
    v_min3_f32 v161, v161, v89, v90
    s_waitcnt lgkmcnt(8)
    v_mfma_f32_32x32x16_bf16 v[48:63], a[128:131], a[16:19], v[48:63]
    ds_read_b64_tr_b16 a[232:233], v196 offset:63488
    ds_read_b64_tr_b16 a[234:235], v196 offset:64000
    v_max3_f32 v160, v160, v91, v92
    v_min3_f32 v161, v161, v91, v92
    v_max3_f32 v160, v160, v93, v94
    v_min3_f32 v161, v161, v93, v94
    v_max_f32 v160, v160, v95
    v_min_f32 v161, v161, v95
    v_mov_b32 v162, v160
    v_mov_b32 v163, v161
    s_nop 0
    v_permlane32_swap_b32 v160, v162
    v_mfma_f32_32x32x16_bf16 v[64:79], a[132:135], a[16:19], v[64:79]
    ds_read_b64_tr_b16 a[236:237], v197 offset:63488
    ds_read_b64_tr_b16 a[238:239], v197 offset:64000
    v_permlane32_swap_b32 v161, v163
    v_max_f32 v160, v160, v162
    v_min_f32 v161, v161, v163
    v_mul_f32 v160, v160, v9
    v_mul_f32_e64 v161, v161, v9
    v_pk_fma_f32 v[144:145], v[80:81], v[8:9], v[160:161] op_sel:[0,1,0] op_sel_hi:[1,1,0] neg_lo:[0,0,1] neg_hi:[0,0,1]
    v_pk_fma_f32 v[80:81], v[80:81], v[8:9], v[160:161] op_sel:[0,0,1] op_sel_hi:[1,0,1]
    v_pk_fma_f32 v[146:147], v[82:83], v[8:9], v[160:161] op_sel:[0,1,0] op_sel_hi:[1,1,0] neg_lo:[0,0,1] neg_hi:[0,0,1]
    v_pk_fma_f32 v[82:83], v[82:83], v[8:9], v[160:161] op_sel:[0,0,1] op_sel_hi:[1,0,1]
    s_waitcnt lgkmcnt(8)
    v_mfma_f32_32x32x16_bf16 v[48:63], a[136:139], a[20:23], v[48:63]
    s_waitcnt vmcnt(6)
    s_barrier
    ds_read_b64_tr_b16 a[112:113], v192 offset:0
    ds_read_b64_tr_b16 a[114:115], v192 offset:512
    s_add_u32 m0, s57, 49152
    s_mov_b32 s71, s66
    buffer_load_dwordx4 v2, s[8:11], s71 offen lds
    v_pk_fma_f32 v[148:149], v[84:85], v[8:9], v[160:161] op_sel:[0,1,0] op_sel_hi:[1,1,0] neg_lo:[0,0,1] neg_hi:[0,0,1]
    v_pk_fma_f32 v[84:85], v[84:85], v[8:9], v[160:161] op_sel:[0,0,1] op_sel_hi:[1,0,1]
    v_mfma_f32_32x32x16_bf16 v[64:79], a[140:143], a[20:23], v[64:79]
    ds_read_b64_tr_b16 a[116:117], v193 offset:0
    ds_read_b64_tr_b16 a[118:119], v193 offset:512
    v_pk_fma_f32 v[150:151], v[86:87], v[8:9], v[160:161] op_sel:[0,1,0] op_sel_hi:[1,1,0] neg_lo:[0,0,1] neg_hi:[0,0,1]
    v_pk_fma_f32 v[86:87], v[86:87], v[8:9], v[160:161] op_sel:[0,0,1] op_sel_hi:[1,0,1]
    v_pk_fma_f32 v[152:153], v[88:89], v[8:9], v[160:161] op_sel:[0,1,0] op_sel_hi:[1,1,0] neg_lo:[0,0,1] neg_hi:[0,0,1]
    v_pk_fma_f32 v[88:89], v[88:89], v[8:9], v[160:161] op_sel:[0,0,1] op_sel_hi:[1,0,1]
    v_pk_fma_f32 v[154:155], v[90:91], v[8:9], v[160:161] op_sel:[0,1,0] op_sel_hi:[1,1,0] neg_lo:[0,0,1] neg_hi:[0,0,1]
    v_pk_fma_f32 v[90:91], v[90:91], v[8:9], v[160:161] op_sel:[0,0,1] op_sel_hi:[1,0,1]
    v_pk_fma_f32 v[156:157], v[92:93], v[8:9], v[160:161] op_sel:[0,1,0] op_sel_hi:[1,1,0] neg_lo:[0,0,1] neg_hi:[0,0,1]
    v_pk_fma_f32 v[92:93], v[92:93], v[8:9], v[160:161] op_sel:[0,0,1] op_sel_hi:[1,0,1]
    v_pk_fma_f32 v[158:159], v[94:95], v[8:9], v[160:161] op_sel:[0,1,0] op_sel_hi:[1,1,0] neg_lo:[0,0,1] neg_hi:[0,0,1]
    s_waitcnt lgkmcnt(8)
    v_mfma_f32_32x32x16_bf16 v[48:63], a[224:227], a[24:27], v[48:63]
    ds_read_b64_tr_b16 a[120:121], v192 offset:2048
    ds_read_b64_tr_b16 a[122:123], v192 offset:2560
    v_pk_fma_f32 v[94:95], v[94:95], v[8:9], v[160:161] op_sel:[0,0,1] op_sel_hi:[1,0,1]
    v_exp_f32 v144, v144
    v_exp_f32 v80, v80
    v_exp_f32 v145, v145
    v_exp_f32_e64 v81, v81
    v_mfma_f32_32x32x16_bf16 v[64:79], a[228:231], a[24:27], v[64:79]
    ds_read_b64_tr_b16 a[124:125], v193 offset:2048
    ds_read_b64_tr_b16 a[126:127], v193 offset:2560
    s_add_u32 m0, s57, 50176
    s_add_u32 s71, s66, 21504
    buffer_load_dwordx4 v2, s[8:11], s71 offen lds
    v_exp_f32_e64 v146, v146
    v_exp_f32 v82, v82
    s_waitcnt lgkmcnt(8)
    v_mfma_f32_32x32x16_bf16 v[48:63], a[232:235], a[28:31], v[48:63]
    ds_read_b64_tr_b16 a[128:129], v192 offset:4096
    ds_read_b64_tr_b16 a[130:131], v192 offset:4608
    v_exp_f32 v147, v147
    v_exp_f32 v83, v83
    v_exp_f32 v148, v148
    v_exp_f32 v84, v84
    v_mfma_f32_32x32x16_bf16 v[64:79], a[236:239], a[28:31], v[64:79]
    ds_read_b64_tr_b16 a[132:133], v193 offset:4096
    ds_read_b64_tr_b16 a[134:135], v193 offset:4608
    v_exp_f32 v149, v149
    v_exp_f32 v85, v85
    v_exp_f32 v150, v150
    v_exp_f32 v86, v86
    v_exp_f32 v151, v151
    s_waitcnt lgkmcnt(8)
    v_mfma_f32_32x32x16_bf16 v[48:63], a[112:115], a[32:35], v[48:63]
    ds_read_b64_tr_b16 a[136:137], v192 offset:6144
    ds_read_b64_tr_b16 a[138:139], v192 offset:6656
    s_add_u32 m0, s57, 51200
    s_add_u32 s71, s66, 43008
    buffer_load_dwordx4 v2, s[8:11], s71 offen lds
    v_exp_f32 v87, v87
    v_exp_f32 v152, v152
    v_mfma_f32_32x32x16_bf16 v[64:79], a[116:119], a[32:35], v[64:79]
    ds_read_b64_tr_b16 a[140:141], v193 offset:6144
    ds_read_b64_tr_b16 a[142:143], v193 offset:6656
    v_exp_f32 v88, v88
    v_exp_f32 v153, v153
    v_exp_f32 v89, v89
    v_exp_f32 v154, v154
    v_exp_f32 v90, v90
    s_waitcnt lgkmcnt(8)
    v_mfma_f32_32x32x16_bf16 v[48:63], a[120:123], a[36:39], v[48:63]
    ds_read_b64_tr_b16 a[224:225], v192 offset:8192
    ds_read_b64_tr_b16 a[226:227], v192 offset:8704
    v_exp_f32 v155, v155
    v_exp_f32 v91, v91
    v_exp_f32 v156, v156
    v_exp_f32 v92, v92
    v_mfma_f32_32x32x16_bf16 v[64:79], a[124:127], a[36:39], v[64:79]
    ds_read_b64_tr_b16 a[228:229], v193 offset:8192
    ds_read_b64_tr_b16 a[230:231], v193 offset:8704
    s_add_u32 m0, s57, 52224
    s_add_u32 s71, s66, 64512
    buffer_load_dwordx4 v2, s[8:11], s71 offen lds
    v_exp_f32 v157, v157
    v_exp_f32 v93, v93
    s_waitcnt lgkmcnt(8)
    v_mfma_f32_32x32x16_bf16 v[48:63], a[128:131], a[40:43], v[48:63]
    ds_read_b64_tr_b16 a[232:233], v192 offset:10240
    ds_read_b64_tr_b16 a[234:235], v192 offset:10752
    v_exp_f32 v158, v158
    v_exp_f32 v94, v94
    v_exp_f32 v159, v159
    v_exp_f32 v95, v95
    v_add_f32 v164, v144, v145
    v_mfma_f32_32x32x16_bf16 v[64:79], a[132:135], a[40:43], v[64:79]
    ds_read_b64_tr_b16 a[236:237], v193 offset:10240
    ds_read_b64_tr_b16 a[238:239], v193 offset:10752
    v_add_f32 v165, v80, v81
    v_add_f32 v166, v156, v157
    v_add_f32 v167, v92, v93
    v_add_f32 v164, v164, v146
    v_add_f32 v165, v165, v82
    v_add_f32 v166, v166, v158
    v_add_f32 v167, v167, v94
    v_add_f32 v164, v164, v147
    v_add_f32 v165, v165, v83
    v_add_f32 v166, v166, v159
    s_waitcnt lgkmcnt(8)
    v_mfma_f32_32x32x16_bf16 v[48:63], a[136:139], a[44:47], v[48:63]
    ds_read_b64_tr_b16 a[112:113], v192 offset:12288
    ds_read_b64_tr_b16 a[114:115], v192 offset:12800
    v_add_f32 v167, v167, v95
    v_add_f32 v164, v164, v148
    v_add_f32 v165, v165, v84
    v_add_f32 v164, v164, v149
    v_add_f32 v165, v165, v85
    v_add_f32 v164, v164, v150
    v_add_f32 v165, v165, v86
    v_add_f32 v164, v164, v151
    v_add_f32 v165, v165, v87
    v_mfma_f32_32x32x16_bf16 v[64:79], a[140:143], a[44:47], v[64:79]
    ds_read_b64_tr_b16 a[116:117], v193 offset:12288
    ds_read_b64_tr_b16 a[118:119], v193 offset:12800
    v_add_f32 v164, v164, v152
    v_add_f32 v165, v165, v88
    v_add_f32 v164, v164, v153
    v_add_f32 v165, v165, v89
    v_add_f32 v164, v164, v154
    v_add_f32 v165, v165, v90
    v_add_f32_e64 v164, v164, v155
    v_add_f32 v165, v165, v91
    v_fma_f32 v164, v166, v10, v164
    s_waitcnt lgkmcnt(8)
    v_mfma_f32_32x32x16_bf16 v[48:63], a[224:227], a[48:51], v[48:63]
    ds_read_b64_tr_b16 a[120:121], v192 offset:14336
    ds_read_b64_tr_b16 a[122:123], v192 offset:14848
    v_fma_f32 v165, v167, v10, v165
    v_mov_b32 v162, v164
    v_mov_b32 v163, v165
    s_nop 0
    v_permlane32_swap_b32 v164, v162
    v_permlane32_swap_b32 v165, v163
    v_add_f32 v164, v164, v162
    v_add_f32 v165, v165, v163
    v_rcp_f32 v165, v165
    v_mfma_f32_32x32x16_bf16 v[64:79], a[228:231], a[48:51], v[64:79]
    ds_read_b64_tr_b16 a[124:125], v193 offset:14336
    ds_read_b64_tr_b16 a[126:127], v193 offset:14848
    v_rcp_f32 v166, v164
    v_mul_f32 v165, v165, v164
    v_mul_f32 v232, v166, v7
    v_cvt_pk_bf16_f32 v234, v166, 0
    v_pk_mul_f32 v[80:81], v[80:81], v[164:165] op_sel:[0,1] op_sel_hi:[1,1]
    v_pk_mul_f32 v[82:83], v[82:83], v[164:165] op_sel:[0,1] op_sel_hi:[1,1]
    v_pk_mul_f32 v[84:85], v[84:85], v[164:165] op_sel:[0,1] op_sel_hi:[1,1]
    v_pk_mul_f32 v[86:87], v[86:87], v[164:165] op_sel:[0,1] op_sel_hi:[1,1]
    s_waitcnt lgkmcnt(8)
    v_mfma_f32_32x32x16_bf16 v[48:63], a[232:235], a[52:55], v[48:63]
    s_waitcnt vmcnt(6)
    s_barrier
    ds_read_b64_tr_b16 a[128:129], v192 offset:16384
    ds_read_b64_tr_b16 a[130:131], v192 offset:16896
    s_add_u32 m0, s57, 65536
    s_add_u32 s71, s66, 344064
    buffer_load_dwordx4 v2, s[8:11], s71 offen lds
    v_pk_mul_f32 v[88:89], v[88:89], v[164:165] op_sel:[0,1] op_sel_hi:[1,1]
    v_pk_mul_f32 v[90:91], v[90:91], v[164:165] op_sel:[0,1] op_sel_hi:[1,1]
    v_mfma_f32_32x32x16_bf16 v[64:79], a[236:239], a[52:55], v[64:79]
    ds_read_b64_tr_b16 a[132:133], v193 offset:16384
    ds_read_b64_tr_b16 a[134:135], v193 offset:16896
    v_pk_mul_f32 v[92:93], v[92:93], v[164:165] op_sel:[0,1] op_sel_hi:[1,1]
    v_pk_mul_f32 v[94:95], v[94:95], v[164:165] op_sel:[0,1] op_sel_hi:[1,1]
    v_cvt_pk_bf16_f32 v144, v144, v145
    v_cvt_pk_bf16_f32 v80, v80, v81
    v_cvt_pk_bf16_f32 v145, v146, v147
    v_cvt_pk_bf16_f32 v81, v82, v83
    v_cvt_pk_bf16_f32 v146, v148, v149
    v_cvt_pk_bf16_f32 v82, v84, v85
    v_cvt_pk_bf16_f32 v147, v150, v151
    s_waitcnt lgkmcnt(8)
    v_mfma_f32_32x32x16_bf16 v[48:63], a[112:115], a[56:59], v[48:63]
    ds_read_b64_tr_b16 a[136:137], v192 offset:18432
    ds_read_b64_tr_b16 a[138:139], v192 offset:18944
    v_cvt_pk_bf16_f32 v83, v86, v87
    v_cvt_pk_bf16_f32 v148, v152, v153
    v_cvt_pk_bf16_f32 v84, v88, v89
    v_cvt_pk_bf16_f32 v149, v154, v155
    v_cvt_pk_bf16_f32 v85, v90, v91
    v_cvt_pk_bf16_f32 v150, v156, v157
    v_cvt_pk_bf16_f32 v86, v92, v93
    v_cvt_pk_bf16_f32 v151, v158, v159
    v_cvt_pk_bf16_f32 v87, v94, v95
    v_mfma_f32_32x32x16_bf16 v[64:79], a[116:119], a[56:59], v[64:79]
    ds_read_b64_tr_b16 a[140:141], v193 offset:18432
    ds_read_b64_tr_b16 a[142:143], v193 offset:18944
    s_add_u32 m0, s57, 66560
    s_add_u32 s71, s66, 365568
    buffer_load_dwordx4 v2, s[8:11], s71 offen lds
    ds_write_b64 v208, v[144:145] offset:0
    ds_write_b64 v212, v[80:81] offset:0
    ds_write_b64 v209, v[146:147] offset:0
    s_waitcnt lgkmcnt(11)
    v_mfma_f32_32x32x16_bf16 v[48:63], a[120:123], a[60:63], v[48:63]
    ds_read_b64_tr_b16 a[224:225], v192 offset:20480
    ds_read_b64_tr_b16 a[226:227], v192 offset:20992
    ds_write_b64 v213, v[82:83] offset:0
    ds_write_b64 v210, v[148:149] offset:0
    ds_write_b64 v214, v[84:85] offset:0
    ds_write_b64 v211, v[150:151] offset:0
    ds_write_b64 v215, v[86:87] offset:0
    v_max3_f32 v160, v96, v97, v98
    v_min3_f32 v161, v96, v97, v98
    v_mfma_f32_32x32x16_bf16 v[64:79], a[124:127], a[60:63], v[64:79]
    ds_read_b64_tr_b16 a[228:229], v193 offset:20480
    ds_read_b64_tr_b16 a[230:231], v193 offset:20992
    v_max3_f32 v160, v160, v99, v100
    v_min3_f32 v161, v161, v99, v100
    v_max3_f32 v160, v160, v101, v102
    v_min3_f32 v161, v161, v101, v102
    v_max3_f32 v160, v160, v103, v104
    v_min3_f32 v161, v161, v103, v104
    v_max3_f32 v160, v160, v105, v106
    v_min3_f32 v161, v161, v105, v106
    v_max3_f32 v160, v160, v107, v108
    v_min3_f32 v161, v161, v107, v108
    s_waitcnt lgkmcnt(15)
    v_mfma_f32_32x32x16_bf16 v[48:63], a[128:131], a[64:67], v[48:63]
    ds_read_b64_tr_b16 a[232:233], v192 offset:22528
    ds_read_b64_tr_b16 a[234:235], v192 offset:23040
    s_add_u32 m0, s57, 67584
    s_add_u32 s71, s66, 387072
    buffer_load_dwordx4 v2, s[8:11], s71 offen lds
    v_max3_f32 v160, v160, v109, v110
    v_min3_f32 v161, v161, v109, v110
    v_max_f32 v160, v160, v111
    v_mfma_f32_32x32x16_bf16 v[64:79], a[132:135], a[64:67], v[64:79]
    ds_read_b64_tr_b16 a[236:237], v193 offset:22528
    ds_read_b64_tr_b16 a[238:239], v193 offset:23040
    v_min_f32 v161, v161, v111
    v_mov_b32 v162, v160
    v_mov_b32 v163, v161
    s_nop 0
    v_permlane32_swap_b32 v160, v162
    v_permlane32_swap_b32 v161, v163
    v_max_f32 v160, v160, v162
    v_min_f32 v161, v161, v163
    v_mul_f32_e64 v160, v160, v9
    v_mul_f32 v161, v161, v9
    v_pk_fma_f32 v[144:145], v[96:97], v[8:9], v[160:161] op_sel:[0,1,0] op_sel_hi:[1,1,0] neg_lo:[0,0,1] neg_hi:[0,0,1]
    s_waitcnt lgkmcnt(15)
    v_mfma_f32_32x32x16_bf16 v[48:63], a[136:139], a[68:71], v[48:63]
    ds_read_b64_tr_b16 a[112:113], v192 offset:24576
    ds_read_b64_tr_b16 a[114:115], v192 offset:25088
    v_pk_fma_f32 v[96:97], v[96:97], v[8:9], v[160:161] op_sel:[0,0,1] op_sel_hi:[1,0,1]
    v_pk_fma_f32 v[146:147], v[98:99], v[8:9], v[160:161] op_sel:[0,1,0] op_sel_hi:[1,1,0] neg_lo:[0,0,1] neg_hi:[0,0,1]
    v_pk_fma_f32 v[98:99], v[98:99], v[8:9], v[160:161] op_sel:[0,0,1] op_sel_hi:[1,0,1]
    v_pk_fma_f32 v[148:149], v[100:101], v[8:9], v[160:161] op_sel:[0,1,0] op_sel_hi:[1,1,0] neg_lo:[0,0,1] neg_hi:[0,0,1]
    v_pk_fma_f32 v[100:101], v[100:101], v[8:9], v[160:161] op_sel:[0,0,1] op_sel_hi:[1,0,1]
    v_pk_fma_f32 v[150:151], v[102:103], v[8:9], v[160:161] op_sel:[0,1,0] op_sel_hi:[1,1,0] neg_lo:[0,0,1] neg_hi:[0,0,1]
    v_pk_fma_f32 v[102:103], v[102:103], v[8:9], v[160:161] op_sel:[0,0,1] op_sel_hi:[1,0,1]
    v_pk_fma_f32 v[152:153], v[104:105], v[8:9], v[160:161] op_sel:[0,1,0] op_sel_hi:[1,1,0] neg_lo:[0,0,1] neg_hi:[0,0,1]
    v_pk_fma_f32 v[104:105], v[104:105], v[8:9], v[160:161] op_sel:[0,0,1] op_sel_hi:[1,0,1]
    v_mfma_f32_32x32x16_bf16 v[64:79], a[140:143], a[68:71], v[64:79]
    ds_read_b64_tr_b16 a[116:117], v193 offset:24576
    ds_read_b64_tr_b16 a[118:119], v193 offset:25088
    s_add_u32 m0, s57, 68608
    s_add_u32 s71, s66, 408576
    buffer_load_dwordx4 v2, s[8:11], s71 offen lds
    v_pk_fma_f32 v[154:155], v[106:107], v[8:9], v[160:161] op_sel:[0,1,0] op_sel_hi:[1,1,0] neg_lo:[0,0,1] neg_hi:[0,0,1]
    v_pk_fma_f32 v[106:107], v[106:107], v[8:9], v[160:161] op_sel:[0,0,1] op_sel_hi:[1,0,1]
    v_pk_fma_f32 v[156:157], v[108:109], v[8:9], v[160:161] op_sel:[0,1,0] op_sel_hi:[1,1,0] neg_lo:[0,0,1] neg_hi:[0,0,1]
    v_pk_fma_f32 v[108:109], v[108:109], v[8:9], v[160:161] op_sel:[0,0,1] op_sel_hi:[1,0,1]
    s_waitcnt lgkmcnt(8)
    v_mfma_f32_32x32x16_bf16 v[48:63], a[224:227], a[72:75], v[48:63]
    ds_read_b64_tr_b16 a[120:121], v192 offset:26624
    ds_read_b64_tr_b16 a[122:123], v192 offset:27136
    v_pk_fma_f32 v[158:159], v[110:111], v[8:9], v[160:161] op_sel:[0,1,0] op_sel_hi:[1,1,0] neg_lo:[0,0,1] neg_hi:[0,0,1]
    v_pk_fma_f32 v[110:111], v[110:111], v[8:9], v[160:161] op_sel:[0,0,1] op_sel_hi:[1,0,1]
    v_exp_f32 v144, v144
    v_exp_f32 v96, v96
    v_exp_f32 v145, v145
    v_mfma_f32_32x32x16_bf16 v[64:79], a[228:231], a[72:75], v[64:79]
    ds_read_b64_tr_b16 a[124:125], v193 offset:26624
    ds_read_b64_tr_b16 a[126:127], v193 offset:27136
    v_exp_f32 v97, v97
    v_exp_f32 v146, v146
    v_exp_f32 v98, v98
    v_exp_f32 v147, v147
    v_exp_f32 v99, v99
    s_waitcnt lgkmcnt(8)
    v_mfma_f32_32x32x16_bf16 v[48:63], a[232:235], a[76:79], v[48:63]
    ds_read_b64_tr_b16 a[128:129], v192 offset:28672
    ds_read_b64_tr_b16 a[130:131], v192 offset:29184
    v_exp_f32 v148, v148
    v_exp_f32 v100, v100
    v_exp_f32 v149, v149
    v_exp_f32 v101, v101
    v_mfma_f32_32x32x16_bf16 v[64:79], a[236:239], a[76:79], v[64:79]
    ds_read_b64_tr_b16 a[132:133], v193 offset:28672
    ds_read_b64_tr_b16 a[134:135], v193 offset:29184
    v_exp_f32 v150, v150
    v_exp_f32 v102, v102
    v_exp_f32 v151, v151
    v_exp_f32 v103, v103
    v_exp_f32 v152, v152
    s_waitcnt lgkmcnt(8)
    v_mfma_f32_32x32x16_bf16 v[48:63], a[112:115], a[80:83], v[48:63]
    ds_read_b64_tr_b16 a[136:137], v192 offset:30720
    ds_read_b64_tr_b16 a[138:139], v192 offset:31232
    v_exp_f32 v104, v104
    v_exp_f32 v153, v153
    v_exp_f32 v105, v105
    v_exp_f32 v154, v154
    v_exp_f32 v106, v106
    v_mfma_f32_32x32x16_bf16 v[64:79], a[116:119], a[80:83], v[64:79]
    ds_read_b64_tr_b16 a[140:141], v193 offset:30720
    ds_read_b64_tr_b16 a[142:143], v193 offset:31232
    v_exp_f32 v155, v155
    v_exp_f32 v107, v107
    v_exp_f32 v156, v156
    v_exp_f32 v108, v108
    s_waitcnt lgkmcnt(8)
    v_mfma_f32_32x32x16_bf16 v[48:63], a[120:123], a[84:87], v[48:63]
    s_waitcnt vmcnt(8)
    s_barrier
    ds_read_b64_tr_b16 a[224:225], v192 offset:32768
    ds_read_b64_tr_b16 a[226:227], v192 offset:33280
    s_add_u32 m0, s57, 0
    s_add_u32 s71, s66, 688128
    buffer_load_dwordx4 v2, s[8:11], s71 offen lds
    v_exp_f32 v157, v157
    v_mfma_f32_32x32x16_bf16 v[64:79], a[124:127], a[84:87], v[64:79]
    ds_read_b64_tr_b16 a[228:229], v193 offset:32768
    ds_read_b64_tr_b16 a[230:231], v193 offset:33280
    v_exp_f32 v109, v109
    v_exp_f32 v158, v158
    v_exp_f32 v110, v110
    v_exp_f32 v159, v159
    v_exp_f32 v111, v111
    s_waitcnt lgkmcnt(8)
    v_mfma_f32_32x32x16_bf16 v[48:63], a[128:131], a[88:91], v[48:63]
    ds_read_b64_tr_b16 a[232:233], v192 offset:34816
    ds_read_b64_tr_b16 a[234:235], v192 offset:35328
    v_add_f32 v164, v144, v145
    v_add_f32 v165, v96, v97
    v_add_f32 v166, v156, v157
    v_add_f32 v167, v108, v109
    v_add_f32 v164, v164, v146
    v_add_f32 v165, v165, v98
    v_add_f32 v166, v166, v158
    v_add_f32 v167, v167, v110
    v_mfma_f32_32x32x16_bf16 v[64:79], a[132:135], a[88:91], v[64:79]
    ds_read_b64_tr_b16 a[236:237], v193 offset:34816
    ds_read_b64_tr_b16 a[238:239], v193 offset:35328
    s_add_u32 m0, s57, 1024
    s_add_u32 s71, s66, 709632
    buffer_load_dwordx4 v2, s[8:11], s71 offen lds
    v_add_f32 v164, v164, v147
    v_add_f32 v165, v165, v99
    v_add_f32 v166, v166, v159
    v_add_f32 v167, v167, v111
    v_add_f32 v164, v164, v148
    s_waitcnt lgkmcnt(8)
    v_mfma_f32_32x32x16_bf16 v[48:63], a[136:139], a[92:95], v[48:63]
    ds_read_b64_tr_b16 a[112:113], v192 offset:36864
    ds_read_b64_tr_b16 a[114:115], v192 offset:37376
    v_add_f32 v165, v165, v100
    v_add_f32 v164, v164, v149
    v_add_f32 v165, v165, v101
    v_add_f32 v164, v164, v150
    v_add_f32 v165, v165, v102
    v_add_f32 v164, v164, v151
    v_add_f32 v165, v165, v103
    v_add_f32 v164, v164, v152
    v_mfma_f32_32x32x16_bf16 v[64:79], a[140:143], a[92:95], v[64:79]
    ds_read_b64_tr_b16 a[116:117], v193 offset:36864
    ds_read_b64_tr_b16 a[118:119], v193 offset:37376
    v_add_f32 v165, v165, v104
    v_add_f32 v164, v164, v153
    v_add_f32 v165, v165, v105
    v_add_f32 v164, v164, v154
    v_add_f32 v165, v165, v106
    v_add_f32 v164, v164, v155
    v_add_f32_e64 v165, v165, v107
    v_fma_f32 v164, v166, v10, v164
    v_fma_f32 v165, v167, v10, v165
    v_mov_b32 v162, v164
    s_waitcnt lgkmcnt(8)
    v_mfma_f32_32x32x16_bf16 v[48:63], a[224:227], a[96:99], v[48:63]
    ds_read_b64_tr_b16 a[120:121], v192 offset:38912
    ds_read_b64_tr_b16 a[122:123], v192 offset:39424
    s_add_u32 m0, s57, 2048
    s_add_u32 s71, s66, 731136
    buffer_load_dwordx4 v2, s[8:11], s71 offen lds
    v_mov_b32 v163, v165
    v_permlane32_swap_b32 v164, v162
    s_nop 0
    v_permlane32_swap_b32 v165, v163
    v_mfma_f32_32x32x16_bf16 v[64:79], a[228:231], a[96:99], v[64:79]
    ds_read_b64_tr_b16 a[124:125], v193 offset:38912
    ds_read_b64_tr_b16 a[126:127], v193 offset:39424
    v_add_f32 v164, v164, v162
    v_add_f32 v165, v165, v163
    v_rcp_f32 v165, v165
    v_rcp_f32 v166, v164
    v_mul_f32_e64 v165, v165, v164
    v_mul_f32 v233, v166, v7
    v_cvt_pk_bf16_f32 v235, v166, 0
    v_pk_mul_f32 v[96:97], v[96:97], v[164:165] op_sel:[0,1] op_sel_hi:[1,1]
    s_waitcnt lgkmcnt(8)
    v_mfma_f32_32x32x16_bf16 v[48:63], a[232:235], a[100:103], v[48:63]
    s_waitcnt vmcnt(7)
    s_barrier
    ds_read_b64_tr_b16 a[128:129], v192 offset:49152
    ds_read_b64_tr_b16 a[130:131], v192 offset:49664
    v_pk_mul_f32 v[98:99], v[98:99], v[164:165] op_sel:[0,1] op_sel_hi:[1,1]
    v_pk_mul_f32 v[100:101], v[100:101], v[164:165] op_sel:[0,1] op_sel_hi:[1,1]
    v_pk_mul_f32 v[102:103], v[102:103], v[164:165] op_sel:[0,1] op_sel_hi:[1,1]
    v_pk_mul_f32 v[104:105], v[104:105], v[164:165] op_sel:[0,1] op_sel_hi:[1,1]
    v_pk_mul_f32 v[106:107], v[106:107], v[164:165] op_sel:[0,1] op_sel_hi:[1,1]
    v_pk_mul_f32 v[108:109], v[108:109], v[164:165] op_sel:[0,1] op_sel_hi:[1,1]
    v_mfma_f32_32x32x16_bf16 v[64:79], a[236:239], a[100:103], v[64:79]
    ds_read_b64_tr_b16 a[132:133], v193 offset:49152
    ds_read_b64_tr_b16 a[134:135], v193 offset:49664
    s_add_u32 m0, s57, 3072
    s_add_u32 s71, s66, 752640
    buffer_load_dwordx4 v2, s[8:11], s71 offen lds
    v_pk_mul_f32 v[110:111], v[110:111], v[164:165] op_sel:[0,1] op_sel_hi:[1,1]
    v_cvt_pk_bf16_f32 v144, v144, v145
    v_cvt_pk_bf16_f32 v96, v96, v97
    v_cvt_pk_bf16_f32 v145, v146, v147
    v_cvt_pk_bf16_f32 v97, v98, v99
    s_waitcnt lgkmcnt(8)
    v_mfma_f32_32x32x16_bf16 v[48:63], a[112:115], a[104:107], v[48:63]
    ds_read_b64_tr_b16 a[136:137], v192 offset:51200
    ds_read_b64_tr_b16 a[138:139], v192 offset:51712
    v_cvt_pk_bf16_f32 v146, v148, v149
    v_cvt_pk_bf16_f32 v98, v100, v101
    v_cvt_pk_bf16_f32 v147, v150, v151
    v_cvt_pk_bf16_f32 v99, v102, v103
    v_cvt_pk_bf16_f32 v148, v152, v153
    v_cvt_pk_bf16_f32 v100, v104, v105
    v_cvt_pk_bf16_f32 v149, v154, v155
    v_cvt_pk_bf16_f32 v101, v106, v107
    v_cvt_pk_bf16_f32 v150, v156, v157
    v_mfma_f32_32x32x16_bf16 v[64:79], a[116:119], a[104:107], v[64:79]
    ds_read_b64_tr_b16 a[140:141], v193 offset:51200
    ds_read_b64_tr_b16 a[142:143], v193 offset:51712
    v_cvt_pk_bf16_f32 v102, v108, v109
    v_cvt_pk_bf16_f32 v151, v158, v159
    v_cvt_pk_bf16_f32 v103, v110, v111
    ds_write_b64 v208, v[144:145] offset:16384
    ds_write_b64 v212, v[96:97] offset:16384
    ds_write_b64 v209, v[146:147] offset:16384
    ds_write_b64 v213, v[98:99] offset:16384
    s_waitcnt lgkmcnt(12)
    v_mfma_f32_32x32x16_bf16 v[48:63], a[120:123], a[108:111], v[48:63]
    ds_read_b64_tr_b16 a[224:225], v192 offset:53248
    ds_read_b64_tr_b16 a[226:227], v192 offset:53760
    s_add_u32 m0, s56, 16384
    s_add_u32 s71, s67, 1032192
    buffer_load_dwordx4 v2, s[8:11], s71 offen lds
    ds_write_b64 v210, v[148:149] offset:16384
    ds_write_b64 v214, v[100:101] offset:16384
    ds_write_b64 v211, v[150:151] offset:16384
    v_mfma_f32_32x32x16_bf16 v[64:79], a[124:127], a[108:111], v[64:79]
    ds_read_b64_tr_b16 a[228:229], v193 offset:53248
    ds_read_b64_tr_b16 a[230:231], v193 offset:53760
    ds_write_b64 v215, v[102:103] offset:16384
    buffer_load_dword v14, off, s[36:39], s86 sc1
    buffer_load_dword v13, off, s[36:39], s87 sc1
    s_waitcnt lgkmcnt(15)
    v_mfma_f32_32x32x16_bf16 v[16:31], a[128:131], a[0:3], 0
    ds_read_b64_tr_b16 a[232:233], v192 offset:55296
    ds_read_b64_tr_b16 a[234:235], v192 offset:55808
    v_pk_mul_f32 v[48:49], v[48:49], v[232:233] op_sel:[0,0] op_sel_hi:[1,0]
    v_pk_mul_f32 v[50:51], v[50:51], v[232:233] op_sel:[0,0] op_sel_hi:[1,0]
    v_pk_mul_f32 v[52:53], v[52:53], v[232:233] op_sel:[0,0] op_sel_hi:[1,0]
    v_pk_mul_f32 v[54:55], v[54:55], v[232:233] op_sel:[0,0] op_sel_hi:[1,0]
    v_pk_mul_f32 v[56:57], v[56:57], v[232:233] op_sel:[0,0] op_sel_hi:[1,0]
    v_mfma_f32_32x32x16_bf16 v[32:47], a[132:135], a[0:3], 0
    ds_read_b64_tr_b16 a[236:237], v193 offset:55296
    ds_read_b64_tr_b16 a[238:239], v193 offset:55808
    s_add_u32 m0, s56, 17408
    s_add_u32 s71, s67, 1053696
    buffer_load_dwordx4 v2, s[8:11], s71 offen lds
    v_pk_mul_f32 v[58:59], v[58:59], v[232:233] op_sel:[0,0] op_sel_hi:[1,0]
    v_pk_mul_f32 v[60:61], v[60:61], v[232:233] op_sel:[0,0] op_sel_hi:[1,0]
    s_waitcnt lgkmcnt(15)
    v_mfma_f32_32x32x16_bf16 v[16:31], a[136:139], a[4:7], v[16:31]
    ds_read_b64_tr_b16 a[112:113], v192 offset:57344
    ds_read_b64_tr_b16 a[114:115], v192 offset:57856
    v_pk_mul_f32 v[62:63], v[62:63], v[232:233] op_sel:[0,0] op_sel_hi:[1,0]
    v_cvt_pk_bf16_f32 v48, v48, v49
    v_cvt_pk_bf16_f32 v49, v50, v51
    v_cvt_pk_bf16_f32 v50, v52, v53
    v_cvt_pk_bf16_f32 v51, v54, v55
    v_mfma_f32_32x32x16_bf16 v[32:47], a[140:143], a[4:7], v[32:47]
    ds_read_b64_tr_b16 a[116:117], v193 offset:57344
    ds_read_b64_tr_b16 a[118:119], v193 offset:57856
    v_cvt_pk_bf16_f32 v52, v56, v57
    v_cvt_pk_bf16_f32 v53, v58, v59
    v_cvt_pk_bf16_f32 v54, v60, v61
    v_cvt_pk_bf16_f32 v55, v62, v63
    v_cndmask_b32 v54, v54, v234, s[60:61]
    v_cndmask_b32 v55, v55, 0, s[60:61]
    s_waitcnt lgkmcnt(9)
    v_mfma_f32_32x32x16_bf16 v[16:31], a[224:227], a[8:11], v[16:31]
    ds_read_b64_tr_b16 a[120:121], v192 offset:59392
    ds_read_b64_tr_b16 a[122:123], v192 offset:59904
    ds_write_b64 v208, v[48:49] offset:32768
    ds_write_b64 v209, v[50:51] offset:32768
    ds_write_b64 v210, v[52:53] offset:32768
    ds_write_b64 v211, v[54:55] offset:32768
    v_mfma_f32_32x32x16_bf16 v[32:47], a[228:231], a[8:11], v[32:47]
    ds_read_b64_tr_b16 a[124:125], v193 offset:59392
    ds_read_b64_tr_b16 a[126:127], v193 offset:59904
    v_pk_mul_f32 v[64:65], v[64:65], v[232:233] op_sel:[0,1] op_sel_hi:[1,1]
    v_pk_mul_f32 v[66:67], v[66:67], v[232:233] op_sel:[0,1] op_sel_hi:[1,1]
    v_pk_mul_f32 v[68:69], v[68:69], v[232:233] op_sel:[0,1] op_sel_hi:[1,1]
    v_pk_mul_f32 v[70:71], v[70:71], v[232:233] op_sel:[0,1] op_sel_hi:[1,1]
    v_pk_mul_f32 v[72:73], v[72:73], v[232:233] op_sel:[0,1] op_sel_hi:[1,1]
    v_pk_mul_f32 v[74:75], v[74:75], v[232:233] op_sel:[0,1] op_sel_hi:[1,1]
    s_waitcnt lgkmcnt(12)
    v_mfma_f32_32x32x16_bf16 v[16:31], a[232:235], a[12:15], v[16:31]
    ds_read_b64_tr_b16 a[128:129], v192 offset:61440
    ds_read_b64_tr_b16 a[130:131], v192 offset:61952
    v_pk_mul_f32 v[76:77], v[76:77], v[232:233] op_sel:[0,1] op_sel_hi:[1,1]
    v_pk_mul_f32 v[78:79], v[78:79], v[232:233] op_sel:[0,1] op_sel_hi:[1,1]
    v_cvt_pk_bf16_f32 v64, v64, v65
    v_cvt_pk_bf16_f32 v65, v66, v67
    v_cvt_pk_bf16_f32 v66, v68, v69
    v_cvt_pk_bf16_f32 v67, v70, v71
    v_mfma_f32_32x32x16_bf16 v[32:47], a[236:239], a[12:15], v[32:47]
    ds_read_b64_tr_b16 a[132:133], v193 offset:61440
    ds_read_b64_tr_b16 a[134:135], v193 offset:61952
    v_cvt_pk_bf16_f32 v68, v72, v73
    v_cvt_pk_bf16_f32 v69, v74, v75
    v_cvt_pk_bf16_f32 v70, v76, v77
    v_cvt_pk_bf16_f32 v71, v78, v79
    v_cndmask_b32 v70, v70, v235, s[60:61]
    v_cndmask_b32 v71, v71, 0, s[60:61]
    s_waitcnt lgkmcnt(12)
    v_mfma_f32_32x32x16_bf16 v[16:31], a[112:115], a[16:19], v[16:31]
    ds_read_b64_tr_b16 a[136:137], v192 offset:63488
    ds_read_b64_tr_b16 a[138:139], v192 offset:64000
    ds_write_b64 v212, v[64:65] offset:32768
    ds_write_b64 v213, v[66:67] offset:32768
    ds_write_b64 v214, v[68:69] offset:32768
    ds_write_b64 v215, v[70:71] offset:32768
    v_mfma_f32_32x32x16_bf16 v[32:47], a[116:119], a[16:19], v[32:47]
    ds_read_b64_tr_b16 a[140:141], v193 offset:63488
    ds_read_b64_tr_b16 a[142:143], v193 offset:64000
    s_waitcnt lgkmcnt(12)
    v_mfma_f32_32x32x16_bf16 v[16:31], a[120:123], a[20:23], v[16:31]
    s_waitcnt lgkmcnt(2)
    s_waitcnt vmcnt(8)
    s_barrier
    ds_read_b64_tr_b16 a[224:225], v196 offset:49152
    ds_read_b64_tr_b16 a[226:227], v196 offset:49664
    s_add_u32 m0, s56, 32768
    s_mov_b32 s71, s62
    buffer_load_dwordx4 v5, s[20:23], s71 offen lds
    v_mfma_f32_32x32x16_bf16 v[32:47], a[124:127], a[20:23], v[32:47]
    ds_read_b64_tr_b16 a[228:229], v197 offset:49152
    ds_read_b64_tr_b16 a[230:231], v197 offset:49664
    v_mfma_f32_32x32x16_bf16 v[16:31], a[128:131], a[24:27], v[16:31]
    ds_read_b64_tr_b16 a[232:233], v196 offset:51200
    ds_read_b64_tr_b16 a[234:235], v196 offset:51712
    v_mfma_f32_32x32x16_bf16 v[32:47], a[132:135], a[24:27], v[32:47]
    ds_read_b64_tr_b16 a[236:237], v197 offset:51200
    ds_read_b64_tr_b16 a[238:239], v197 offset:51712
    s_add_u32 m0, s56, 33792
    s_add_u32 s71, s62, 57344
    buffer_load_dwordx4 v5, s[20:23], s71 offen lds
    ds_read_b64_tr_b16 a[160:161], v216 offset:0
    s_waitcnt lgkmcnt(9)
    v_mfma_f32_32x32x16_bf16 v[16:31], a[136:139], a[28:31], v[16:31]
    ds_read_b64_tr_b16 a[112:113], v196 offset:53248
    ds_read_b64_tr_b16 a[114:115], v196 offset:53760
    ds_read_b64_tr_b16 a[192:193], v218 offset:0
    ds_read_b64_tr_b16 a[162:163], v217 offset:0
    ds_read_b64_tr_b16 a[194:195], v219 offset:0
    ds_read_b64_tr_b16 a[164:165], v216 offset:2048
    ds_read_b64_tr_b16 a[196:197], v218 offset:2048
    ds_read_b64_tr_b16 a[166:167], v217 offset:2048
    v_mfma_f32_32x32x16_bf16 v[32:47], a[140:143], a[28:31], v[32:47]
    ds_read_b64_tr_b16 a[116:117], v197 offset:53248
    ds_read_b64_tr_b16 a[118:119], v197 offset:53760
    ds_read_b64_tr_b16 a[198:199], v219 offset:2048
    ds_read_b64_tr_b16 a[168:169], v216 offset:4096
    ds_read_b64_tr_b16 a[200:201], v218 offset:4096
    ds_read_b64_tr_b16 a[170:171], v217 offset:4096
    ds_read_b64_tr_b16 a[202:203], v219 offset:4096
    ds_read_b64_tr_b16 a[172:173], v216 offset:6144
    ds_read_b64_tr_b16 a[204:205], v218 offset:6144
    s_waitcnt lgkmcnt(15)
    v_mfma_f32_32x32x16_bf16 v[16:31], a[224:227], a[32:35], v[16:31]
    ds_read_b64_tr_b16 a[120:121], v196 offset:55296
    ds_read_b64_tr_b16 a[122:123], v196 offset:55808
    s_add_u32 m0, s56, 40960
    s_mov_b32 s71, s62
    buffer_load_dwordx4 v6, s[24:27], s71 offen lds
    v_mfma_f32_32x32x16_bf16 v[32:47], a[228:231], a[32:35], v[32:47]
    ds_read_b64_tr_b16 a[124:125], v197 offset:55296
    ds_read_b64_tr_b16 a[126:127], v197 offset:55808
    ds_read_b64_tr_b16 a[174:175], v217 offset:6144
    ds_read_b64_tr_b16 a[206:207], v219 offset:6144
    ds_read_b64_tr_b16 a[176:177], v216 offset:8192
    ds_read_b64_tr_b16 a[208:209], v218 offset:8192
    ds_read_b64_tr_b16 a[178:179], v217 offset:8192
    ds_read_b64_tr_b16 a[210:211], v219 offset:8192
    ds_read_b64_tr_b16 a[180:181], v216 offset:10240
    v_mfma_f32_32x32x16_bf16 v[16:31], a[232:235], a[36:39], v[16:31]
    ds_read_b64_tr_b16 a[128:129], v196 offset:57344
    ds_read_b64_tr_b16 a[130:131], v196 offset:57856
    ds_read_b64_tr_b16 a[212:213], v218 offset:10240
    ds_read_b64_tr_b16 a[182:183], v217 offset:10240
    ds_read_b64_tr_b16 a[214:215], v219 offset:10240
    ds_read_b64_tr_b16 a[184:185], v216 offset:12288
    ds_read_b64_tr_b16 a[216:217], v218 offset:12288
    ds_read_b64_tr_b16 a[186:187], v217 offset:12288
    v_mfma_f32_32x32x16_bf16 v[32:47], a[236:239], a[36:39], v[32:47]
    ds_read_b64_tr_b16 a[132:133], v197 offset:57344
    ds_read_b64_tr_b16 a[134:135], v197 offset:57856
    s_add_u32 m0, s56, 41984
    s_add_u32 s71, s62, 57344
    buffer_load_dwordx4 v6, s[24:27], s71 offen lds
    ds_read_b64_tr_b16 a[218:219], v219 offset:12288
    s_waitcnt lgkmcnt(15)
    v_mfma_f32_32x32x16_bf16 v[16:31], a[112:115], a[40:43], v[16:31]
    ds_read_b64_tr_b16 a[136:137], v196 offset:59392
    ds_read_b64_tr_b16 a[138:139], v196 offset:59904
    ds_read_b64_tr_b16 a[188:189], v216 offset:14336
    ds_read_b64_tr_b16 a[220:221], v218 offset:14336
    ds_read_b64_tr_b16 a[190:191], v217 offset:14336
    ds_read_b64_tr_b16 a[222:223], v219 offset:14336
    v_mfma_f32_32x32x16_bf16 v[32:47], a[116:119], a[40:43], v[32:47]
    ds_read_b64_tr_b16 a[140:141], v197 offset:59392
    ds_read_b64_tr_b16 a[142:143], v197 offset:59904
    v_mfma_f32_32x32x16_bf16 v[48:63], a[160:163], a[192:195], 0
    v_mfma_f32_32x32x16_bf16 v[16:31], a[120:123], a[44:47], v[16:31]
    ds_read_b64_tr_b16 a[224:225], v196 offset:61440
    ds_read_b64_tr_b16 a[226:227], v196 offset:61952
    v_mfma_f32_32x32x16_bf16 v[48:63], a[164:167], a[196:199], v[48:63]
    v_mfma_f32_32x32x16_bf16 v[32:47], a[124:127], a[44:47], v[32:47]
    ds_read_b64_tr_b16 a[228:229], v197 offset:61440
    ds_read_b64_tr_b16 a[230:231], v197 offset:61952
    v_mfma_f32_32x32x16_bf16 v[48:63], a[168:171], a[200:203], v[48:63]
    s_waitcnt lgkmcnt(13)
    v_mfma_f32_32x32x16_bf16 v[16:31], a[128:131], a[48:51], v[16:31]
    ds_read_b64_tr_b16 a[232:233], v196 offset:63488
    ds_read_b64_tr_b16 a[234:235], v196 offset:64000
    v_mfma_f32_32x32x16_bf16 v[48:63], a[172:175], a[204:207], v[48:63]
    v_mfma_f32_32x32x16_bf16 v[32:47], a[132:135], a[48:51], v[32:47]
    ds_read_b64_tr_b16 a[236:237], v197 offset:63488
    ds_read_b64_tr_b16 a[238:239], v197 offset:64000
    v_mfma_f32_32x32x16_bf16 v[48:63], a[176:179], a[208:211], v[48:63]
    s_waitcnt lgkmcnt(8)
    v_mfma_f32_32x32x16_bf16 v[16:31], a[136:139], a[52:55], v[16:31]
    s_waitcnt vmcnt(8)
    s_barrier
    ds_read_b64_tr_b16 a[112:113], v192 offset:0
    ds_read_b64_tr_b16 a[114:115], v192 offset:512
    s_add_u32 m0, s56, 49152
    s_add_u32 s71, s62, 458752
    buffer_load_dwordx4 v5, s[20:23], s71 offen lds
    v_mfma_f32_32x32x16_bf16 v[32:47], a[140:143], a[52:55], v[32:47]
    ds_read_b64_tr_b16 a[116:117], v193 offset:0
    ds_read_b64_tr_b16 a[118:119], v193 offset:512
    s_waitcnt lgkmcnt(8)
    v_mfma_f32_32x32x16_bf16 v[16:31], a[224:227], a[56:59], v[16:31]
    ds_read_b64_tr_b16 a[120:121], v192 offset:2048
    ds_read_b64_tr_b16 a[122:123], v192 offset:2560
    v_mfma_f32_32x32x16_bf16 v[48:63], a[180:183], a[212:215], v[48:63]
    v_mfma_f32_32x32x16_bf16 v[32:47], a[228:231], a[56:59], v[32:47]
    ds_read_b64_tr_b16 a[124:125], v193 offset:2048
    ds_read_b64_tr_b16 a[126:127], v193 offset:2560
    s_add_u32 m0, s56, 50176
    s_add_u32 s71, s62, 516096
    buffer_load_dwordx4 v5, s[20:23], s71 offen lds
    s_waitcnt lgkmcnt(8)
    v_mfma_f32_32x32x16_bf16 v[16:31], a[232:235], a[60:63], v[16:31]
    ds_read_b64_tr_b16 a[128:129], v192 offset:4096
    ds_read_b64_tr_b16 a[130:131], v192 offset:4608
    v_mfma_f32_32x32x16_bf16 v[48:63], a[184:187], a[216:219], v[48:63]
    v_mfma_f32_32x32x16_bf16 v[32:47], a[236:239], a[60:63], v[32:47]
    ds_read_b64_tr_b16 a[132:133], v193 offset:4096
    ds_read_b64_tr_b16 a[134:135], v193 offset:4608
    v_mfma_f32_32x32x16_bf16 v[48:63], a[188:191], a[220:223], v[48:63]
    s_waitcnt lgkmcnt(8)
    v_mfma_f32_32x32x16_bf16 v[16:31], a[112:115], a[64:67], v[16:31]
    ds_read_b64_tr_b16 a[136:137], v192 offset:6144
    ds_read_b64_tr_b16 a[138:139], v192 offset:6656
    s_add_u32 m0, s56, 57344
    s_add_u32 s71, s62, 458752
    buffer_load_dwordx4 v6, s[24:27], s71 offen lds
    v_mfma_f32_32x32x16_bf16 v[32:47], a[116:119], a[64:67], v[32:47]
    ds_read_b64_tr_b16 a[140:141], v193 offset:6144
    ds_read_b64_tr_b16 a[142:143], v193 offset:6656
    s_waitcnt vmcnt(9)
    v_readfirstlane_b32 s52, v14
    s_nop 1
    s_cmp_eq_u32 s52, 1
    s_cbranch_scc1 L_zok_13
    s_mov_b32 s91, 131072
L_zspin_14:
    buffer_load_dword v14, off, s[36:39], s86 sc1
    s_waitcnt vmcnt(0)
    v_readfirstlane_b32 s52, v14
    s_nop 1
    s_cmp_eq_u32 s52, 1
    s_cbranch_scc1 L_zok_13
    s_sub_u32 s91, s91, 1
    s_cmp_eq_u32 s91, 0
    s_cbranch_scc1 L_zok_13
    s_branch L_zspin_14
L_zok_13:
    buffer_atomic_add_f32 v48, v12, s[40:43], s72 offen offset:0
    buffer_atomic_add_f32 v49, v12, s[40:43], s72 offen offset:256
    s_waitcnt lgkmcnt(8)
    v_mfma_f32_32x32x16_bf16 v[16:31], a[120:123], a[68:71], v[16:31]
    ds_read_b64_tr_b16 a[224:225], v192 offset:8192
    ds_read_b64_tr_b16 a[226:227], v192 offset:8704
    buffer_atomic_add_f32 v50, v12, s[40:43], s72 offen offset:512
    buffer_atomic_add_f32 v51, v12, s[40:43], s72 offen offset:768
    buffer_atomic_add_f32 v52, v12, s[40:43], s72 offen offset:1024
    v_mfma_f32_32x32x16_bf16 v[32:47], a[124:127], a[68:71], v[32:47]
    ds_read_b64_tr_b16 a[228:229], v193 offset:8192
    ds_read_b64_tr_b16 a[230:231], v193 offset:8704
    s_add_u32 m0, s56, 58368
    s_add_u32 s71, s62, 516096
    buffer_load_dwordx4 v6, s[24:27], s71 offen lds
    s_waitcnt lgkmcnt(8)
    v_mfma_f32_32x32x16_bf16 v[16:31], a[128:131], a[72:75], v[16:31]
    ds_read_b64_tr_b16 a[232:233], v192 offset:10240
    ds_read_b64_tr_b16 a[234:235], v192 offset:10752
    buffer_atomic_add_f32 v53, v12, s[40:43], s72 offen offset:1280
    buffer_atomic_add_f32 v54, v12, s[40:43], s72 offen offset:1536
    buffer_atomic_add_f32 v55, v12, s[40:43], s72 offen offset:1792
    v_mfma_f32_32x32x16_bf16 v[32:47], a[132:135], a[72:75], v[32:47]
    ds_read_b64_tr_b16 a[236:237], v193 offset:10240
    ds_read_b64_tr_b16 a[238:239], v193 offset:10752
    buffer_atomic_add_f32 v56, v12, s[40:43], s72 offen offset:2048
    buffer_atomic_add_f32 v57, v12, s[40:43], s72 offen offset:2304
    buffer_atomic_add_f32 v58, v12, s[40:43], s72 offen offset:2560
    s_waitcnt lgkmcnt(8)
    v_mfma_f32_32x32x16_bf16 v[16:31], a[136:139], a[76:79], v[16:31]
    ds_read_b64_tr_b16 a[112:113], v192 offset:12288
    ds_read_b64_tr_b16 a[114:115], v192 offset:12800
    buffer_atomic_add_f32 v59, v12, s[40:43], s72 offen offset:2816
    buffer_atomic_add_f32 v60, v12, s[40:43], s72 offen offset:3072
    v_mfma_f32_32x32x16_bf16 v[32:47], a[140:143], a[76:79], v[32:47]
    ds_read_b64_tr_b16 a[116:117], v193 offset:12288
    ds_read_b64_tr_b16 a[118:119], v193 offset:12800
    buffer_atomic_add_f32 v61, v12, s[40:43], s72 offen offset:3328
    buffer_atomic_add_f32 v62, v12, s[40:43], s72 offen offset:3584
    buffer_atomic_add_f32 v63, v12, s[40:43], s72 offen offset:3840
    s_waitcnt lgkmcnt(8)
    v_mfma_f32_32x32x16_bf16 v[16:31], a[224:227], a[80:83], v[16:31]
    ds_read_b64_tr_b16 a[120:121], v192 offset:14336
    ds_read_b64_tr_b16 a[122:123], v192 offset:14848
    v_mfma_f32_32x32x16_bf16 v[32:47], a[228:231], a[80:83], v[32:47]
    ds_read_b64_tr_b16 a[124:125], v193 offset:14336
    ds_read_b64_tr_b16 a[126:127], v193 offset:14848
    s_waitcnt lgkmcnt(8)
    v_mfma_f32_32x32x16_bf16 v[16:31], a[232:235], a[84:87], v[16:31]
    s_waitcnt vmcnt(24)
    s_barrier
    ds_read_b64_tr_b16 a[128:129], v192 offset:16384
    ds_read_b64_tr_b16 a[130:131], v192 offset:16896
    s_add_u32 m0, s56, 65536
    s_add_u32 s71, s62, 917504
    buffer_load_dwordx4 v5, s[20:23], s71 offen lds
    v_mfma_f32_32x32x16_bf16 v[32:47], a[236:239], a[84:87], v[32:47]
    ds_read_b64_tr_b16 a[132:133], v193 offset:16384
    ds_read_b64_tr_b16 a[134:135], v193 offset:16896
    s_waitcnt lgkmcnt(8)
    v_mfma_f32_32x32x16_bf16 v[16:31], a[112:115], a[88:91], v[16:31]
    ds_read_b64_tr_b16 a[136:137], v192 offset:18432
    ds_read_b64_tr_b16 a[138:139], v192 offset:18944
    v_mfma_f32_32x32x16_bf16 v[32:47], a[116:119], a[88:91], v[32:47]
    ds_read_b64_tr_b16 a[140:141], v193 offset:18432
    ds_read_b64_tr_b16 a[142:143], v193 offset:18944
    s_add_u32 m0, s56, 66560
    s_add_u32 s71, s62, 974848
    buffer_load_dwordx4 v5, s[20:23], s71 offen lds
    s_waitcnt lgkmcnt(8)
    v_mfma_f32_32x32x16_bf16 v[16:31], a[120:123], a[92:95], v[16:31]
    ds_read_b64_tr_b16 a[224:225], v192 offset:20480
    ds_read_b64_tr_b16 a[226:227], v192 offset:20992
    v_mfma_f32_32x32x16_bf16 v[32:47], a[124:127], a[92:95], v[32:47]
    ds_read_b64_tr_b16 a[228:229], v193 offset:20480
    ds_read_b64_tr_b16 a[230:231], v193 offset:20992
    s_waitcnt lgkmcnt(8)
    v_mfma_f32_32x32x16_bf16 v[16:31], a[128:131], a[96:99], v[16:31]
    ds_read_b64_tr_b16 a[232:233], v192 offset:22528
    ds_read_b64_tr_b16 a[234:235], v192 offset:23040
    s_add_u32 m0, s56, 73728
    s_add_u32 s71, s62, 917504
    buffer_load_dwordx4 v6, s[24:27], s71 offen lds
    v_mfma_f32_32x32x16_bf16 v[32:47], a[132:135], a[96:99], v[32:47]
    ds_read_b64_tr_b16 a[236:237], v193 offset:22528
    ds_read_b64_tr_b16 a[238:239], v193 offset:23040
    s_waitcnt lgkmcnt(8)
    v_mfma_f32_32x32x16_bf16 v[16:31], a[136:139], a[100:103], v[16:31]
    s_waitcnt vmcnt(23)
    s_barrier
    ds_read_b64_tr_b16 a[112:113], v200 offset:32768
    ds_read_b64_tr_b16 a[114:115], v200 offset:33024
    v_mfma_f32_32x32x16_bf16 v[32:47], a[140:143], a[100:103], v[32:47]
    ds_read_b64_tr_b16 a[116:117], v201 offset:32768
    ds_read_b64_tr_b16 a[118:119], v201 offset:33024
    s_add_u32 m0, s56, 74752
    s_add_u32 s71, s62, 974848
    buffer_load_dwordx4 v6, s[24:27], s71 offen lds
    s_waitcnt lgkmcnt(8)
    v_mfma_f32_32x32x16_bf16 v[16:31], a[224:227], a[104:107], v[16:31]
    ds_read_b64_tr_b16 a[120:121], v200 offset:33792
    ds_read_b64_tr_b16 a[122:123], v200 offset:34048
    v_mfma_f32_32x32x16_bf16 v[32:47], a[228:231], a[104:107], v[32:47]
    ds_read_b64_tr_b16 a[124:125], v201 offset:33792
    ds_read_b64_tr_b16 a[126:127], v201 offset:34048
    s_waitcnt lgkmcnt(8)
    v_mfma_f32_32x32x16_bf16 v[16:31], a[232:235], a[108:111], v[16:31]
    ds_read_b64_tr_b16 a[128:129], v200 offset:34816
    ds_read_b64_tr_b16 a[130:131], v200 offset:35072
    s_add_u32 m0, s58, 0
    s_add_u32 s71, s63, 1376256
    buffer_load_dwordx4 v5, s[20:23], s71 offen lds
    v_mfma_f32_32x32x16_bf16 v[32:47], a[236:239], a[108:111], v[32:47]
    ds_read_b64_tr_b16 a[132:133], v201 offset:34816
    ds_read_b64_tr_b16 a[134:135], v201 offset:35072
    s_waitcnt lgkmcnt(8)
    v_mfma_f32_32x32x16_bf16 v[80:95], a[112:115], a[0:3], 0
    ds_read_b64_tr_b16 a[136:137], v200 offset:35840
    ds_read_b64_tr_b16 a[138:139], v200 offset:36096
    v_mfma_f32_32x32x16_bf16 v[96:111], a[116:119], a[0:3], 0
    ds_read_b64_tr_b16 a[140:141], v201 offset:35840
    ds_read_b64_tr_b16 a[142:143], v201 offset:36096
    s_add_u32 m0, s58, 8192
    s_add_u32 s71, s63, 1376256
    buffer_load_dwordx4 v6, s[24:27], s71 offen lds
    v_cvt_pk_bf16_f32 v176, v16, v17
    v_cvt_pk_bf16_f32 v177, v18, v19
    v_cvt_pk_bf16_f32 v178, v20, v21
    s_waitcnt lgkmcnt(8)
    v_mfma_f32_32x32x16_bf16 v[80:95], a[120:123], a[4:7], v[80:95]
    ds_read_b64_tr_b16 a[224:225], v200 offset:36864
    ds_read_b64_tr_b16 a[226:227], v200 offset:37120
    v_cvt_pk_bf16_f32 v179, v22, v23
    v_cvt_pk_bf16_f32 v180, v24, v25
    v_cvt_pk_bf16_f32 v181, v26, v27
    v_cvt_pk_bf16_f32 v182, v28, v29
    v_cvt_pk_bf16_f32 v183, v30, v31
    v_cndmask_b32 v182, v182, 0, s[60:61]
    v_cndmask_b32 v183, v183, 0, s[60:61]
    v_mfma_f32_32x32x16_bf16 v[96:111], a[124:127], a[4:7], v[96:111]
    ds_read_b64_tr_b16 a[228:229], v201 offset:36864
    ds_read_b64_tr_b16 a[230:231], v201 offset:37120
    v_mfma_f32_32x32x16_bf16 v[48:63], a[144:147], v[176:179], 0
    s_waitcnt lgkmcnt(8)
    v_mfma_f32_32x32x16_bf16 v[80:95], a[128:131], a[8:11], v[80:95]
    ds_read_b64_tr_b16 a[232:233], v200 offset:37888
    ds_read_b64_tr_b16 a[234:235], v200 offset:38144
    v_mfma_f32_32x32x16_bf16 v[48:63], a[148:151], v[180:183], v[48:63]
    v_cvt_pk_bf16_f32 v184, v32, v33
    v_cvt_pk_bf16_f32 v185, v34, v35
    v_mfma_f32_32x32x16_bf16 v[96:111], a[132:135], a[8:11], v[96:111]
    ds_read_b64_tr_b16 a[236:237], v201 offset:37888
    ds_read_b64_tr_b16 a[238:239], v201 offset:38144
    v_cvt_pk_bf16_f32 v186, v36, v37
    v_cvt_pk_bf16_f32 v187, v38, v39
    v_cvt_pk_bf16_f32 v188, v40, v41
    v_cvt_pk_bf16_f32 v189, v42, v43
    v_cvt_pk_bf16_f32 v190, v44, v45
    v_cvt_pk_bf16_f32 v191, v46, v47
    v_cndmask_b32 v190, v190, 0, s[60:61]
    v_cndmask_b32 v191, v191, 0, s[60:61]
    s_waitcnt lgkmcnt(8)
    v_mfma_f32_32x32x16_bf16 v[80:95], a[136:139], a[12:15], v[80:95]
    ds_read_b64_tr_b16 a[112:113], v200 offset:38912
    ds_read_b64_tr_b16 a[114:115], v200 offset:39168
    v_mfma_f32_32x32x16_bf16 v[64:79], a[152:155], v[184:187], 0
    v_mfma_f32_32x32x16_bf16 v[96:111], a[140:143], a[12:15], v[96:111]
    ds_read_b64_tr_b16 a[116:117], v201 offset:38912
    ds_read_b64_tr_b16 a[118:119], v201 offset:39168
    v_mfma_f32_32x32x16_bf16 v[64:79], a[156:159], v[188:191], v[64:79]
    v_max3_f32 v160, v48, v49, v50
    v_min3_f32 v161, v48, v49, v50
    s_waitcnt lgkmcnt(8)
    v_mfma_f32_32x32x16_bf16 v[80:95], a[224:227], a[16:19], v[80:95]
    ds_read_b64_tr_b16 a[120:121], v200 offset:39936
    ds_read_b64_tr_b16 a[122:123], v200 offset:40192
    v_max3_f32 v160, v160, v51, v52
    v_min3_f32 v161, v161, v51, v52
    v_max3_f32 v160, v160, v53, v54
    v_min3_f32 v161, v161, v53, v54
    v_max3_f32 v160, v160, v55, v56
    v_min3_f32 v161, v161, v55, v56
    v_max3_f32 v160, v160, v57, v58
    v_min3_f32 v161, v161, v57, v58
    v_mfma_f32_32x32x16_bf16 v[96:111], a[228:231], a[16:19], v[96:111]
    ds_read_b64_tr_b16 a[124:125], v201 offset:39936
    ds_read_b64_tr_b16 a[126:127], v201 offset:40192
    v_max3_f32 v160, v160, v59, v60
    v_min3_f32 v161, v161, v59, v60
    v_max3_f32 v160, v160, v61, v62
    v_min3_f32 v161, v161, v61, v62
    v_max_f32 v160, v160, v63
    v_min_f32 v161, v161, v63
    v_mov_b32 v162, v160
    v_mov_b32 v163, v161
    s_waitcnt lgkmcnt(8)
    v_mfma_f32_32x32x16_bf16 v[80:95], a[232:235], a[20:23], v[80:95]
    s_waitcnt vmcnt(6)
    s_barrier
    s_cmp_lg_u32 s44, 0
    s_cbranch_scc1 L_nw0_18
    v_mov_b32 v253, 1
    s_mov_b64 exec, 1
    buffer_atomic_add v253, off, s[40:43], s74 sc1
    s_mov_b64 exec, -1
L_nw0_18:
    ds_read_b64_tr_b16 a[128:129], v200 offset:49152
    ds_read_b64_tr_b16 a[130:131], v200 offset:49408
    s_add_u32 m0, s57, 16384
    s_add_u32 s71, s3, 100352
    buffer_load_dwordx4 v238, s[28:31], s71 offen lds
    v_mfma_f32_32x32x16_bf16 v[96:111], a[236:239], a[20:23], v[96:111]
    ds_read_b64_tr_b16 a[132:133], v201 offset:49152
    ds_read_b64_tr_b16 a[134:135], v201 offset:49408
    v_permlane32_swap_b32 v160, v162
    v_permlane32_swap_b32 v161, v163
    v_max_f32 v160, v160, v162
    v_min_f32 v161, v161, v163
    v_mul_f32_e64 v160, v160, v9
    v_mul_f32 v161, v161, v9
    v_pk_fma_f32 v[144:145], v[48:49], v[8:9], v[160:161] op_sel:[0,1,0] op_sel_hi:[1,1,0] neg_lo:[0,0,1] neg_hi:[0,0,1]
    v_pk_fma_f32 v[48:49], v[48:49], v[8:9], v[160:161] op_sel:[0,0,1] op_sel_hi:[1,0,1]
    v_pk_fma_f32 v[146:147], v[50:51], v[8:9], v[160:161] op_sel:[0,1,0] op_sel_hi:[1,1,0] neg_lo:[0,0,1] neg_hi:[0,0,1]
    s_waitcnt lgkmcnt(8)
    v_mfma_f32_32x32x16_bf16 v[80:95], a[112:115], a[24:27], v[80:95]
    ds_read_b64_tr_b16 a[136:137], v200 offset:50176
    ds_read_b64_tr_b16 a[138:139], v200 offset:50432
    v_pk_fma_f32 v[50:51], v[50:51], v[8:9], v[160:161] op_sel:[0,0,1] op_sel_hi:[1,0,1]
    v_pk_fma_f32 v[148:149], v[52:53], v[8:9], v[160:161] op_sel:[0,1,0] op_sel_hi:[1,1,0] neg_lo:[0,0,1] neg_hi:[0,0,1]
    v_pk_fma_f32 v[52:53], v[52:53], v[8:9], v[160:161] op_sel:[0,0,1] op_sel_hi:[1,0,1]
    v_pk_fma_f32 v[150:151], v[54:55], v[8:9], v[160:161] op_sel:[0,1,0] op_sel_hi:[1,1,0] neg_lo:[0,0,1] neg_hi:[0,0,1]
    v_pk_fma_f32 v[54:55], v[54:55], v[8:9], v[160:161] op_sel:[0,0,1] op_sel_hi:[1,0,1]
    v_pk_fma_f32 v[152:153], v[56:57], v[8:9], v[160:161] op_sel:[0,1,0] op_sel_hi:[1,1,0] neg_lo:[0,0,1] neg_hi:[0,0,1]
    v_pk_fma_f32 v[56:57], v[56:57], v[8:9], v[160:161] op_sel:[0,0,1] op_sel_hi:[1,0,1]
    v_mfma_f32_32x32x16_bf16 v[96:111], a[116:119], a[24:27], v[96:111]
    ds_read_b64_tr_b16 a[140:141], v201 offset:50176
    ds_read_b64_tr_b16 a[142:143], v201 offset:50432
    s_add_u32 m0, s57, 17408
    s_add_u32 s71, s3, 107520
    buffer_load_dwordx4 v238, s[28:31], s71 offen lds
    v_pk_fma_f32 v[154:155], v[58:59], v[8:9], v[160:161] op_sel:[0,1,0] op_sel_hi:[1,1,0] neg_lo:[0,0,1] neg_hi:[0,0,1]
    v_pk_fma_f32 v[58:59], v[58:59], v[8:9], v[160:161] op_sel:[0,0,1] op_sel_hi:[1,0,1]
    v_pk_fma_f32 v[156:157], v[60:61], v[8:9], v[160:161] op_sel:[0,1,0] op_sel_hi:[1,1,0] neg_lo:[0,0,1] neg_hi:[0,0,1]
    v_pk_fma_f32 v[60:61], v[60:61], v[8:9], v[160:161] op_sel:[0,0,1] op_sel_hi:[1,0,1]
    s_waitcnt lgkmcnt(8)
    v_mfma_f32_32x32x16_bf16 v[80:95], a[120:123], a[28:31], v[80:95]
    ds_read_b64_tr_b16 a[224:225], v200 offset:51200
    ds_read_b64_tr_b16 a[226:227], v200 offset:51456
    v_pk_fma_f32 v[158:159], v[62:63], v[8:9], v[160:161] op_sel:[0,1,0] op_sel_hi:[1,1,0] neg_lo:[0,0,1] neg_hi:[0,0,1]
    v_pk_fma_f32 v[62:63], v[62:63], v[8:9], v[160:161] op_sel:[0,0,1] op_sel_hi:[1,0,1]
    v_exp_f32 v144, v144
    v_exp_f32 v48, v48
    v_exp_f32 v145, v145
    v_mfma_f32_32x32x16_bf16 v[96:111], a[124:127], a[28:31], v[96:111]
    ds_read_b64_tr_b16 a[228:229], v201 offset:51200
    ds_read_b64_tr_b16 a[230:231], v201 offset:51456
    s_add_u32 m0, s82, 0
    s_mov_b32 s71, s3
    buffer_load_dwordx4 v238, s[28:31], s71 offen lds
    v_exp_f32 v49, v49
    s_waitcnt lgkmcnt(8)
    v_mfma_f32_32x32x16_bf16 v[80:95], a[128:131], a[32:35], v[80:95]
    ds_read_b64_tr_b16 a[232:233], v200 offset:52224
    ds_read_b64_tr_b16 a[234:235], v200 offset:52480
    s_add_u32 m0, s57, 18432
    s_add_u32 s71, s3, 172032
    buffer_load_dwordx4 v238, s[28:31], s71 offen lds
    v_exp_f32 v146, v146
    v_exp_f32 v50, v50
    v_mfma_f32_32x32x16_bf16 v[96:111], a[132:135], a[32:35], v[96:111]
    ds_read_b64_tr_b16 a[236:237], v201 offset:52224
    ds_read_b64_tr_b16 a[238:239], v201 offset:52480
    v_exp_f32 v147, v147
    v_exp_f32 v51, v51
    v_exp_f32_e64 v148, v148
    v_exp_f32 v52, v52
    s_waitcnt lgkmcnt(8)
    v_mfma_f32_32x32x16_bf16 v[80:95], a[136:139], a[36:39], v[80:95]
    ds_read_b64_tr_b16 a[112:113], v200 offset:53248
    ds_read_b64_tr_b16 a[114:115], v200 offset:53504
    s_add_u32 m0, s82, 1024
    s_add_u32 s71, s3, 7168
    buffer_load_dwordx4 v238, s[28:31], s71 offen lds
    v_exp_f32_e64 v149, v149
    v_mfma_f32_32x32x16_bf16 v[96:111], a[140:143], a[36:39], v[96:111]
    ds_read_b64_tr_b16 a[116:117], v201 offset:53248
    ds_read_b64_tr_b16 a[118:119], v201 offset:53504
    s_add_u32 m0, s57, 19456
    s_add_u32 s71, s3, 179200
    buffer_load_dwordx4 v238, s[28:31], s71 offen lds
    v_exp_f32_e64 v53, v53
    v_exp_f32 v150, v150
    s_waitcnt lgkmcnt(8)
    v_mfma_f32_32x32x16_bf16 v[80:95], a[224:227], a[40:43], v[80:95]
    ds_read_b64_tr_b16 a[120:121], v200 offset:54272
    ds_read_b64_tr_b16 a[122:123], v200 offset:54528
    v_exp_f32 v54, v54
    v_exp_f32 v151, v151
    v_exp_f32 v55, v55
    v_exp_f32 v152, v152
    v_mfma_f32_32x32x16_bf16 v[96:111], a[228:231], a[40:43], v[96:111]
    ds_read_b64_tr_b16 a[124:125], v201 offset:54272
    ds_read_b64_tr_b16 a[126:127], v201 offset:54528
    s_add_u32 m0, s82, 2048
    s_add_u32 s71, s3, 14336
    buffer_load_dwordx4 v238, s[28:31], s71 offen lds
    v_exp_f32 v56, v56
    s_waitcnt lgkmcnt(8)
    v_mfma_f32_32x32x16_bf16 v[80:95], a[232:235], a[44:47], v[80:95]
    ds_read_b64_tr_b16 a[128:129], v200 offset:55296
    ds_read_b64_tr_b16 a[130:131], v200 offset:55552
    v_exp_f32 v153, v153
    v_exp_f32 v57, v57
    v_exp_f32 v154, v154
    v_exp_f32 v58, v58
    v_mfma_f32_32x32x16_bf16 v[96:111], a[236:239], a[44:47], v[96:111]
    ds_read_b64_tr_b16 a[132:133], v201 offset:55296
    ds_read_b64_tr_b16 a[134:135], v201 offset:55552
    s_add_u32 m0, s82, 3072
    s_add_u32 s71, s3, 21504
    buffer_load_dwordx4 v238, s[28:31], s71 offen lds
    v_exp_f32 v155, v155
    v_exp_f32 v59, v59
    s_waitcnt lgkmcnt(8)
    v_mfma_f32_32x32x16_bf16 v[80:95], a[112:115], a[48:51], v[80:95]
    ds_read_b64_tr_b16 a[136:137], v200 offset:56320
    ds_read_b64_tr_b16 a[138:139], v200 offset:56576
    v_exp_f32 v156, v156
    v_exp_f32 v60, v60
    v_exp_f32 v157, v157
    v_mfma_f32_32x32x16_bf16 v[96:111], a[116:119], a[48:51], v[96:111]
    ds_read_b64_tr_b16 a[140:141], v201 offset:56320
    ds_read_b64_tr_b16 a[142:143], v201 offset:56576
    v_exp_f32 v61, v61
    v_exp_f32 v158, v158
    v_exp_f32 v62, v62
    v_exp_f32 v159, v159
    v_exp_f32_e64 v63, v63
    s_waitcnt lgkmcnt(8)
    v_mfma_f32_32x32x16_bf16 v[80:95], a[120:123], a[52:55], v[80:95]
    s_waitcnt vmcnt(10)
    s_barrier
    ds_read_b64_tr_b16 a[224:225], v204 offset:49152
    ds_read_b64_tr_b16 a[226:227], v204 offset:49408
    s_add_u32 m0, s57, 32768
    s_add_u32 s71, s3, 186368
    buffer_load_dwordx4 v238, s[28:31], s71 offen lds
    v_mfma_f32_32x32x16_bf16 v[96:111], a[124:127], a[52:55], v[96:111]
    ds_read_b64_tr_b16 a[228:229], v205 offset:49152
    ds_read_b64_tr_b16 a[230:231], v205 offset:49408
    s_add_u32 m0, s82, 4096
    s_add_u32 s71, s3, 28672
    buffer_load_dwordx4 v238, s[28:31], s71 offen lds
    v_cvt_pk_bf16_f32 v144, v144, v145
    v_cvt_pk_bf16_f32 v48, v48, v49
    v_cvt_pk_bf16_f32 v145, v146, v147
    s_waitcnt lgkmcnt(8)
    v_mfma_f32_32x32x16_bf16 v[80:95], a[128:131], a[56:59], v[80:95]
    ds_read_b64_tr_b16 a[232:233], v204 offset:50176
    ds_read_b64_tr_b16 a[234:235], v204 offset:50432
    v_cvt_pk_bf16_f32 v49, v50, v51
    v_cvt_pk_bf16_f32 v146, v148, v149
    v_cvt_pk_bf16_f32 v50, v52, v53
    v_cvt_pk_bf16_f32 v147, v150, v151
    v_cvt_pk_bf16_f32 v51, v54, v55
    v_cvt_pk_bf16_f32 v148, v152, v153
    v_cvt_pk_bf16_f32 v52, v56, v57
    v_mfma_f32_32x32x16_bf16 v[96:111], a[132:135], a[56:59], v[96:111]
    ds_read_b64_tr_b16 a[236:237], v205 offset:50176
    ds_read_b64_tr_b16 a[238:239], v205 offset:50432
    s_add_u32 m0, s57, 33792
    s_add_u32 s71, s3, 193536
    buffer_load_dwordx4 v238, s[28:31], s71 offen lds
    v_cvt_pk_bf16_f32 v149, v154, v155
    v_cvt_pk_bf16_f32 v53, v58, v59
    v_cvt_pk_bf16_f32 v150, v156, v157
    v_cvt_pk_bf16_f32 v54, v60, v61
    s_waitcnt lgkmcnt(8)
    v_mfma_f32_32x32x16_bf16 v[80:95], a[136:139], a[60:63], v[80:95]
    ds_read_b64_tr_b16 a[112:113], v204 offset:51200
    ds_read_b64_tr_b16 a[114:115], v204 offset:51456
    s_add_u32 m0, s82, 5120
    s_add_u32 s71, s3, 35840
    buffer_load_dwordx4 v238, s[28:31], s71 offen lds
    v_cvt_pk_bf16_f32 v151, v158, v159
    v_cvt_pk_bf16_f32 v55, v62, v63
    v_mfma_f32_32x32x16_bf16 v[96:111], a[140:143], a[60:63], v[96:111]
    ds_read_b64_tr_b16 a[116:117], v205 offset:51200
    ds_read_b64_tr_b16 a[118:119], v205 offset:51456
    v_max3_f32 v160, v64, v65, v66
    v_min3_f32 v161, v64, v65, v66
    v_max3_f32 v160, v160, v67, v68
    v_min3_f32 v161, v161, v67, v68
    v_max3_f32 v160, v160, v69, v70
    v_min3_f32 v161, v161, v69, v70
    v_max3_f32 v160, v160, v71, v72
    v_min3_f32 v161, v161, v71, v72
    v_max3_f32 v160, v160, v73, v74
    s_waitcnt lgkmcnt(8)
    v_mfma_f32_32x32x16_bf16 v[80:95], a[224:227], a[64:67], v[80:95]
    ds_read_b64_tr_b16 a[120:121], v204 offset:52224
    ds_read_b64_tr_b16 a[122:123], v204 offset:52480
    s_add_u32 m0, s57, 34816
    s_add_u32 s71, s3, 200704
    buffer_load_dwordx4 v238, s[28:31], s71 offen lds
    v_min3_f32 v161, v161, v73, v74
    v_max3_f32 v160, v160, v75, v76
    v_mfma_f32_32x32x16_bf16 v[96:111], a[228:231], a[64:67], v[96:111]
    ds_read_b64_tr_b16 a[124:125], v205 offset:52224
    ds_read_b64_tr_b16 a[126:127], v205 offset:52480
    s_add_u32 m0, s82, 6144
    s_add_u32 s71, s3, 43008
    buffer_load_dwordx4 v238, s[28:31], s71 offen lds
    v_min3_f32 v161, v161, v75, v76
    v_max3_f32 v160, v160, v77, v78
    v_min3_f32 v161, v161, v77, v78
    v_max_f32 v160, v160, v79
    s_waitcnt lgkmcnt(8)
    v_mfma_f32_32x32x16_bf16 v[80:95], a[232:235], a[68:71], v[80:95]
    ds_read_b64_tr_b16 a[128:129], v204 offset:53248
    ds_read_b64_tr_b16 a[130:131], v204 offset:53504
    v_min_f32 v161, v161, v79
    v_mov_b32 v162, v160
    v_mov_b32 v163, v161
    s_nop 0
    v_permlane32_swap_b32 v160, v162
    v_permlane32_swap_b32 v161, v163
    v_max_f32 v160, v160, v162
    v_min_f32 v161, v161, v163
    v_mfma_f32_32x32x16_bf16 v[96:111], a[236:239], a[68:71], v[96:111]
    ds_read_b64_tr_b16 a[132:133], v205 offset:53248
    ds_read_b64_tr_b16 a[134:135], v205 offset:53504
    s_add_u32 m0, s57, 35840
    s_add_u32 s71, s3, 207872
    buffer_load_dwordx4 v238, s[28:31], s71 offen lds
    v_mul_f32_e64 v160, v160, v9
    v_mul_f32 v161, v161, v9
    v_pk_fma_f32 v[152:153], v[64:65], v[8:9], v[160:161] op_sel:[0,1,0] op_sel_hi:[1,1,0] neg_lo:[0,0,1] neg_hi:[0,0,1]
    s_waitcnt lgkmcnt(8)
    v_mfma_f32_32x32x16_bf16 v[80:95], a[112:115], a[72:75], v[80:95]
    ds_read_b64_tr_b16 a[136:137], v204 offset:54272
    ds_read_b64_tr_b16 a[138:139], v204 offset:54528
    v_pk_fma_f32 v[64:65], v[64:65], v[8:9], v[160:161] op_sel:[0,0,1] op_sel_hi:[1,0,1]
    v_pk_fma_f32 v[154:155], v[66:67], v[8:9], v[160:161] op_sel:[0,1,0] op_sel_hi:[1,1,0] neg_lo:[0,0,1] neg_hi:[0,0,1]
    v_pk_fma_f32 v[66:67], v[66:67], v[8:9], v[160:161] op_sel:[0,0,1] op_sel_hi:[1,0,1]
    v_pk_fma_f32 v[156:157], v[68:69], v[8:9], v[160:161] op_sel:[0,1,0] op_sel_hi:[1,1,0] neg_lo:[0,0,1] neg_hi:[0,0,1]
    v_pk_fma_f32 v[68:69], v[68:69], v[8:9], v[160:161] op_sel:[0,0,1] op_sel_hi:[1,0,1]
    v_pk_fma_f32 v[158:159], v[70:71], v[8:9], v[160:161] op_sel:[0,1,0] op_sel_hi:[1,1,0] neg_lo:[0,0,1] neg_hi:[0,0,1]
    v_pk_fma_f32 v[70:71], v[70:71], v[8:9], v[160:161] op_sel:[0,0,1] op_sel_hi:[1,0,1]
    v_pk_fma_f32 v[168:169], v[72:73], v[8:9], v[160:161] op_sel:[0,1,0] op_sel_hi:[1,1,0] neg_lo:[0,0,1] neg_hi:[0,0,1]
    v_mfma_f32_32x32x16_bf16 v[96:111], a[116:119], a[72:75], v[96:111]
    ds_read_b64_tr_b16 a[140:141], v205 offset:54272
    ds_read_b64_tr_b16 a[142:143], v205 offset:54528
    s_add_u32 m0, s82, 7168
    s_add_u32 s71, s3, 50176
    buffer_load_dwordx4 v238, s[28:31], s71 offen lds
    v_pk_fma_f32 v[72:73], v[72:73], v[8:9], v[160:161] op_sel:[0,0,1] op_sel_hi:[1,0,1]
    v_pk_fma_f32 v[170:171], v[74:75], v[8:9], v[160:161] op_sel:[0,1,0] op_sel_hi:[1,1,0] neg_lo:[0,0,1] neg_hi:[0,0,1]
    v_pk_fma_f32 v[74:75], v[74:75], v[8:9], v[160:161] op_sel:[0,0,1] op_sel_hi:[1,0,1]
    s_waitcnt lgkmcnt(8)
    v_mfma_f32_32x32x16_bf16 v[80:95], a[120:123], a[76:79], v[80:95]
    ds_read_b64_tr_b16 a[224:225], v204 offset:55296
    ds_read_b64_tr_b16 a[226:227], v204 offset:55552
    v_pk_fma_f32 v[172:173], v[76:77], v[8:9], v[160:161] op_sel:[0,1,0] op_sel_hi:[1,1,0] neg_lo:[0,0,1] neg_hi:[0,0,1]
    v_pk_fma_f32 v[76:77], v[76:77], v[8:9], v[160:161] op_sel:[0,0,1] op_sel_hi:[1,0,1]
    v_pk_fma_f32 v[174:175], v[78:79], v[8:9], v[160:161] op_sel:[0,1,0] op_sel_hi:[1,1,0] neg_lo:[0,0,1] neg_hi:[0,0,1]
    v_pk_fma_f32 v[78:79], v[78:79], v[8:9], v[160:161] op_sel:[0,0,1] op_sel_hi:[1,0,1]
    v_exp_f32 v152, v152
    v_exp_f32_e64 v64, v64
    v_mfma_f32_32x32x16_bf16 v[96:111], a[124:127], a[76:79], v[96:111]
    ds_read_b64_tr_b16 a[228:229], v205 offset:55296
    ds_read_b64_tr_b16 a[230:231], v205 offset:55552
    s_add_u32 m0, s82, 8192
    s_add_u32 s71, s3, 57344
    buffer_load_dwordx4 v238, s[28:31], s71 offen lds
    v_exp_f32_e64 v153, v153
    v_exp_f32 v65, v65
    s_waitcnt lgkmcnt(8)
    v_mfma_f32_32x32x16_bf16 v[80:95], a[128:131], a[80:83], v[80:95]
    ds_read_b64_tr_b16 a[232:233], v204 offset:56320
    ds_read_b64_tr_b16 a[234:235], v204 offset:56576
    buffer_load_dword v14, off, s[40:43], s74 sc1
    v_exp_f32_e64 v154, v154
    v_mfma_f32_32x32x16_bf16 v[96:111], a[132:135], a[80:83], v[96:111]
    ds_read_b64_tr_b16 a[236:237], v205 offset:56320
    ds_read_b64_tr_b16 a[238:239], v205 offset:56576
    s_add_u32 m0, s82, 9216
    s_add_u32 s71, s3, 64512
    buffer_load_dwordx4 v238, s[28:31], s71 offen lds
    v_exp_f32_e64 v66, v66
    v_exp_f32 v155, v155
    s_waitcnt lgkmcnt(8)
    v_mfma_f32_32x32x16_bf16 v[80:95], a[136:139], a[84:87], v[80:95]
    s_waitcnt vmcnt(19)
    s_barrier
    ds_read_b64_tr_b16 a[112:113], v200 offset:0
    ds_read_b64_tr_b16 a[114:115], v200 offset:256
    s_add_u32 m0, s57, 49152
    s_add_u32 s71, s3, 215040
    buffer_load_dwordx4 v238, s[28:31], s71 offen lds
    v_mfma_f32_32x32x16_bf16 v[96:111], a[140:143], a[84:87], v[96:111]
    ds_read_b64_tr_b16 a[116:117], v201 offset:0
    ds_read_b64_tr_b16 a[118:119], v201 offset:256
    v_exp_f32 v67, v67
    v_exp_f32 v156, v156
    v_exp_f32_e64 v68, v68
    v_exp_f32 v157, v157
    s_waitcnt lgkmcnt(8)
    v_mfma_f32_32x32x16_bf16 v[80:95], a[224:227], a[88:91], v[80:95]
    ds_read_b64_tr_b16 a[120:121], v200 offset:1024
    ds_read_b64_tr_b16 a[122:123], v200 offset:1280
    s_add_u32 m0, s82, 10240
    s_add_u32 s71, s3, 71680
    buffer_load_dwordx4 v238, s[28:31], s71 offen lds
    v_exp_f32 v69, v69
    v_exp_f32 v158, v158
    v_mfma_f32_32x32x16_bf16 v[96:111], a[228:231], a[88:91], v[96:111]
    ds_read_b64_tr_b16 a[124:125], v201 offset:1024
    ds_read_b64_tr_b16 a[126:127], v201 offset:1280
    s_add_u32 m0, s57, 50176
    s_add_u32 s71, s3, 222208
    buffer_load_dwordx4 v238, s[28:31], s71 offen lds
    v_exp_f32 v70, v70
    s_waitcnt lgkmcnt(8)
    v_mfma_f32_32x32x16_bf16 v[80:95], a[232:235], a[92:95], v[80:95]
    ds_read_b64_tr_b16 a[128:129], v200 offset:2048
    ds_read_b64_tr_b16 a[130:131], v200 offset:2304
    v_exp_f32 v159, v159
    v_exp_f32 v71, v71
    v_exp_f32 v168, v168
    v_exp_f32 v72, v72
    v_mfma_f32_32x32x16_bf16 v[96:111], a[236:239], a[92:95], v[96:111]
    ds_read_b64_tr_b16 a[132:133], v201 offset:2048
    ds_read_b64_tr_b16 a[134:135], v201 offset:2304
    v_exp_f32 v169, v169
    v_exp_f32 v73, v73
    v_exp_f32_e64 v170, v170
    v_exp_f32 v74, v74
    s_waitcnt lgkmcnt(8)
    v_mfma_f32_32x32x16_bf16 v[80:95], a[112:115], a[96:99], v[80:95]
    ds_read_b64_tr_b16 a[136:137], v200 offset:3072
    ds_read_b64_tr_b16 a[138:139], v200 offset:3328
    s_add_u32 m0, s57, 51200
    s_add_u32 s71, s3, 229376
    buffer_load_dwordx4 v238, s[28:31], s71 offen lds
    v_exp_f32 v171, v171
    v_exp_f32 v75, v75
    v_mfma_f32_32x32x16_bf16 v[96:111], a[116:119], a[96:99], v[96:111]
    ds_read_b64_tr_b16 a[140:141], v201 offset:3072
    ds_read_b64_tr_b16 a[142:143], v201 offset:3328
    s_add_u32 m0, s82, 11264
    s_add_u32 s71, s3, 78848
    buffer_load_dwordx4 v238, s[28:31], s71 offen lds
    v_exp_f32 v172, v172
    s_waitcnt lgkmcnt(8)
    v_mfma_f32_32x32x16_bf16 v[80:95], a[120:123], a[100:103], v[80:95]
    s_add_u32 m0, s82, 12288
    s_add_u32 s71, s3, 86016
    buffer_load_dwordx4 v238, s[28:31], s71 offen lds
    v_exp_f32 v76, v76
    v_exp_f32 v173, v173
    v_exp_f32_e64 v77, v77
    v_mfma_f32_32x32x16_bf16 v[96:111], a[124:127], a[100:103], v[96:111]
    s_add_u32 m0, s57, 52224
    s_add_u32 s71, s3, 236544
    buffer_load_dwordx4 v238, s[28:31], s71 offen lds
    v_exp_f32_e64 v174, v174
    v_exp_f32 v78, v78
    s_waitcnt lgkmcnt(4)
    v_mfma_f32_32x32x16_bf16 v[80:95], a[128:131], a[104:107], v[80:95]
    v_exp_f32 v175, v175
    v_exp_f32 v79, v79
    v_cvt_pk_bf16_f32 v152, v152, v153
    v_cvt_pk_bf16_f32 v64, v64, v65
    v_cvt_pk_bf16_f32 v153, v154, v155
    v_cvt_pk_bf16_f32 v65, v66, v67
    v_cvt_pk_bf16_f32 v154, v156, v157
    v_cvt_pk_bf16_f32 v66, v68, v69
    v_mfma_f32_32x32x16_bf16 v[96:111], a[132:135], a[104:107], v[96:111]
    s_add_u32 m0, s82, 13312
    s_add_u32 s71, s3, 93184
    buffer_load_dwordx4 v238, s[28:31], s71 offen lds
    v_cvt_pk_bf16_f32 v155, v158, v159
    v_cvt_pk_bf16_f32 v67, v70, v71
    v_cvt_pk_bf16_f32 v156, v168, v169
    v_cvt_pk_bf16_f32 v68, v72, v73
    v_cvt_pk_bf16_f32 v157, v170, v171
    s_waitcnt lgkmcnt(0)
    v_mfma_f32_32x32x16_bf16 v[80:95], a[136:139], a[108:111], v[80:95]
    s_add_u32 m0, s56, 148480
    s_mov_b32 s71, s93
    buffer_load_dwordx4 v239, s[4:7], s71 offen lds
    v_cvt_pk_bf16_f32 v69, v74, v75
    v_cvt_pk_bf16_f32 v158, v172, v173
    v_cvt_pk_bf16_f32 v70, v76, v77
    v_cvt_pk_bf16_f32 v159, v174, v175
    v_cvt_pk_bf16_f32 v71, v78, v79
    v_mfma_f32_32x32x16_bf16 v[96:111], a[140:143], a[108:111], v[96:111]
    s_add_u32 m0, s56, 149504
    s_add_u32 s71, s93, 7168
    buffer_load_dwordx4 v239, s[4:7], s71 offen lds
    s_waitcnt vmcnt(11)
    v_readfirstlane_b32 s52, v14
    s_nop 1
    s_cmp_eq_u32 s52, 16
    s_cbranch_scc1 L_cok_15
    s_mov_b32 s91, 131072
L_cspin_16:
    buffer_load_dword v14, off, s[40:43], s74 sc1
    s_waitcnt vmcnt(0)
    v_readfirstlane_b32 s52, v14
    s_nop 1
    s_cmp_eq_u32 s52, 16
    s_cbranch_scc1 L_cok_15
    s_sub_u32 s91, s91, 1
    s_cmp_eq_u32 s91, 0
    s_cbranch_scc1 L_cok_15
    s_branch L_cspin_16
L_cok_15:
    buffer_load_dword v16, v12, s[40:43], s72 offen offset:0 sc1
    buffer_load_dword v17, v12, s[40:43], s72 offen offset:256 sc1
    buffer_load_dword v18, v12, s[40:43], s72 offen offset:512 sc1
    buffer_load_dword v19, v12, s[40:43], s72 offen offset:768 sc1
    buffer_load_dword v20, v12, s[40:43], s72 offen offset:1024 sc1
    buffer_load_dword v21, v12, s[40:43], s72 offen offset:1280 sc1
    buffer_load_dword v22, v12, s[40:43], s72 offen offset:1536 sc1
    buffer_load_dword v23, v12, s[40:43], s72 offen offset:1792 sc1
    buffer_load_dword v24, v12, s[40:43], s72 offen offset:2048 sc1
    buffer_load_dword v25, v12, s[40:43], s72 offen offset:2304 sc1
    buffer_load_dword v26, v12, s[40:43], s72 offen offset:2560 sc1
    buffer_load_dword v27, v12, s[40:43], s72 offen offset:2816 sc1
    buffer_load_dword v28, v12, s[40:43], s72 offen offset:3072 sc1
    buffer_load_dword v29, v12, s[40:43], s72 offen offset:3328 sc1
    buffer_load_dword v30, v12, s[40:43], s72 offen offset:3584 sc1
    buffer_load_dword v31, v12, s[40:43], s72 offen offset:3840 sc1
    s_barrier
    v_pk_mul_f32 v[168:169], v[80:81], v[8:9] op_sel:[0,0] op_sel_hi:[1,0]
    v_pk_mul_f32 v[160:161], v[96:97], v[8:9] op_sel:[0,0] op_sel_hi:[1,0]
    v_pk_mul_f32 v[170:171], v[82:83], v[8:9] op_sel:[0,0] op_sel_hi:[1,0]
    v_pk_mul_f32 v[162:163], v[98:99], v[8:9] op_sel:[0,0] op_sel_hi:[1,0]
    v_pk_mul_f32 v[172:173], v[84:85], v[8:9] op_sel:[0,0] op_sel_hi:[1,0]
    v_pk_mul_f32 v[164:165], v[100:101], v[8:9] op_sel:[0,0] op_sel_hi:[1,0]
    v_pk_mul_f32 v[174:175], v[86:87], v[8:9] op_sel:[0,0] op_sel_hi:[1,0]
    v_pk_mul_f32 v[166:167], v[102:103], v[8:9] op_sel:[0,0] op_sel_hi:[1,0]
    v_exp_f32 v168, v168
    v_exp_f32 v160, v160
    v_exp_f32 v169, v169
    v_exp_f32 v161, v161
    v_exp_f32 v170, v170
    v_exp_f32 v162, v162
    v_exp_f32 v171, v171
    v_exp_f32 v163, v163
    v_exp_f32 v172, v172
    v_exp_f32 v164, v164
    v_exp_f32 v173, v173
    v_exp_f32 v165, v165
    v_exp_f32 v174, v174
    v_exp_f32 v166, v166
    v_exp_f32 v175, v175
    v_exp_f32_e64 v167, v167
    v_pk_mul_f32 v[80:81], v[80:81], v[88:89]
    v_pk_mul_f32 v[96:97], v[96:97], v[104:105]
    v_pk_mul_f32 v[82:83], v[82:83], v[90:91]
    v_pk_mul_f32 v[98:99], v[98:99], v[106:107]
    v_pk_mul_f32 v[84:85], v[84:85], v[92:93]
    v_pk_mul_f32 v[100:101], v[100:101], v[108:109]
    v_pk_mul_f32 v[86:87], v[86:87], v[94:95]
    v_pk_mul_f32 v[102:103], v[102:103], v[110:111]
    v_pk_add_f32 v[168:169], v[168:169], 1.0 op_sel_hi:[1,0]
    v_pk_add_f32 v[160:161], v[160:161], 1.0 op_sel_hi:[1,0]
    v_pk_add_f32 v[170:171], v[170:171], 1.0 op_sel_hi:[1,0]
    v_pk_add_f32 v[162:163], v[162:163], 1.0 op_sel_hi:[1,0]
    v_pk_add_f32 v[172:173], v[172:173], 1.0 op_sel_hi:[1,0]
    v_pk_add_f32 v[164:165], v[164:165], 1.0 op_sel_hi:[1,0]
    v_pk_add_f32 v[174:175], v[174:175], 1.0 op_sel_hi:[1,0]
    v_pk_add_f32 v[166:167], v[166:167], 1.0 op_sel_hi:[1,0]
    v_rcp_f32 v168, v168
    v_rcp_f32 v160, v160
    v_rcp_f32 v169, v169
    v_rcp_f32 v161, v161
    v_rcp_f32 v170, v170
    v_rcp_f32 v162, v162
    v_rcp_f32 v171, v171
    v_rcp_f32 v163, v163
    v_rcp_f32 v172, v172
    v_rcp_f32 v164, v164
    v_rcp_f32 v173, v173
    v_rcp_f32 v165, v165
    v_rcp_f32 v174, v174
    v_rcp_f32 v166, v166
    v_rcp_f32 v175, v175
    v_rcp_f32 v167, v167
    v_pk_mul_f32 v[80:81], v[80:81], v[168:169]
    v_pk_mul_f32 v[96:97], v[96:97], v[160:161]
    v_pk_mul_f32 v[82:83], v[82:83], v[170:171]
    v_pk_mul_f32 v[98:99], v[98:99], v[162:163]
    v_pk_mul_f32 v[84:85], v[84:85], v[172:173]
    v_pk_mul_f32 v[100:101], v[100:101], v[164:165]
    v_pk_mul_f32 v[86:87], v[86:87], v[174:175]
    v_pk_mul_f32 v[102:103], v[102:103], v[166:167]
    v_cvt_pk_bf16_f32 v88, v80, v81
    v_cvt_pk_bf16_f32 v104, v96, v97
    v_cvt_pk_bf16_f32 v89, v82, v83
    v_cvt_pk_bf16_f32 v105, v98, v99
    v_cvt_pk_bf16_f32 v90, v84, v85
    v_cvt_pk_bf16_f32 v106, v100, v101
    v_cvt_pk_bf16_f32 v91, v86, v87
    v_cvt_pk_bf16_f32 v107, v102, v103
    buffer_store_dwordx4 v[88:91], v11, s[40:43], s68 offen offset:0 sc1
    buffer_store_dwordx4 v[104:107], v11, s[40:43], s68 offen offset:1024 sc1
    s_waitcnt vmcnt(20)
    ds_read_b64_tr_b16 a[0:1], v246 offset:0
    ds_read_b64_tr_b16 a[2:3], v246 offset:1024
    ds_read_b64_tr_b16 a[4:5], v247 offset:0
    ds_read_b64_tr_b16 a[6:7], v247 offset:1024
    ds_read_b64_tr_b16 a[8:9], v246 offset:2048
    ds_read_b64_tr_b16 a[10:11], v246 offset:3072
    s_add_u32 m0, s57, 0
    s_add_u32 s71, s3, 243712
    buffer_load_dwordx4 v238, s[28:31], s71 offen lds
    ds_read_b64_tr_b16 a[12:13], v247 offset:2048
    ds_read_b64_tr_b16 a[14:15], v247 offset:3072
    ds_read_b64_tr_b16 a[16:17], v246 offset:4096
    ds_read_b64_tr_b16 a[18:19], v246 offset:5120
    ds_read_b64_tr_b16 a[20:21], v247 offset:4096
    ds_read_b64_tr_b16 a[22:23], v247 offset:5120
    ds_read_b64_tr_b16 a[24:25], v246 offset:6144
    s_add_u32 m0, s57, 1024
    s_add_u32 s71, s3, 250880
    buffer_load_dwordx4 v238, s[28:31], s71 offen lds
    ds_read_b64_tr_b16 a[26:27], v246 offset:7168
    ds_read_b64_tr_b16 a[28:29], v247 offset:6144
    ds_read_b64_tr_b16 a[30:31], v247 offset:7168
    ds_read_b64_tr_b16 a[32:33], v246 offset:8192
    ds_read_b64_tr_b16 a[34:35], v246 offset:9216
    ds_read_b64_tr_b16 a[36:37], v247 offset:8192
    s_add_u32 m0, s57, 2048
    s_add_u32 s71, s3, 258048
    buffer_load_dwordx4 v238, s[28:31], s71 offen lds
    ds_read_b64_tr_b16 a[38:39], v247 offset:9216
    ds_read_b64_tr_b16 a[40:41], v246 offset:10240
    ds_read_b64_tr_b16 a[42:43], v246 offset:11264
    ds_read_b64_tr_b16 a[44:45], v247 offset:10240
    ds_read_b64_tr_b16 a[46:47], v247 offset:11264
    ds_read_b64_tr_b16 a[48:49], v246 offset:12288
    ds_read_b64_tr_b16 a[50:51], v246 offset:13312
    s_add_u32 m0, s57, 3072
    s_add_u32 s71, s3, 265216
    buffer_load_dwordx4 v238, s[28:31], s71 offen lds
    ds_read_b64_tr_b16 a[52:53], v247 offset:12288
    ds_read_b64_tr_b16 a[54:55], v247 offset:13312
    ds_read_b64_tr_b16 a[56:57], v240 offset:16384
    ds_read_b64_tr_b16 a[58:59], v240 offset:17408
    ds_read_b64_tr_b16 a[60:61], v241 offset:16384
    ds_read_b64_tr_b16 a[62:63], v241 offset:17408
    ds_read_b64_tr_b16 a[64:65], v240 offset:18432
    s_add_u32 m0, s57, 65536
    s_add_u32 s71, s3, 272384
    buffer_load_dwordx4 v238, s[28:31], s71 offen lds
    ds_read_b64_tr_b16 a[66:67], v240 offset:19456
    ds_read_b64_tr_b16 a[68:69], v241 offset:18432
    ds_read_b64_tr_b16 a[70:71], v241 offset:19456
    ds_read_b64_tr_b16 a[72:73], v240 offset:32768
    ds_read_b64_tr_b16 a[74:75], v240 offset:33792
    ds_read_b64_tr_b16 a[76:77], v241 offset:32768
    s_add_u32 m0, s57, 66560
    s_add_u32 s71, s3, 279552
    buffer_load_dwordx4 v238, s[28:31], s71 offen lds
    ds_read_b64_tr_b16 a[78:79], v241 offset:33792
    ds_read_b64_tr_b16 a[80:81], v240 offset:34816
    ds_read_b64_tr_b16 a[82:83], v240 offset:35840
    ds_read_b64_tr_b16 a[84:85], v241 offset:34816
    ds_read_b64_tr_b16 a[86:87], v241 offset:35840
    ds_read_b64_tr_b16 a[88:89], v240 offset:49152
    ds_read_b64_tr_b16 a[90:91], v240 offset:50176
    s_add_u32 m0, s57, 67584
    s_add_u32 s71, s3, 114688
    buffer_load_dwordx4 v238, s[28:31], s71 offen lds
    ds_read_b64_tr_b16 a[92:93], v241 offset:49152
    ds_read_b64_tr_b16 a[94:95], v241 offset:50176
    ds_read_b64_tr_b16 a[96:97], v240 offset:51200
    ds_read_b64_tr_b16 a[98:99], v240 offset:52224
    ds_read_b64_tr_b16 a[100:101], v241 offset:51200
    ds_read_b64_tr_b16 a[102:103], v241 offset:52224
    s_add_u32 m0, s57, 68608
    s_add_u32 s71, s3, 121856
    buffer_load_dwordx4 v238, s[28:31], s71 offen lds
    s_lshl_b32 s50, s44, 11
    s_add_u32 s50, s50, 140288
    v_add_u32 v237, s50, v11
    v_mov_b32 v236, 0x3f803f80
    s_waitcnt vmcnt(24)
    v_cvt_pk_bf16_f32 v16, v16, v17
    s_waitcnt vmcnt(22)
    v_cvt_pk_bf16_f32 v17, v18, v19
    s_waitcnt vmcnt(20)
    v_cvt_pk_bf16_f32 v18, v20, v21
    s_waitcnt vmcnt(18)
    v_cvt_pk_bf16_f32 v19, v22, v23
    s_waitcnt vmcnt(16)
    v_cvt_pk_bf16_f32 v20, v24, v25
    s_waitcnt vmcnt(14)
    v_cvt_pk_bf16_f32 v21, v26, v27
    s_waitcnt vmcnt(12)
    v_cvt_pk_bf16_f32 v22, v28, v29
    s_waitcnt vmcnt(10)
    v_cvt_pk_bf16_f32 v23, v30, v31
    v_cndmask_b32 v16, v16, v236, s[80:81]
    v_cndmask_b32 v17, v17, v236, s[80:81]
    v_cndmask_b32 v18, v18, v236, s[80:81]
    v_cndmask_b32 v19, v19, v236, s[80:81]
    v_cndmask_b32 v20, v20, v236, s[80:81]
    v_cndmask_b32 v21, v21, v236, s[80:81]
    v_cndmask_b32 v22, v22, v236, s[80:81]
    v_cndmask_b32 v23, v23, v236, s[80:81]
    v_cndmask_b32 v22, v22, 0, s[60:61]
    v_cndmask_b32 v23, v23, 0, s[60:61]
    ds_write_b128 v237, v[16:19]
    ds_write_b128 v237, v[20:23] offset:1024
    v_readfirstlane_b32 s52, v13
    s_nop 1
    s_cmp_eq_u32 s52, 1
    s_cbranch_scc1 L_zok_19
    s_mov_b32 s91, 131072
L_zspin_20:
    buffer_load_dword v13, off, s[36:39], s87 sc1
    s_waitcnt vmcnt(0)
    v_readfirstlane_b32 s52, v13
    s_nop 1
    s_cmp_eq_u32 s52, 1
    s_cbranch_scc1 L_zok_19
    s_sub_u32 s91, s91, 1
    s_cmp_eq_u32 s91, 0
    s_cbranch_scc1 L_zok_19
    s_branch L_zspin_20
L_zok_19:
    buffer_load_dword v143, off, s[40:43], s76 sc1
    s_waitcnt lgkmcnt(0)
    s_barrier
    v_add_u32 v237, 140288, v11
    ds_read_b128 a[160:163], v237 offset:0
    ds_read_b128 a[164:167], v237 offset:1024
    ds_read_b128 a[168:171], v237 offset:2048
    ds_read_b128 a[172:175], v237 offset:3072
    ds_read_b128 a[176:179], v237 offset:4096
    ds_read_b128 a[180:183], v237 offset:5120
    ds_read_b128 a[184:187], v237 offset:6144
    ds_read_b128 a[188:191], v237 offset:7168
    s_waitcnt lgkmcnt(7)
    v_mfma_f32_32x32x16_bf16 v[16:31], a[160:163], v[144:147], 0
    s_waitcnt lgkmcnt(6)
    v_mfma_f32_32x32x16_bf16 v[16:31], a[164:167], v[148:151], v[16:31]
    s_waitcnt lgkmcnt(5)
    v_mfma_f32_32x32x16_bf16 v[32:47], a[168:171], v[48:51], 0
    s_waitcnt lgkmcnt(4)
    v_mfma_f32_32x32x16_bf16 v[32:47], a[172:175], v[52:55], v[32:47]
    s_waitcnt lgkmcnt(3)
    v_mfma_f32_32x32x16_bf16 v[80:95], a[176:179], v[152:155], 0
    s_waitcnt lgkmcnt(2)
    v_mfma_f32_32x32x16_bf16 v[80:95], a[180:183], v[156:159], v[80:95]
    s_waitcnt lgkmcnt(1)
    v_mfma_f32_32x32x16_bf16 v[96:111], a[184:187], v[64:67], 0
    s_waitcnt lgkmcnt(0)
    v_mfma_f32_32x32x16_bf16 v[96:111], a[188:191], v[68:71], v[96:111]
    v_mov_b32 v160, v28
    v_mov_b32 v164, v28
    v_mov_b32 v161, v29
    v_mov_b32 v165, v29
    v_mov_b32 v162, v44
    v_mov_b32 v166, v44
    v_mov_b32 v163, v45
    v_mov_b32 v167, v45
    v_permlane32_swap_b32 v160, v164
    v_permlane32_swap_b32 v161, v165
    v_permlane32_swap_b32 v162, v166
    v_permlane32_swap_b32 v163, v167
    v_mov_b32 v168, v92
    v_mov_b32 v172, v92
    v_mov_b32 v169, v93
    v_mov_b32 v173, v93
    v_mov_b32 v170, v108
    v_mov_b32 v174, v108
    v_mov_b32 v171, v109
    v_mov_b32 v175, v109
    v_permlane32_swap_b32 v168, v172
    v_permlane32_swap_b32 v169, v173
    v_permlane32_swap_b32 v170, v174
    v_permlane32_swap_b32 v171, v175
    v_rcp_f32 v165, v165
    v_rcp_f32 v167, v167
    v_rcp_f32 v173, v173
    v_rcp_f32 v175, v175
    v_mul_f32 v164, v164, v165
    v_fma_f32 v164, v166, v167, v164
    v_mul_f32_e64 v172, v172, v173
    v_fma_f32 v172, v174, v175, v172
    v_add_f32 v164, 0x358637bd, v164
    v_add_f32 v172, 0x358637bd, v172
    v_rcp_f32 v164, v164
    v_rcp_f32 v172, v172
    v_mul_f32 v165, v165, v164
    v_mul_f32 v167, v167, v164
    v_mul_f32 v173, v173, v172
    v_mul_f32 v175, v175, v172
    v_pk_mul_f32 v[16:17], v[16:17], v[164:165] op_sel:[0,1] op_sel_hi:[1,1]
    v_pk_mul_f32 v[18:19], v[18:19], v[164:165] op_sel:[0,1] op_sel_hi:[1,1]
    v_pk_mul_f32 v[20:21], v[20:21], v[164:165] op_sel:[0,1] op_sel_hi:[1,1]
    v_pk_mul_f32 v[22:23], v[22:23], v[164:165] op_sel:[0,1] op_sel_hi:[1,1]
    v_pk_mul_f32 v[24:25], v[24:25], v[164:165] op_sel:[0,1] op_sel_hi:[1,1]
    v_pk_mul_f32 v[26:27], v[26:27], v[164:165] op_sel:[0,1] op_sel_hi:[1,1]
    v_pk_mul_f32 v[28:29], v[28:29], v[164:165] op_sel:[0,1] op_sel_hi:[1,1]
    v_pk_mul_f32 v[30:31], v[30:31], v[164:165] op_sel:[0,1] op_sel_hi:[1,1]
    v_pk_fma_f32 v[16:17], v[32:33], v[166:167], v[16:17] op_sel:[0,1,0] op_sel_hi:[1,1,1]
    v_pk_fma_f32 v[18:19], v[34:35], v[166:167], v[18:19] op_sel:[0,1,0] op_sel_hi:[1,1,1]
    v_pk_fma_f32 v[20:21], v[36:37], v[166:167], v[20:21] op_sel:[0,1,0] op_sel_hi:[1,1,1]
    v_pk_fma_f32 v[22:23], v[38:39], v[166:167], v[22:23] op_sel:[0,1,0] op_sel_hi:[1,1,1]
    v_pk_fma_f32 v[24:25], v[40:41], v[166:167], v[24:25] op_sel:[0,1,0] op_sel_hi:[1,1,1]
    v_pk_fma_f32 v[26:27], v[42:43], v[166:167], v[26:27] op_sel:[0,1,0] op_sel_hi:[1,1,1]
    v_pk_fma_f32 v[28:29], v[44:45], v[166:167], v[28:29] op_sel:[0,1,0] op_sel_hi:[1,1,1]
    v_pk_fma_f32 v[30:31], v[46:47], v[166:167], v[30:31] op_sel:[0,1,0] op_sel_hi:[1,1,1]
    v_cvt_pk_bf16_f32 v16, v16, v17
    v_cvt_pk_bf16_f32 v17, v18, v19
    v_cvt_pk_bf16_f32 v18, v20, v21
    v_cvt_pk_bf16_f32 v19, v22, v23
    v_cvt_pk_bf16_f32 v20, v24, v25
    v_cvt_pk_bf16_f32 v21, v26, v27
    v_cvt_pk_bf16_f32 v22, v28, v29
    v_cvt_pk_bf16_f32 v23, v30, v31
    v_cndmask_b32 v22, v22, 0, s[60:61]
    v_cndmask_b32 v23, v23, 0, s[60:61]
    buffer_store_dwordx4 v[16:19], v11, s[40:43], s73 offen offset:0 sc1
    buffer_store_dwordx4 v[20:23], v11, s[40:43], s73 offen offset:1024 sc1
    v_pk_mul_f32 v[80:81], v[80:81], v[172:173] op_sel:[0,1] op_sel_hi:[1,1]
    v_pk_mul_f32 v[82:83], v[82:83], v[172:173] op_sel:[0,1] op_sel_hi:[1,1]
    v_pk_mul_f32 v[84:85], v[84:85], v[172:173] op_sel:[0,1] op_sel_hi:[1,1]
    v_pk_mul_f32 v[86:87], v[86:87], v[172:173] op_sel:[0,1] op_sel_hi:[1,1]
    v_pk_mul_f32 v[88:89], v[88:89], v[172:173] op_sel:[0,1] op_sel_hi:[1,1]
    v_pk_mul_f32 v[90:91], v[90:91], v[172:173] op_sel:[0,1] op_sel_hi:[1,1]
    v_pk_mul_f32 v[92:93], v[92:93], v[172:173] op_sel:[0,1] op_sel_hi:[1,1]
    v_pk_mul_f32 v[94:95], v[94:95], v[172:173] op_sel:[0,1] op_sel_hi:[1,1]
    v_pk_fma_f32 v[80:81], v[96:97], v[174:175], v[80:81] op_sel:[0,1,0] op_sel_hi:[1,1,1]
    v_pk_fma_f32 v[82:83], v[98:99], v[174:175], v[82:83] op_sel:[0,1,0] op_sel_hi:[1,1,1]
    v_pk_fma_f32 v[84:85], v[100:101], v[174:175], v[84:85] op_sel:[0,1,0] op_sel_hi:[1,1,1]
    v_pk_fma_f32 v[86:87], v[102:103], v[174:175], v[86:87] op_sel:[0,1,0] op_sel_hi:[1,1,1]
    v_pk_fma_f32 v[88:89], v[104:105], v[174:175], v[88:89] op_sel:[0,1,0] op_sel_hi:[1,1,1]
    v_pk_fma_f32 v[90:91], v[106:107], v[174:175], v[90:91] op_sel:[0,1,0] op_sel_hi:[1,1,1]
    v_pk_fma_f32 v[92:93], v[108:109], v[174:175], v[92:93] op_sel:[0,1,0] op_sel_hi:[1,1,1]
    v_pk_fma_f32 v[94:95], v[110:111], v[174:175], v[94:95] op_sel:[0,1,0] op_sel_hi:[1,1,1]
    v_cvt_pk_bf16_f32 v80, v80, v81
    v_cvt_pk_bf16_f32 v81, v82, v83
    v_cvt_pk_bf16_f32 v82, v84, v85
    v_cvt_pk_bf16_f32 v83, v86, v87
    v_cvt_pk_bf16_f32 v84, v88, v89
    v_cvt_pk_bf16_f32 v85, v90, v91
    v_cvt_pk_bf16_f32 v86, v92, v93
    v_cvt_pk_bf16_f32 v87, v94, v95
    v_cndmask_b32 v86, v86, 0, s[60:61]
    v_cndmask_b32 v87, v87, 0, s[60:61]
    buffer_store_dwordx4 v[80:83], v11, s[40:43], s73 offen offset:2048 sc1
    buffer_store_dwordx4 v[84:87], v11, s[40:43], s73 offen offset:3072 sc1
    s_waitcnt vmcnt(13)
    s_barrier
    s_cmp_lg_u32 s44, 0
    s_cbranch_scc1 L_nw0_21
    v_mov_b32 v253, 1
    s_mov_b64 exec, 1
    buffer_atomic_add v253, off, s[40:43], s75 sc1
    s_mov_b64 exec, -1
L_nw0_21:
    s_cmp_lg_u32 s46, 0
    s_cbranch_scc1 L_go_22
    s_waitcnt vmcnt(0)
    s_barrier
    s_cmp_lg_u32 s44, 0
    s_cbranch_scc1 L_nw0_23
    v_mov_b32 v253, 1
    s_mov_b64 exec, 1
    buffer_atomic_add v253, off, s[40:43], s88 sc1
    s_mov_b64 exec, -1
L_nw0_23:
    s_branch L_exit
L_go_22:
    v_add_u32 v7, 65536, v240
    v_add_u32 v8, 65536, v241
    s_waitcnt vmcnt(4)
    v_readfirstlane_b32 s52, v143
    s_nop 1
    s_cmp_eq_u32 s52, 8
    s_cbranch_scc1 L_cok_24
    s_mov_b32 s91, 131072
L_cspin_25:
    buffer_load_dword v143, off, s[40:43], s76 sc1
    s_waitcnt vmcnt(0)
    v_readfirstlane_b32 s52, v143
    s_nop 1
    s_cmp_eq_u32 s52, 8
    s_cbranch_scc1 L_cok_24
    s_sub_u32 s91, s91, 1
    s_cmp_eq_u32 s91, 0
    s_cbranch_scc1 L_cok_24
    s_branch L_cspin_25
L_cok_24:
    s_branch L_phase2
L_typeF:
    buffer_load_dwordx4 v[16:19], v141, s[4:7], s98 offen offset:0
    s_mul_i32 s51, s48, 384
    s_mul_i32 s50, s44, 57344
    s_add_u32 s64, s50, s51
    s_add_u32 s65, s64, 128
    s_add_u32 s67, s64, 256
    buffer_load_dwordx4 v[32:35], v141, s[4:7], s98 offen offset:128
    s_add_u32 s66, s67, s50
    s_lshl_b32 s50, s51, 5
    s_add_u32 s68, s68, s50
    s_add_u32 s69, s68, 4096
    s_add_u32 s70, s68, 8192
    v_lshrrev_b32_e64 v220, 5, v1
    buffer_load_dwordx4 v[48:51], v141, s[4:7], s98 offen offset:256
    v_bfe_u32 v222, v1, 2, 2
    v_lshl_add_u32 v220, v220, 3, v222
    v_bfe_u32 v221, v1, 4, 1
    v_and_b32 v223, 3, v1
    v_bfe_u32 v222, v1, 3, 1
    v_lshlrev_b32 v236, 7, v220
    buffer_load_dwordx4 v[64:67], v141, s[4:7], s98 offen offset:384
    v_lshl_add_u32 v236, v221, 13, v236
    v_lshl_add_u32 v236, v223, 3, v236
    v_lshl_or_b32 v237, v222, 1, v221
    v_xor_b32 v220, 0, v237
    v_lshl_add_u32 v192, v220, 5, v236
    v_xor_b32 v220, 1, v237
    buffer_load_dwordx4 v[80:83], v141, s[4:7], s98 offen offset:512
    v_lshl_add_u32 v193, v220, 5, v236
    v_xor_b32 v220, 2, v237
    v_lshl_add_u32 v194, v220, 5, v236
    v_xor_b32 v220, 3, v237
    v_lshl_add_u32 v195, v220, 5, v236
    buffer_load_dwordx4 v[96:99], v141, s[4:7], s98 offen offset:640
    v_add_u32 v196, 0x4000, v192
    v_add_u32 v197, 0x4000, v193
    v_add_u32 v198, 0x4000, v194
    v_add_u32 v199, 0x4000, v195
    v_lshrrev_b32_e64 v220, 5, v1
    v_bfe_u32 v222, v1, 2, 2
    buffer_load_dwordx4 v[112:115], v141, s[4:7], s98 offen offset:768
    v_lshl_add_u32 v220, v220, 3, v222
    v_bfe_u32 v221, v1, 4, 1
    v_and_b32 v223, 3, v1
    v_bfe_u32 v222, v1, 3, 1
    v_lshlrev_b32 v236, 6, v220
    v_lshl_add_u32 v236, v221, 13, v236
    buffer_load_dwordx4 v[20:23], v141, s[4:7], s99 offen offset:0
    v_lshl_add_u32 v236, v223, 3, v236
    v_xor_b32 v220, 0, v221
    v_lshl_add_u32 v200, v220, 5, v236
    v_xor_b32 v220, 1, v221
    v_lshl_add_u32 v201, v220, 5, v236
    v_add_u32 v204, 0x4000, v200
    buffer_load_dwordx4 v[36:39], v141, s[4:7], s99 offen offset:128
    v_add_u32 v205, 0x4000, v201
    s_sub_u32 s92, s46, 1
    s_max_i32 s92, s92, 0
    s_lshl_b32 s92, s92, 7
    s_lshl_b32 s91, s45, 7
    buffer_load_dwordx4 v[52:55], v141, s[4:7], s99 offen offset:256
    s_lshl_b32 s50, s47, 6
    s_add_u32 s91, s91, s50
    v_lshrrev_b32 v220, 3, v1
    v_and_b32 v221, 7, v1
    v_mul_u32_u24 v222, 896, v220
    v_bfe_u32 v223, v220, 1, 1
    buffer_load_dwordx4 v[68:71], v141, s[4:7], s99 offen offset:384
    v_lshlrev_b32 v223, 2, v223
    v_xor_b32 v223, v223, v221
    v_lshl_add_u32 v238, v223, 4, v222
    v_xor_b32 v223, v220, v221
    v_lshl_add_u32 v239, v223, 4, v222
    v_lshl_add_u32 v243, v221, 4, v222
    buffer_load_dwordx4 v[84:87], v141, s[4:7], s99 offen offset:512
    v_lshlrev_b32 v234, 7, v220
    v_lshl_add_u32 v234, v223, 4, v234
    s_add_u32 s50, s56, 123904
    v_add_u32 v248, s50, v234
    s_mul_i32 s3, s44, 344064
    s_add_u32 s3, s3, s92
    buffer_load_dwordx4 v[100:103], v141, s[4:7], s99 offen offset:640
    s_mul_i32 s49, s44, 57344
    s_add_u32 s49, s49, s92
    s_mul_i32 s59, s44, 7168
    s_add_u32 s59, s59, s92
    s_lshl_b32 s50, s44, 4
    buffer_load_dwordx4 v[116:119], v141, s[4:7], s99 offen offset:768
    s_add_u32 s50, s50, s91
    s_mul_i32 s93, s50, 896
    s_add_u32 s93, s93, s92
    v_lshrrev_b32 v220, 5, v1
    v_bfe_u32 v221, v1, 2, 2
    v_lshl_or_b32 v220, v220, 2, v221
    buffer_load_dwordx4 v[24:27], v141, s[4:7], s100 offen offset:0
    v_lshlrev_b32 v220, 7, v220
    v_bfe_u32 v221, v1, 4, 1
    v_lshl_add_u32 v220, v221, 5, v220
    v_and_b32 v221, 3, v1
    v_lshl_add_u32 v220, v221, 3, v220
    v_bfe_u32 v221, v1, 3, 1
    buffer_load_dwordx4 v[40:43], v141, s[4:7], s100 offen offset:128
    s_and_b32 s50, s44, 1
    v_xor_b32 v221, s50, v221
    v_lshl_add_u32 v222, v221, 6, v220
    v_add_u32 v240, s57, v222
    s_mul_i32 s51, s50, 28672
    s_add_u32 s51, s51, 0
    buffer_load_dwordx4 v[56:59], v141, s[4:7], s100 offen offset:256
    v_add_u32 v242, s51, v222
    v_xor_b32 v221, 1, v221
    v_lshl_add_u32 v222, v221, 6, v220
    v_add_u32_e64 v241, s57, v222
    v_add_u32 v244, 0x4000, v240
    buffer_load_dwordx4 v[72:75], v141, s[4:7], s100 offen offset:384
    v_add_u32 v245, 0x4000, v241
    s_mul_i32 s82, s44, 14336
    s_add_u32 s82, s82, 81920
    s_sub_u32 s50, s82, s57
    v_add_u32 v246, s50, v240
    v_add_u32 v247, s50, v241
    buffer_load_dwordx4 v[88:91], v141, s[4:7], s100 offen offset:512
    s_lshr_b32 s50, s44, 1
    s_lshl_b32 s51, s45, 2
    s_lshl_b32 s52, s47, 1
    s_add_u32 s51, s51, s52
    s_add_u32 s52, s51, s50
    s_mul_i32 s89, s52, 114688
    buffer_load_dwordx4 v[104:107], v141, s[4:7], s100 offen offset:640
    s_lshl_b32 s83, s52, 15
    s_add_u32 s83, s83, 7340032
    s_and_b32 s80, s44, 1
    s_lshl_b32 s80, s80, 14
    s_add_u32 s83, s83, s80
    s_xor_b32 s50, s50, 1
    buffer_load_dwordx4 v[120:123], v141, s[4:7], s100 offen offset:768
    s_add_u32 s52, s51, s50
    s_mul_i32 s90, s52, 114688
    s_lshl_b32 s50, s44, 12
    s_add_u32 s84, s89, s50
    s_add_u32 s85, s90, s50
    buffer_load_dwordx4 v[28:31], v141, s[4:7], s101 offen offset:0
    s_mul_i32 s50, s44, 24576
    s_add_u32 s89, s89, s50
    s_add_u32 s90, s90, s50
    s_xor_b32 s50, s44, 1
    s_mul_i32 s50, s50, 12288
    s_add_u32 s50, s50, 58368
    buffer_load_dwordx4 v[44:47], v141, s[4:7], s101 offen offset:128
    v_add_u32 v224, s50, v11
    s_xor_b32 s50, s44, 2
    s_mul_i32 s50, s50, 12288
    s_add_u32 s50, s50, 62464
    v_add_u32 v225, s50, v11
    s_xor_b32 s50, s44, 3
    buffer_load_dwordx4 v[60:63], v141, s[4:7], s101 offen offset:256
    s_mul_i32 s50, s50, 12288
    s_add_u32 s50, s50, 66560
    v_add_u32 v226, s50, v11
    s_mul_i32 s50, s44, 12288
    s_add_u32 s50, s50, 58368
    v_add_u32 v227, s50, v11
    buffer_load_dwordx4 v[76:79], v141, s[4:7], s101 offen offset:384
    v_and_b32 v220, 31, v1
    s_lshr_b32 s50, s44, 1
    s_lshl_b32 s50, s50, 5
    v_add_u32 v221, s50, v220
    v_lshlrev_b32 v222, 7, v221
    buffer_load_dwordx4 v[92:95], v141, s[4:7], s101 offen offset:512
    s_and_b32 s51, s44, 1
    s_lshl_b32 s51, s51, 2
    v_and_b32 v223, 7, v220
    v_xor_b32 v223, s51, v223
    v_lshl_add_u32 v222, v223, 4, v222
    v_lshrrev_b32 v223, 5, v1
    buffer_load_dwordx4 v[108:111], v141, s[4:7], s101 offen offset:640
    v_lshl_add_u32 v222, v223, 3, v222
    v_add_u32 v222, 123904, v222
    v_xor_b32 v228, 0, v222
    v_xor_b32 v229, 16, v222
    v_xor_b32 v230, 32, v222
    v_xor_b32 v231, 48, v222
    buffer_load_dwordx4 v[124:127], v141, s[4:7], s101 offen offset:768
    s_lshl_b32 s50, s47, 8
    s_add_u32 s50, s50, 163328
    v_lshlrev_b32 v221, 2, v221
    v_add_u32 v15, s50, v221
    s_mov_b32 s80, 0x20000000
    s_mov_b32 s81, 0x20000000
    s_waitcnt vmcnt(27)
    v_dot2_f32_bf16 v144, v16, s53, 0
    v_dot2_f32_bf16 v146, v16, v16, 0
    v_dot2_f32_bf16 v145, v17, s53, 0
    v_dot2_f32_bf16 v147, v17, v17, 0
    v_dot2_f32_bf16 v144, v18, s53, v144
    v_dot2_f32_bf16 v146, v18, v18, v146
    v_dot2_f32_bf16 v145, v19, s53, v145
    v_dot2_f32_bf16 v147, v19, v19, v147
    s_waitcnt vmcnt(26)
    v_dot2_f32_bf16 v144, v32, s53, v144
    v_dot2_f32_bf16 v146, v32, v32, v146
    v_dot2_f32_bf16 v145, v33, s53, v145
    v_dot2_f32_bf16 v147, v33, v33, v147
    v_dot2_f32_bf16 v144, v34, s53, v144
    v_dot2_f32_bf16 v146, v34, v34, v146
    v_dot2_f32_bf16 v145, v35, s53, v145
    v_dot2_f32_bf16 v147, v35, v35, v147
    s_waitcnt vmcnt(25)
    v_dot2_f32_bf16 v144, v48, s53, v144
    v_dot2_f32_bf16 v146, v48, v48, v146
    v_dot2_f32_bf16 v145, v49, s53, v145
    v_dot2_f32_bf16 v147, v49, v49, v147
    v_dot2_f32_bf16 v144, v50, s53, v144
    v_dot2_f32_bf16 v146, v50, v50, v146
    v_dot2_f32_bf16 v145, v51, s53, v145
    v_dot2_f32_bf16 v147, v51, v51, v147
    s_waitcnt vmcnt(24)
    v_dot2_f32_bf16 v144, v64, s53, v144
    v_dot2_f32_bf16 v146, v64, v64, v146
    v_dot2_f32_bf16 v145, v65, s53, v145
    v_dot2_f32_bf16 v147, v65, v65, v147
    v_dot2_f32_bf16 v144, v66, s53, v144
    v_dot2_f32_bf16 v146, v66, v66, v146
    v_dot2_f32_bf16 v145, v67, s53, v145
    v_dot2_f32_bf16 v147, v67, v67, v147
    s_waitcnt vmcnt(23)
    v_dot2_f32_bf16 v144, v80, s53, v144
    v_dot2_f32_bf16 v146, v80, v80, v146
    v_dot2_f32_bf16 v145, v81, s53, v145
    v_dot2_f32_bf16 v147, v81, v81, v147
    v_dot2_f32_bf16 v144, v82, s53, v144
    v_dot2_f32_bf16 v146, v82, v82, v146
    v_dot2_f32_bf16 v145, v83, s53, v145
    v_dot2_f32_bf16 v147, v83, v83, v147
    s_waitcnt vmcnt(22)
    v_dot2_f32_bf16 v144, v96, s53, v144
    v_dot2_f32_bf16 v146, v96, v96, v146
    v_dot2_f32_bf16 v145, v97, s53, v145
    v_dot2_f32_bf16 v147, v97, v97, v147
    v_dot2_f32_bf16 v144, v98, s53, v144
    v_dot2_f32_bf16 v146, v98, v98, v146
    v_dot2_f32_bf16 v145, v99, s53, v145
    v_dot2_f32_bf16 v147, v99, v99, v147
    s_waitcnt vmcnt(21)
    v_dot2_f32_bf16 v144, v112, s53, v144
    v_dot2_f32_bf16 v146, v112, v112, v146
    v_dot2_f32_bf16 v145, v113, s53, v145
    v_dot2_f32_bf16 v147, v113, v113, v147
    v_dot2_f32_bf16 v144, v114, s53, v144
    v_dot2_f32_bf16 v146, v114, v114, v146
    v_dot2_f32_bf16 v145, v115, s53, v145
    v_dot2_f32_bf16 v147, v115, v115, v147
    s_cmp_lg_u32 s48, 0
    s_cbranch_scc1 L_nz_26
    v_mov_b32_e64 v138, 0
    buffer_store_dword v138, off, s[40:43], s75 sc1
    s_add_u32 s51, s75, 4096
    buffer_store_dword v138, off, s[40:43], s51 sc1
    buffer_store_dword v138, off, s[40:43], s76 sc1
L_nz_26:
    s_add_u32 m0, s56, 0
    s_mov_b32 s71, s64
    buffer_load_dwordx4 v3, s[20:23], s71 offen lds
    s_add_u32 m0, s56, 1024
    s_add_u32 s71, s64, 28672
    buffer_load_dwordx4 v3, s[20:23], s71 offen lds
    s_add_u32 m0, s56, 8192
    s_mov_b32 s71, s64
    buffer_load_dwordx4 v4, s[24:27], s71 offen lds
    s_add_u32 m0, s56, 9216
    s_add_u32 s71, s64, 28672
    buffer_load_dwordx4 v4, s[24:27], s71 offen lds
    s_waitcnt vmcnt(24)
    v_dot2_f32_bf16 v148, v20, s53, 0
    v_dot2_f32_bf16 v150, v20, v20, 0
    v_dot2_f32_bf16 v149, v21, s53, 0
    v_add_f32_e64 v144, v144, v145
    v_dot2_f32_bf16 v151, v21, v21, 0
    v_dot2_f32_bf16 v148, v22, s53, v148
    v_add_f32 v146, v146, v147
    v_dot2_f32_bf16 v150, v22, v22, v150
    v_dot2_f32_bf16 v149, v23, s53, v149
    v_add_f32_dpp v144, v144, v144 quad_perm:[1,0,3,2] row_mask:0xf bank_mask:0xf
    v_dot2_f32_bf16 v151, v23, v23, v151
    s_waitcnt vmcnt(23)
    v_dot2_f32_bf16 v148, v36, s53, v148
    v_add_f32_dpp v146, v146, v146 quad_perm:[1,0,3,2] row_mask:0xf bank_mask:0xf
    v_dot2_f32_bf16 v150, v36, v36, v150
    v_dot2_f32_bf16 v149, v37, s53, v149
    v_add_f32_dpp v144, v144, v144 quad_perm:[2,3,0,1] row_mask:0xf bank_mask:0xf
    v_dot2_f32_bf16 v151, v37, v37, v151
    v_dot2_f32_bf16 v148, v38, s53, v148
    v_add_f32_dpp v146, v146, v146 quad_perm:[2,3,0,1] row_mask:0xf bank_mask:0xf
    v_dot2_f32_bf16 v150, v38, v38, v150
    v_dot2_f32_bf16 v149, v39, s53, v149
    v_add_f32_dpp v144, v144, v144 row_half_mirror row_mask:0xf bank_mask:0xf
    v_dot2_f32_bf16 v151, v39, v39, v151
    s_waitcnt vmcnt(22)
    v_dot2_f32_bf16 v148, v52, s53, v148
    v_add_f32_dpp v146, v146, v146 row_half_mirror row_mask:0xf bank_mask:0xf
    v_dot2_f32_bf16 v150, v52, v52, v150
    v_dot2_f32_bf16 v149, v53, s53, v149
    v_mul_f32 v145, 0x3b124925, v144
    v_dot2_f32_bf16 v151, v53, v53, v151
    v_dot2_f32_bf16 v148, v54, s53, v148
    v_mul_f32 v146, 0x3b124925, v146
    v_dot2_f32_bf16 v150, v54, v54, v150
    v_dot2_f32_bf16 v149, v55, s53, v149
    v_fmamk_f32 v144, v145, 0xc3e00000, v144
    v_dot2_f32_bf16 v151, v55, v55, v151
    s_waitcnt vmcnt(21)
    v_dot2_f32_bf16 v148, v68, s53, v148
    v_fmamk_f32 v144, v144, 0x3b124925, v145
    v_dot2_f32_bf16 v150, v68, v68, v150
    v_dot2_f32_bf16 v149, v69, s53, v149
    v_fma_f32 v146, -v144, v144, v146
    v_dot2_f32_bf16 v151, v69, v69, v151
    v_dot2_f32_bf16 v148, v70, s53, v148
    v_dot2_f32_bf16 v150, v70, v70, v150
    v_cvt_pk_bf16_f32 v144, 0, v144
    v_dot2_f32_bf16 v149, v71, s53, v149
    v_dot2_f32_bf16 v151, v71, v71, v151
    v_max_f32 v146, 0, v146
    s_waitcnt vmcnt(20)
    v_dot2_f32_bf16 v148, v84, s53, v148
    v_dot2_f32_bf16 v150, v84, v84, v150
    v_sub_f32_e64 v145, 0, v144
    v_dot2_f32_bf16 v149, v85, s53, v149
    v_dot2_f32_bf16 v151, v85, v85, v151
    v_cvt_pk_bf16_f32 v146, 0, v146
    v_dot2_f32_bf16 v148, v86, s53, v148
    v_dot2_f32_bf16 v150, v86, v86, v150
    v_add_f32 v146, 0x3727c5ac, v146
    v_dot2_f32_bf16 v149, v87, s53, v149
    v_dot2_f32_bf16 v151, v87, v87, v151
    v_cvt_pk_bf16_f32 v146, 0, v146
    s_waitcnt vmcnt(19)
    v_dot2_f32_bf16 v148, v100, s53, v148
    v_dot2_f32_bf16 v150, v100, v100, v150
    v_sqrt_f32_e64 v146, v146
    v_dot2_f32_bf16 v149, v101, s53, v149
    v_dot2_f32_bf16 v151, v101, v101, v151
    s_lshl_b32 s50, s94, 5
    v_dot2_f32_bf16 v148, v102, s53, v148
    v_dot2_f32_bf16 v150, v102, v102, v150
    v_cvt_pk_bf16_f32 v146, 0, v146
    v_dot2_f32_bf16 v149, v103, s53, v149
    v_dot2_f32_bf16 v151, v103, v103, v151
    v_add_u32 v136, s50, v129
    s_waitcnt vmcnt(18)
    v_dot2_f32_bf16 v148, v116, s53, v148
    v_dot2_f32_bf16 v150, v116, v116, v150
    v_rcp_f32_e64 v146, v146
    v_dot2_f32_bf16 v149, v117, s53, v149
    v_dot2_f32_bf16 v151, v117, v117, v151
    s_mul_i32 s50, s94, 7296
    v_dot2_f32_bf16 v148, v118, s53, v148
    v_dot2_f32_bf16 v150, v118, v118, v150
    v_add_u32_e64 v132, s50, v128
    v_dot2_f32_bf16 v149, v119, s53, v149
    v_dot2_f32_bf16 v151, v119, v119, v151
    ds_write_b32 v136, v146
    v_dot2_f32_bf16 v152, v16, s54, v145
    v_dot2_f32_bf16 v153, v16, s55, v145
    v_dot2_f32_bf16 v154, v17, s54, v145
    v_dot2_f32_bf16 v155, v17, s55, v145
    v_dot2_f32_bf16 v156, v18, s54, v145
    v_dot2_f32_bf16 v157, v18, s55, v145
    v_dot2_f32_bf16 v158, v19, s54, v145
    v_dot2_f32_bf16 v159, v19, s55, v145
    v_cvt_pk_bf16_f32 v16, v152, v153
    v_cvt_pk_bf16_f32 v17, v154, v155
    v_cvt_pk_bf16_f32 v18, v156, v157
    v_cvt_pk_bf16_f32 v19, v158, v159
    ds_write_b128 v132, v[16:19] offset:0
    v_dot2_f32_bf16 v152, v32, s54, v145
    v_dot2_f32_bf16 v153, v32, s55, v145
    v_dot2_f32_bf16 v154, v33, s54, v145
    v_dot2_f32_bf16 v155, v33, s55, v145
    v_dot2_f32_bf16 v156, v34, s54, v145
    v_dot2_f32_bf16 v157, v34, s55, v145
    s_add_u32 m0, s56, 16384
    s_add_u32 s71, s64, 229376
    buffer_load_dwordx4 v3, s[20:23], s71 offen lds
    v_dot2_f32_bf16 v158, v35, s54, v145
    v_dot2_f32_bf16 v159, v35, s55, v145
    v_cvt_pk_bf16_f32 v32, v152, v153
    v_cvt_pk_bf16_f32 v33, v154, v155
    v_cvt_pk_bf16_f32 v34, v156, v157
    v_cvt_pk_bf16_f32 v35, v158, v159
    ds_write_b128 v132, v[32:35] offset:128
    v_dot2_f32_bf16 v152, v48, s54, v145
    v_dot2_f32_bf16 v153, v48, s55, v145
    v_dot2_f32_bf16 v154, v49, s54, v145
    v_dot2_f32_bf16 v155, v49, s55, v145
    v_dot2_f32_bf16 v156, v50, s54, v145
    v_dot2_f32_bf16 v157, v50, s55, v145
    v_dot2_f32_bf16 v158, v51, s54, v145
    v_dot2_f32_bf16 v159, v51, s55, v145
    v_cvt_pk_bf16_f32 v48, v152, v153
    v_cvt_pk_bf16_f32 v49, v154, v155
    v_cvt_pk_bf16_f32 v50, v156, v157
    s_add_u32 m0, s56, 17408
    s_add_u32 s71, s64, 258048
    buffer_load_dwordx4 v3, s[20:23], s71 offen lds
    v_cvt_pk_bf16_f32 v51, v158, v159
    ds_write_b128 v132, v[48:51] offset:256
    v_dot2_f32_bf16 v152, v64, s54, v145
    v_dot2_f32_bf16 v153, v64, s55, v145
    v_dot2_f32_bf16 v154, v65, s54, v145
    v_dot2_f32_bf16 v155, v65, s55, v145
    v_dot2_f32_bf16 v156, v66, s54, v145
    v_dot2_f32_bf16 v157, v66, s55, v145
    v_dot2_f32_bf16 v158, v67, s54, v145
    v_dot2_f32_bf16 v159, v67, s55, v145
    v_cvt_pk_bf16_f32 v64, v152, v153
    v_cvt_pk_bf16_f32 v65, v154, v155
    v_cvt_pk_bf16_f32 v66, v156, v157
    v_cvt_pk_bf16_f32 v67, v158, v159
    ds_write_b128 v132, v[64:67] offset:384
    v_dot2_f32_bf16 v152, v80, s54, v145
    v_dot2_f32_bf16 v153, v80, s55, v145
    v_dot2_f32_bf16 v154, v81, s54, v145
    s_add_u32 m0, s56, 24576
    s_add_u32 s71, s64, 229376
    buffer_load_dwordx4 v4, s[24:27], s71 offen lds
    v_dot2_f32_bf16 v155, v81, s55, v145
    v_dot2_f32_bf16 v156, v82, s54, v145
    v_dot2_f32_bf16 v157, v82, s55, v145
    v_dot2_f32_bf16 v158, v83, s54, v145
    v_dot2_f32_bf16 v159, v83, s55, v145
    v_cvt_pk_bf16_f32 v80, v152, v153
    v_cvt_pk_bf16_f32 v81, v154, v155
    v_cvt_pk_bf16_f32 v82, v156, v157
    v_cvt_pk_bf16_f32 v83, v158, v159
    ds_write_b128 v132, v[80:83] offset:512
    v_dot2_f32_bf16 v152, v96, s54, v145
    v_dot2_f32_bf16 v153, v96, s55, v145
    v_dot2_f32_bf16 v154, v97, s54, v145
    v_dot2_f32_bf16 v155, v97, s55, v145
    v_dot2_f32_bf16 v156, v98, s54, v145
    v_dot2_f32_bf16 v157, v98, s55, v145
    v_dot2_f32_bf16 v158, v99, s54, v145
    v_dot2_f32_bf16 v159, v99, s55, v145
    s_add_u32 m0, s56, 25600
    s_add_u32 s71, s64, 258048
    buffer_load_dwordx4 v4, s[24:27], s71 offen lds
    v_cvt_pk_bf16_f32 v96, v152, v153
    v_cvt_pk_bf16_f32 v97, v154, v155
    v_cvt_pk_bf16_f32 v98, v156, v157
    v_cvt_pk_bf16_f32 v99, v158, v159
    ds_write_b128 v132, v[96:99] offset:640
    v_dot2_f32_bf16 v152, v112, s54, v145
    v_dot2_f32_bf16 v153, v112, s55, v145
    v_dot2_f32_bf16 v154, v113, s54, v145
    v_dot2_f32_bf16 v155, v113, s55, v145
    v_dot2_f32_bf16 v156, v114, s54, v145
    v_dot2_f32_bf16 v157, v114, s55, v145
    v_dot2_f32_bf16 v158, v115, s54, v145
    v_dot2_f32_bf16 v159, v115, s55, v145
    v_cvt_pk_bf16_f32 v112, v152, v153
    v_cvt_pk_bf16_f32 v113, v154, v155
    v_cvt_pk_bf16_f32 v114, v156, v157
    v_cvt_pk_bf16_f32 v115, v158, v159
    ds_write_b128 v132, v[112:115] offset:768
    s_cmp_lg_u32 s44, 0
    s_cbranch_scc1 L_wu_32
    v_min_u32 v143, 36, v1
    s_mul_i32 s51, s2, 37
    v_add_u32 v143, s51, v143
    v_lshlrev_b32 v143, 7, v143
    buffer_load_dword v252, v143, s[8:11], 0 offen
L_wu_32:
    s_cmp_lg_u32 s44, 1
    s_cbranch_scc1 L_wu_33
    v_min_u32 v143, 48, v1
    s_mul_i32 s51, s2, 49
    v_add_u32 v143, s51, v143
    v_lshlrev_b32 v143, 7, v143
    buffer_load_dword v252, v143, s[20:23], 0 offen
L_wu_33:
    s_cmp_lg_u32 s44, 2
    s_cbranch_scc1 L_wu_34
    v_min_u32 v143, 48, v1
    s_mul_i32 s51, s2, 49
    v_add_u32 v143, s51, v143
    v_lshlrev_b32 v143, 7, v143
    buffer_load_dword v252, v143, s[24:27], 0 offen
L_wu_34:
    s_waitcnt vmcnt(21)
    v_dot2_f32_bf16 v144, v24, s53, 0
    v_dot2_f32_bf16 v146, v24, v24, 0
    v_dot2_f32_bf16 v145, v25, s53, 0
    v_add_f32 v148, v148, v149
    v_dot2_f32_bf16 v147, v25, v25, 0
    v_dot2_f32_bf16 v144, v26, s53, v144
    v_add_f32 v150, v150, v151
    v_dot2_f32_bf16 v146, v26, v26, v146
    v_dot2_f32_bf16 v145, v27, s53, v145
    v_add_f32_dpp v148, v148, v148 quad_perm:[1,0,3,2] row_mask:0xf bank_mask:0xf
    v_dot2_f32_bf16 v147, v27, v27, v147
    s_waitcnt vmcnt(20)
    v_dot2_f32_bf16 v144, v40, s53, v144
    v_add_f32_dpp v150, v150, v150 quad_perm:[1,0,3,2] row_mask:0xf bank_mask:0xf
    v_dot2_f32_bf16 v146, v40, v40, v146
    v_dot2_f32_bf16 v145, v41, s53, v145
    v_add_f32_dpp v148, v148, v148 quad_perm:[2,3,0,1] row_mask:0xf bank_mask:0xf
    v_dot2_f32_bf16 v147, v41, v41, v147
    v_dot2_f32_bf16 v144, v42, s53, v144
    v_add_f32_dpp v150, v150, v150 quad_perm:[2,3,0,1] row_mask:0xf bank_mask:0xf
    v_dot2_f32_bf16 v146, v42, v42, v146
    v_dot2_f32_bf16 v145, v43, s53, v145
    v_add_f32_dpp v148, v148, v148 row_half_mirror row_mask:0xf bank_mask:0xf
    v_dot2_f32_bf16 v147, v43, v43, v147
    s_waitcnt vmcnt(19)
    v_dot2_f32_bf16 v144, v56, s53, v144
    v_add_f32_dpp v150, v150, v150 row_half_mirror row_mask:0xf bank_mask:0xf
    v_dot2_f32_bf16 v146, v56, v56, v146
    v_dot2_f32_bf16 v145, v57, s53, v145
    v_mul_f32 v149, 0x3b124925, v148
    v_dot2_f32_bf16 v147, v57, v57, v147
    v_dot2_f32_bf16 v144, v58, s53, v144
    v_mul_f32 v150, 0x3b124925, v150
    v_dot2_f32_bf16 v146, v58, v58, v146
    v_dot2_f32_bf16 v145, v59, s53, v145
    v_fmamk_f32 v148, v149, 0xc3e00000, v148
    v_dot2_f32_bf16 v147, v59, v59, v147
    s_waitcnt vmcnt(18)
    v_dot2_f32_bf16 v144, v72, s53, v144
    v_fmamk_f32 v148, v148, 0x3b124925, v149
    v_dot2_f32_bf16 v146, v72, v72, v146
    v_dot2_f32_bf16 v145, v73, s53, v145
    v_fma_f32 v150, -v148, v148, v150
    v_dot2_f32_bf16 v147, v73, v73, v147
    v_dot2_f32_bf16 v144, v74, s53, v144
    v_dot2_f32_bf16 v146, v74, v74, v146
    v_cvt_pk_bf16_f32 v148, 0, v148
    v_dot2_f32_bf16 v145, v75, s53, v145
    v_dot2_f32_bf16 v147, v75, v75, v147
    v_max_f32 v150, 0, v150
    s_waitcnt vmcnt(17)
    v_dot2_f32_bf16 v144, v88, s53, v144
    v_dot2_f32_bf16 v146, v88, v88, v146
    v_sub_f32_e64 v149, 0, v148
    v_dot2_f32_bf16 v145, v89, s53, v145
    v_dot2_f32_bf16 v147, v89, v89, v147
    v_cvt_pk_bf16_f32 v150, 0, v150
    v_dot2_f32_bf16 v144, v90, s53, v144
    v_dot2_f32_bf16 v146, v90, v90, v146
    v_add_f32 v150, 0x3727c5ac, v150
    v_dot2_f32_bf16 v145, v91, s53, v145
    v_dot2_f32_bf16 v147, v91, v91, v147
    v_cvt_pk_bf16_f32 v150, 0, v150
    s_waitcnt vmcnt(16)
    v_dot2_f32_bf16 v144, v104, s53, v144
    v_dot2_f32_bf16 v146, v104, v104, v146
    v_sqrt_f32_e64 v150, v150
    v_dot2_f32_bf16 v145, v105, s53, v145
    v_dot2_f32_bf16 v147, v105, v105, v147
    s_lshl_b32 s50, s95, 5
    v_dot2_f32_bf16 v144, v106, s53, v144
    v_dot2_f32_bf16 v146, v106, v106, v146
    v_cvt_pk_bf16_f32 v150, 0, v150
    v_dot2_f32_bf16 v145, v107, s53, v145
    v_dot2_f32_bf16 v147, v107, v107, v147
    v_add_u32 v136, s50, v129
    s_waitcnt vmcnt(15)
    v_dot2_f32_bf16 v144, v120, s53, v144
    v_dot2_f32_bf16 v146, v120, v120, v146
    v_rcp_f32_e64 v150, v150
    v_dot2_f32_bf16 v145, v121, s53, v145
    v_dot2_f32_bf16 v147, v121, v121, v147
    s_mul_i32 s50, s95, 7296
    v_dot2_f32_bf16 v144, v122, s53, v144
    v_dot2_f32_bf16 v146, v122, v122, v146
    v_add_u32_e64 v133, s50, v128
    v_dot2_f32_bf16 v145, v123, s53, v145
    v_dot2_f32_bf16 v147, v123, v123, v147
    ds_write_b32 v136, v150
    v_dot2_f32_bf16 v152, v20, s54, v149
    v_dot2_f32_bf16 v153, v20, s55, v149
    v_dot2_f32_bf16 v154, v21, s54, v149
    v_dot2_f32_bf16 v155, v21, s55, v149
    v_dot2_f32_bf16 v156, v22, s54, v149
    v_dot2_f32_bf16 v157, v22, s55, v149
    v_dot2_f32_bf16 v158, v23, s54, v149
    v_dot2_f32_bf16 v159, v23, s55, v149
    v_cvt_pk_bf16_f32 v20, v152, v153
    v_cvt_pk_bf16_f32 v21, v154, v155
    v_cvt_pk_bf16_f32 v22, v156, v157
    v_cvt_pk_bf16_f32 v23, v158, v159
    ds_write_b128 v133, v[20:23] offset:0
    v_dot2_f32_bf16 v152, v36, s54, v149
    v_dot2_f32_bf16 v153, v36, s55, v149
    v_dot2_f32_bf16 v154, v37, s54, v149
    v_dot2_f32_bf16 v155, v37, s55, v149
    v_dot2_f32_bf16 v156, v38, s54, v149
    v_dot2_f32_bf16 v157, v38, s55, v149
    v_dot2_f32_bf16 v158, v39, s54, v149
    v_dot2_f32_bf16 v159, v39, s55, v149
    v_cvt_pk_bf16_f32 v36, v152, v153
    v_cvt_pk_bf16_f32 v37, v154, v155
    v_cvt_pk_bf16_f32 v38, v156, v157
    v_cvt_pk_bf16_f32 v39, v158, v159
    ds_write_b128 v133, v[36:39] offset:128
    v_dot2_f32_bf16 v152, v52, s54, v149
    v_dot2_f32_bf16 v153, v52, s55, v149
    v_dot2_f32_bf16 v154, v53, s54, v149
    v_dot2_f32_bf16 v155, v53, s55, v149
    v_dot2_f32_bf16 v156, v54, s54, v149
    v_dot2_f32_bf16 v157, v54, s55, v149
    v_dot2_f32_bf16 v158, v55, s54, v149
    v_dot2_f32_bf16 v159, v55, s55, v149
    v_cvt_pk_bf16_f32 v52, v152, v153
    v_cvt_pk_bf16_f32 v53, v154, v155
    v_cvt_pk_bf16_f32 v54, v156, v157
    v_cvt_pk_bf16_f32 v55, v158, v159
    ds_write_b128 v133, v[52:55] offset:256
    v_dot2_f32_bf16 v152, v68, s54, v149
    v_dot2_f32_bf16 v153, v68, s55, v149
    v_dot2_f32_bf16 v154, v69, s54, v149
    v_dot2_f32_bf16 v155, v69, s55, v149
    v_dot2_f32_bf16 v156, v70, s54, v149
    v_dot2_f32_bf16 v157, v70, s55, v149
    v_dot2_f32_bf16 v158, v71, s54, v149
    v_dot2_f32_bf16 v159, v71, s55, v149
    v_cvt_pk_bf16_f32 v68, v152, v153
    v_cvt_pk_bf16_f32 v69, v154, v155
    v_cvt_pk_bf16_f32 v70, v156, v157
    v_cvt_pk_bf16_f32 v71, v158, v159
    ds_write_b128 v133, v[68:71] offset:384
    v_dot2_f32_bf16 v152, v84, s54, v149
    v_dot2_f32_bf16 v153, v84, s55, v149
    v_dot2_f32_bf16 v154, v85, s54, v149
    v_dot2_f32_bf16 v155, v85, s55, v149
    v_dot2_f32_bf16 v156, v86, s54, v149
    v_dot2_f32_bf16 v157, v86, s55, v149
    v_dot2_f32_bf16 v158, v87, s54, v149
    v_dot2_f32_bf16 v159, v87, s55, v149
    v_cvt_pk_bf16_f32 v84, v152, v153
    v_cvt_pk_bf16_f32 v85, v154, v155
    v_cvt_pk_bf16_f32 v86, v156, v157
    v_cvt_pk_bf16_f32 v87, v158, v159
    ds_write_b128 v133, v[84:87] offset:512
    v_dot2_f32_bf16 v152, v100, s54, v149
    v_dot2_f32_bf16 v153, v100, s55, v149
    v_dot2_f32_bf16 v154, v101, s54, v149
    v_dot2_f32_bf16 v155, v101, s55, v149
    v_dot2_f32_bf16 v156, v102, s54, v149
    v_dot2_f32_bf16 v157, v102, s55, v149
    v_dot2_f32_bf16 v158, v103, s54, v149
    v_dot2_f32_bf16 v159, v103, s55, v149
    v_cvt_pk_bf16_f32 v100, v152, v153
    v_cvt_pk_bf16_f32 v101, v154, v155
    v_cvt_pk_bf16_f32 v102, v156, v157
    v_cvt_pk_bf16_f32 v103, v158, v159
    ds_write_b128 v133, v[100:103] offset:640
    v_dot2_f32_bf16 v152, v116, s54, v149
    v_dot2_f32_bf16 v153, v116, s55, v149
    v_dot2_f32_bf16 v154, v117, s54, v149
    v_dot2_f32_bf16 v155, v117, s55, v149
    v_dot2_f32_bf16 v156, v118, s54, v149
    v_dot2_f32_bf16 v157, v118, s55, v149
    v_dot2_f32_bf16 v158, v119, s54, v149
    v_dot2_f32_bf16 v159, v119, s55, v149
    v_cvt_pk_bf16_f32 v116, v152, v153
    v_cvt_pk_bf16_f32 v117, v154, v155
    v_cvt_pk_bf16_f32 v118, v156, v157
    v_cvt_pk_bf16_f32 v119, v158, v159
    ds_write_b128 v133, v[116:119] offset:768
    s_waitcnt vmcnt(14)
    v_dot2_f32_bf16 v148, v28, s53, 0
    v_dot2_f32_bf16 v150, v28, v28, 0
    v_dot2_f32_bf16 v149, v29, s53, 0
    v_add_f32 v144, v144, v145
    v_dot2_f32_bf16 v151, v29, v29, 0
    v_dot2_f32_bf16 v148, v30, s53, v148
    v_add_f32 v146, v146, v147
    v_dot2_f32_bf16 v150, v30, v30, v150
    v_dot2_f32_bf16 v149, v31, s53, v149
    v_add_f32_dpp v144, v144, v144 quad_perm:[1,0,3,2] row_mask:0xf bank_mask:0xf
    v_dot2_f32_bf16 v151, v31, v31, v151
    s_waitcnt vmcnt(13)
    v_dot2_f32_bf16 v148, v44, s53, v148
    v_add_f32_dpp v146, v146, v146 quad_perm:[1,0,3,2] row_mask:0xf bank_mask:0xf
    v_dot2_f32_bf16 v150, v44, v44, v150
    v_dot2_f32_bf16 v149, v45, s53, v149
    v_add_f32_dpp v144, v144, v144 quad_perm:[2,3,0,1] row_mask:0xf bank_mask:0xf
    v_dot2_f32_bf16 v151, v45, v45, v151
    v_dot2_f32_bf16 v148, v46, s53, v148
    v_add_f32_dpp v146, v146, v146 quad_perm:[2,3,0,1] row_mask:0xf bank_mask:0xf
    v_dot2_f32_bf16 v150, v46, v46, v150
    v_dot2_f32_bf16 v149, v47, s53, v149
    v_add_f32_dpp v144, v144, v144 row_half_mirror row_mask:0xf bank_mask:0xf
    v_dot2_f32_bf16 v151, v47, v47, v151
    s_waitcnt vmcnt(12)
    v_dot2_f32_bf16 v148, v60, s53, v148
    v_add_f32_dpp v146, v146, v146 row_half_mirror row_mask:0xf bank_mask:0xf
    v_dot2_f32_bf16 v150, v60, v60, v150
    v_dot2_f32_bf16 v149, v61, s53, v149
    v_mul_f32 v145, 0x3b124925, v144
    v_dot2_f32_bf16 v151, v61, v61, v151
    v_dot2_f32_bf16 v148, v62, s53, v148
    v_mul_f32 v146, 0x3b124925, v146
    v_dot2_f32_bf16 v150, v62, v62, v150
    v_dot2_f32_bf16 v149, v63, s53, v149
    v_fmamk_f32 v144, v145, 0xc3e00000, v144
    v_dot2_f32_bf16 v151, v63, v63, v151
    s_waitcnt vmcnt(11)
    v_dot2_f32_bf16 v148, v76, s53, v148
    v_fmamk_f32 v144, v144, 0x3b124925, v145
    v_dot2_f32_bf16 v150, v76, v76, v150
    v_dot2_f32_bf16 v149, v77, s53, v149
    v_fma_f32 v146, -v144, v144, v146
    v_dot2_f32_bf16 v151, v77, v77, v151
    v_dot2_f32_bf16 v148, v78, s53, v148
    v_dot2_f32_bf16 v150, v78, v78, v150
    v_cvt_pk_bf16_f32 v144, 0, v144
    v_dot2_f32_bf16 v149, v79, s53, v149
    v_dot2_f32_bf16 v151, v79, v79, v151
    v_max_f32 v146, 0, v146
    s_waitcnt vmcnt(10)
    v_dot2_f32_bf16 v148, v92, s53, v148
    v_dot2_f32_bf16 v150, v92, v92, v150
    v_sub_f32_e64 v145, 0, v144
    v_dot2_f32_bf16 v149, v93, s53, v149
    v_dot2_f32_bf16 v151, v93, v93, v151
    v_cvt_pk_bf16_f32 v146, 0, v146
    v_dot2_f32_bf16 v148, v94, s53, v148
    v_dot2_f32_bf16 v150, v94, v94, v150
    v_add_f32 v146, 0x3727c5ac, v146
    v_dot2_f32_bf16 v149, v95, s53, v149
    v_dot2_f32_bf16 v151, v95, v95, v151
    v_cvt_pk_bf16_f32 v146, 0, v146
    s_waitcnt vmcnt(9)
    v_dot2_f32_bf16 v148, v108, s53, v148
    v_dot2_f32_bf16 v150, v108, v108, v150
    v_sqrt_f32_e64 v146, v146
    v_dot2_f32_bf16 v149, v109, s53, v149
    v_dot2_f32_bf16 v151, v109, v109, v151
    s_lshl_b32 s50, s96, 5
    v_dot2_f32_bf16 v148, v110, s53, v148
    v_dot2_f32_bf16 v150, v110, v110, v150
    v_cvt_pk_bf16_f32 v146, 0, v146
    v_dot2_f32_bf16 v149, v111, s53, v149
    v_dot2_f32_bf16 v151, v111, v111, v151
    v_add_u32 v136, s50, v129
    s_waitcnt vmcnt(8)
    v_dot2_f32_bf16 v148, v124, s53, v148
    v_dot2_f32_bf16 v150, v124, v124, v150
    v_rcp_f32_e64 v146, v146
    v_dot2_f32_bf16 v149, v125, s53, v149
    v_dot2_f32_bf16 v151, v125, v125, v151
    s_mul_i32 s50, s96, 7296
    v_dot2_f32_bf16 v148, v126, s53, v148
    v_dot2_f32_bf16 v150, v126, v126, v150
    v_add_u32_e64 v134, s50, v128
    v_dot2_f32_bf16 v149, v127, s53, v149
    v_dot2_f32_bf16 v151, v127, v127, v151
    ds_write_b32 v136, v146
    v_dot2_f32_bf16 v152, v24, s54, v145
    v_dot2_f32_bf16 v153, v24, s55, v145
    v_dot2_f32_bf16 v154, v25, s54, v145
    v_dot2_f32_bf16 v155, v25, s55, v145
    v_dot2_f32_bf16 v156, v26, s54, v145
    v_dot2_f32_bf16 v157, v26, s55, v145
    v_dot2_f32_bf16 v158, v27, s54, v145
    v_dot2_f32_bf16 v159, v27, s55, v145
    v_cvt_pk_bf16_f32 v24, v152, v153
    v_cvt_pk_bf16_f32 v25, v154, v155
    v_cvt_pk_bf16_f32 v26, v156, v157
    v_cvt_pk_bf16_f32 v27, v158, v159
    ds_write_b128 v134, v[24:27] offset:0
    v_dot2_f32_bf16 v152, v40, s54, v145
    v_dot2_f32_bf16 v153, v40, s55, v145
    v_dot2_f32_bf16 v154, v41, s54, v145
    v_dot2_f32_bf16 v155, v41, s55, v145
    v_dot2_f32_bf16 v156, v42, s54, v145
    v_dot2_f32_bf16 v157, v42, s55, v145
    v_dot2_f32_bf16 v158, v43, s54, v145
    v_dot2_f32_bf16 v159, v43, s55, v145
    v_cvt_pk_bf16_f32 v40, v152, v153
    v_cvt_pk_bf16_f32 v41, v154, v155
    v_cvt_pk_bf16_f32 v42, v156, v157
    v_cvt_pk_bf16_f32 v43, v158, v159
    ds_write_b128 v134, v[40:43] offset:128
    v_dot2_f32_bf16 v152, v56, s54, v145
    v_dot2_f32_bf16 v153, v56, s55, v145
    v_dot2_f32_bf16 v154, v57, s54, v145
    v_dot2_f32_bf16 v155, v57, s55, v145
    v_dot2_f32_bf16 v156, v58, s54, v145
    v_dot2_f32_bf16 v157, v58, s55, v145
    v_dot2_f32_bf16 v158, v59, s54, v145
    v_dot2_f32_bf16 v159, v59, s55, v145
    v_cvt_pk_bf16_f32 v56, v152, v153
    v_cvt_pk_bf16_f32 v57, v154, v155
    v_cvt_pk_bf16_f32 v58, v156, v157
    v_cvt_pk_bf16_f32 v59, v158, v159
    ds_write_b128 v134, v[56:59] offset:256
    v_dot2_f32_bf16 v152, v72, s54, v145
    v_dot2_f32_bf16 v153, v72, s55, v145
    v_dot2_f32_bf16 v154, v73, s54, v145
    v_dot2_f32_bf16 v155, v73, s55, v145
    v_dot2_f32_bf16 v156, v74, s54, v145
    v_dot2_f32_bf16 v157, v74, s55, v145
    v_dot2_f32_bf16 v158, v75, s54, v145
    v_dot2_f32_bf16 v159, v75, s55, v145
    v_cvt_pk_bf16_f32 v72, v152, v153
    v_cvt_pk_bf16_f32 v73, v154, v155
    v_cvt_pk_bf16_f32 v74, v156, v157
    v_cvt_pk_bf16_f32 v75, v158, v159
    ds_write_b128 v134, v[72:75] offset:384
    v_dot2_f32_bf16 v152, v88, s54, v145
    v_dot2_f32_bf16 v153, v88, s55, v145
    v_dot2_f32_bf16 v154, v89, s54, v145
    v_dot2_f32_bf16 v155, v89, s55, v145
    v_dot2_f32_bf16 v156, v90, s54, v145
    v_dot2_f32_bf16 v157, v90, s55, v145
    v_dot2_f32_bf16 v158, v91, s54, v145
    v_dot2_f32_bf16 v159, v91, s55, v145
    v_cvt_pk_bf16_f32 v88, v152, v153
    v_cvt_pk_bf16_f32 v89, v154, v155
    v_cvt_pk_bf16_f32 v90, v156, v157
    v_cvt_pk_bf16_f32 v91, v158, v159
    ds_write_b128 v134, v[88:91] offset:512
    v_dot2_f32_bf16 v152, v104, s54, v145
    v_dot2_f32_bf16 v153, v104, s55, v145
    v_dot2_f32_bf16 v154, v105, s54, v145
    v_dot2_f32_bf16 v155, v105, s55, v145
    v_dot2_f32_bf16 v156, v106, s54, v145
    v_dot2_f32_bf16 v157, v106, s55, v145
    v_dot2_f32_bf16 v158, v107, s54, v145
    v_dot2_f32_bf16 v159, v107, s55, v145
    v_cvt_pk_bf16_f32 v104, v152, v153
    v_cvt_pk_bf16_f32 v105, v154, v155
    v_cvt_pk_bf16_f32 v106, v156, v157
    v_cvt_pk_bf16_f32 v107, v158, v159
    ds_write_b128 v134, v[104:107] offset:640
    v_dot2_f32_bf16 v152, v120, s54, v145
    v_dot2_f32_bf16 v153, v120, s55, v145
    v_dot2_f32_bf16 v154, v121, s54, v145
    v_dot2_f32_bf16 v155, v121, s55, v145
    v_dot2_f32_bf16 v156, v122, s54, v145
    v_dot2_f32_bf16 v157, v122, s55, v145
    v_dot2_f32_bf16 v158, v123, s54, v145
    v_dot2_f32_bf16 v159, v123, s55, v145
    v_cvt_pk_bf16_f32 v120, v152, v153
    v_cvt_pk_bf16_f32 v121, v154, v155
    v_cvt_pk_bf16_f32 v122, v156, v157
    v_cvt_pk_bf16_f32 v123, v158, v159
    ds_write_b128 v134, v[120:123] offset:768
    s_cmp_lg_u32 s44, 3
    s_cbranch_scc1 L_wu_35
    v_min_u32 v143, 48, v1
    s_mul_i32 s51, s2, 49
    v_add_u32 v143, s51, v143
    v_lshlrev_b32 v143, 7, v143
    buffer_load_dword v252, v143, s[28:31], 0 offen
L_wu_35:
    s_cmp_lg_u32 s44, 0
    s_cbranch_scc1 L_wu_36
    v_min_u32 v143, 12, v1
    s_mul_i32 s51, s2, 13
    v_add_u32 v143, s51, v143
    v_lshlrev_b32 v143, 7, v143
    buffer_load_dword v252, v143, s[16:19], 0 offen
L_wu_36:
    v_add_f32_e64 v148, v148, v149
    v_add_f32 v150, v150, v151
    s_nop 0
    v_add_f32_dpp v148, v148, v148 quad_perm:[1,0,3,2] row_mask:0xf bank_mask:0xf
    v_add_f32_dpp v150, v150, v150 quad_perm:[1,0,3,2] row_mask:0xf bank_mask:0xf
    s_nop 0
    v_add_f32_dpp v148, v148, v148 quad_perm:[2,3,0,1] row_mask:0xf bank_mask:0xf
    v_add_f32_dpp v150, v150, v150 quad_perm:[2,3,0,1] row_mask:0xf bank_mask:0xf
    s_nop 0
    v_add_f32_dpp v148, v148, v148 row_half_mirror row_mask:0xf bank_mask:0xf
    v_add_f32_dpp v150, v150, v150 row_half_mirror row_mask:0xf bank_mask:0xf
    v_mul_f32 v149, 0x3b124925, v148
    v_mul_f32 v150, 0x3b124925, v150
    v_fmamk_f32 v148, v149, 0xc3e00000, v148
    v_fmamk_f32 v148, v148, 0x3b124925, v149
    v_fma_f32 v150, -v148, v148, v150
    v_cvt_pk_bf16_f32 v148, 0, v148
    v_max_f32 v150, 0, v150
    v_sub_f32 v149, 0, v148
    v_cvt_pk_bf16_f32 v150, 0, v150
    v_add_f32 v150, 0x3727c5ac, v150
    v_cvt_pk_bf16_f32 v150, 0, v150
    v_sqrt_f32 v150, v150
    s_lshl_b32 s50, s97, 5
    v_cvt_pk_bf16_f32 v150, 0, v150
    v_add_u32 v136, s50, v129
    v_rcp_f32 v150, v150
    s_mul_i32 s50, s97, 7296
    v_add_u32_e64 v135, s50, v128
    ds_write_b32 v136, v150
    v_dot2_f32_bf16 v152, v28, s54, v149
    v_dot2_f32_bf16 v153, v28, s55, v149
    v_dot2_f32_bf16 v154, v29, s54, v149
    v_dot2_f32_bf16 v155, v29, s55, v149
    v_dot2_f32_bf16 v156, v30, s54, v149
    v_dot2_f32_bf16 v157, v30, s55, v149
    v_dot2_f32_bf16 v158, v31, s54, v149
    v_dot2_f32_bf16 v159, v31, s55, v149
    v_cvt_pk_bf16_f32 v28, v152, v153
    v_cvt_pk_bf16_f32 v29, v154, v155
    v_cvt_pk_bf16_f32 v30, v156, v157
    v_cvt_pk_bf16_f32 v31, v158, v159
    ds_write_b128 v135, v[28:31] offset:0
    v_dot2_f32_bf16 v152, v44, s54, v149
    v_dot2_f32_bf16 v153, v44, s55, v149
    v_dot2_f32_bf16 v154, v45, s54, v149
    v_dot2_f32_bf16 v155, v45, s55, v149
    v_dot2_f32_bf16 v156, v46, s54, v149
    v_dot2_f32_bf16 v157, v46, s55, v149
    v_dot2_f32_bf16 v158, v47, s54, v149
    v_dot2_f32_bf16 v159, v47, s55, v149
    v_cvt_pk_bf16_f32 v44, v152, v153
    v_cvt_pk_bf16_f32 v45, v154, v155
    v_cvt_pk_bf16_f32 v46, v156, v157
    v_cvt_pk_bf16_f32 v47, v158, v159
    ds_write_b128 v135, v[44:47] offset:128
    v_dot2_f32_bf16 v152, v60, s54, v149
    v_dot2_f32_bf16 v153, v60, s55, v149
    v_dot2_f32_bf16 v154, v61, s54, v149
    v_dot2_f32_bf16 v155, v61, s55, v149
    v_dot2_f32_bf16 v156, v62, s54, v149
    v_dot2_f32_bf16 v157, v62, s55, v149
    v_dot2_f32_bf16 v158, v63, s54, v149
    v_dot2_f32_bf16 v159, v63, s55, v149
    v_cvt_pk_bf16_f32 v60, v152, v153
    v_cvt_pk_bf16_f32 v61, v154, v155
    v_cvt_pk_bf16_f32 v62, v156, v157
    v_cvt_pk_bf16_f32 v63, v158, v159
    ds_write_b128 v135, v[60:63] offset:256
    v_dot2_f32_bf16 v152, v76, s54, v149
    v_dot2_f32_bf16 v153, v76, s55, v149
    v_dot2_f32_bf16 v154, v77, s54, v149
    v_dot2_f32_bf16 v155, v77, s55, v149
    v_dot2_f32_bf16 v156, v78, s54, v149
    v_dot2_f32_bf16 v157, v78, s55, v149
    v_dot2_f32_bf16 v158, v79, s54, v149
    v_dot2_f32_bf16 v159, v79, s55, v149
    v_cvt_pk_bf16_f32 v76, v152, v153
    v_cvt_pk_bf16_f32 v77, v154, v155
    v_cvt_pk_bf16_f32 v78, v156, v157
    v_cvt_pk_bf16_f32 v79, v158, v159
    ds_write_b128 v135, v[76:79] offset:384
    v_dot2_f32_bf16 v152, v92, s54, v149
    v_dot2_f32_bf16 v153, v92, s55, v149
    v_dot2_f32_bf16 v154, v93, s54, v149
    v_dot2_f32_bf16 v155, v93, s55, v149
    v_dot2_f32_bf16 v156, v94, s54, v149
    v_dot2_f32_bf16 v157, v94, s55, v149
    v_dot2_f32_bf16 v158, v95, s54, v149
    v_dot2_f32_bf16 v159, v95, s55, v149
    v_cvt_pk_bf16_f32 v92, v152, v153
    v_cvt_pk_bf16_f32 v93, v154, v155
    v_cvt_pk_bf16_f32 v94, v156, v157
    v_cvt_pk_bf16_f32 v95, v158, v159
    ds_write_b128 v135, v[92:95] offset:512
    v_dot2_f32_bf16 v152, v108, s54, v149
    v_dot2_f32_bf16 v153, v108, s55, v149
    v_dot2_f32_bf16 v154, v109, s54, v149
    v_dot2_f32_bf16 v155, v109, s55, v149
    v_dot2_f32_bf16 v156, v110, s54, v149
    v_dot2_f32_bf16 v157, v110, s55, v149
    v_dot2_f32_bf16 v158, v111, s54, v149
    v_dot2_f32_bf16 v159, v111, s55, v149
    v_cvt_pk_bf16_f32 v108, v152, v153
    v_cvt_pk_bf16_f32 v109, v154, v155
    v_cvt_pk_bf16_f32 v110, v156, v157
    v_cvt_pk_bf16_f32 v111, v158, v159
    ds_write_b128 v135, v[108:111] offset:640
    v_dot2_f32_bf16 v152, v124, s54, v149
    v_dot2_f32_bf16 v153, v124, s55, v149
    v_dot2_f32_bf16 v154, v125, s54, v149
    v_dot2_f32_bf16 v155, v125, s55, v149
    v_dot2_f32_bf16 v156, v126, s54, v149
    v_dot2_f32_bf16 v157, v126, s55, v149
    v_dot2_f32_bf16 v158, v127, s54, v149
    v_dot2_f32_bf16 v159, v127, s55, v149
    v_cvt_pk_bf16_f32 v124, v152, v153
    v_cvt_pk_bf16_f32 v125, v154, v155
    v_cvt_pk_bf16_f32 v126, v156, v157
    v_cvt_pk_bf16_f32 v127, v158, v159
    ds_write_b128 v135, v[124:127] offset:768
    ds_read_b128 a[0:3], v130 offset:0
    ds_read_b128 a[4:7], v130 offset:32
    ds_read_b128 a[8:11], v130 offset:64
    ds_read_b128 a[12:15], v130 offset:96
    ds_read_b128 a[16:19], v130 offset:128
    ds_read_b128 a[20:23], v130 offset:160
    ds_read_b128 a[24:27], v130 offset:192
    ds_read_b128 a[28:31], v130 offset:224
    ds_read_b128 a[32:35], v130 offset:256
    ds_read_b128 a[36:39], v130 offset:288
    ds_read_b128 a[40:43], v130 offset:320
    ds_read_b128 a[44:47], v130 offset:352
    ds_read_b128 a[48:51], v130 offset:384
    ds_read_b128 a[52:55], v130 offset:416
    ds_read_b128 a[56:59], v130 offset:448
    ds_read_b128 a[60:63], v130 offset:480
    ds_read_b128 a[64:67], v130 offset:512
    ds_read_b128 a[68:71], v130 offset:544
    ds_read_b128 a[72:75], v130 offset:576
    ds_read_b128 a[76:79], v130 offset:608
    ds_read_b128 a[80:83], v130 offset:640
    ds_read_b128 a[84:87], v130 offset:672
    ds_read_b128 a[88:91], v130 offset:704
    ds_read_b128 a[92:95], v130 offset:736
    ds_read_b128 a[96:99], v130 offset:768
    ds_read_b128 a[100:103], v130 offset:800
    ds_read_b128 a[104:107], v130 offset:832
    ds_read_b128 a[108:111], v130 offset:864
    ds_read_b32 v7, v131
    s_waitcnt lgkmcnt(0)
    v_mul_f32 v8, 0xbfb8aa3b, v7
    v_mul_f32 v9, 0x3fb8aa3b, v7
    s_waitcnt vmcnt(4)
    s_barrier
    s_cmp_lg_u32 s48, 0
    s_cbranch_scc1 L_nzf_37
    s_cmp_lg_u32 s44, 0
    s_cbranch_scc1 L_nzf_37
    v_mov_b32 v138, 1
    buffer_store_dword v138, off, s[36:39], s87 sc1
L_nzf_37:
    ds_read_b64_tr_b16 a[112:113], v192 offset:0
    ds_read_b64_tr_b16 a[114:115], v192 offset:512
    ds_read_b64_tr_b16 a[116:117], v193 offset:0
    ds_read_b64_tr_b16 a[118:119], v193 offset:512
    ds_read_b64_tr_b16 a[120:121], v194 offset:0
    ds_read_b64_tr_b16 a[122:123], v194 offset:512
    ds_read_b64_tr_b16 a[124:125], v195 offset:0
    ds_read_b64_tr_b16 a[126:127], v195 offset:512
    ds_read_b64_tr_b16 a[128:129], v192 offset:2048
    ds_read_b64_tr_b16 a[130:131], v192 offset:2560
    ds_read_b64_tr_b16 a[132:133], v193 offset:2048
    ds_read_b64_tr_b16 a[134:135], v193 offset:2560
    s_waitcnt lgkmcnt(8)
    v_mfma_f32_32x32x16_bf16 v[16:31], a[112:115], a[0:3], 0
    ds_read_b64_tr_b16 a[136:137], v194 offset:2048
    ds_read_b64_tr_b16 a[138:139], v194 offset:2560
    s_add_u32 m0, s56, 32768
    s_add_u32 s71, s64, 458752
    buffer_load_dwordx4 v3, s[20:23], s71 offen lds
    v_mfma_f32_32x32x16_bf16 v[32:47], a[116:119], a[0:3], 0
    ds_read_b64_tr_b16 a[140:141], v195 offset:2048
    ds_read_b64_tr_b16 a[142:143], v195 offset:2560
    s_add_u32 m0, s56, 33792
    s_add_u32 s71, s64, 487424
    buffer_load_dwordx4 v3, s[20:23], s71 offen lds
    s_waitcnt lgkmcnt(8)
    v_mfma_f32_32x32x16_bf16 v[48:63], a[120:123], a[0:3], 0
    ds_read_b64_tr_b16 a[224:225], v192 offset:4096
    ds_read_b64_tr_b16 a[226:227], v192 offset:4608
    s_add_u32 m0, s56, 40960
    s_add_u32 s71, s64, 458752
    buffer_load_dwordx4 v4, s[24:27], s71 offen lds
    v_mfma_f32_32x32x16_bf16 v[64:79], a[124:127], a[0:3], 0
    ds_read_b64_tr_b16 a[228:229], v193 offset:4096
    ds_read_b64_tr_b16 a[230:231], v193 offset:4608
    s_add_u32 m0, s56, 41984
    s_add_u32 s71, s64, 487424
    buffer_load_dwordx4 v4, s[24:27], s71 offen lds
    s_waitcnt lgkmcnt(8)
    v_mfma_f32_32x32x16_bf16 v[16:31], a[128:131], a[4:7], v[16:31]
    ds_read_b64_tr_b16 a[232:233], v194 offset:4096
    ds_read_b64_tr_b16 a[234:235], v194 offset:4608
    s_add_u32 m0, s56, 49152
    s_add_u32 s71, s64, 688128
    buffer_load_dwordx4 v3, s[20:23], s71 offen lds
    v_mfma_f32_32x32x16_bf16 v[32:47], a[132:135], a[4:7], v[32:47]
    ds_read_b64_tr_b16 a[236:237], v195 offset:4096
    ds_read_b64_tr_b16 a[238:239], v195 offset:4608
    s_add_u32 m0, s56, 50176
    s_add_u32 s71, s64, 716800
    buffer_load_dwordx4 v3, s[20:23], s71 offen lds
    s_waitcnt lgkmcnt(8)
    v_mfma_f32_32x32x16_bf16 v[48:63], a[136:139], a[4:7], v[48:63]
    ds_read_b64_tr_b16 a[112:113], v192 offset:6144
    ds_read_b64_tr_b16 a[114:115], v192 offset:6656
    s_add_u32 m0, s56, 57344
    s_add_u32 s71, s64, 688128
    buffer_load_dwordx4 v4, s[24:27], s71 offen lds
    v_mfma_f32_32x32x16_bf16 v[64:79], a[140:143], a[4:7], v[64:79]
    ds_read_b64_tr_b16 a[116:117], v193 offset:6144
    ds_read_b64_tr_b16 a[118:119], v193 offset:6656
    s_add_u32 m0, s56, 58368
    s_add_u32 s71, s64, 716800
    buffer_load_dwordx4 v4, s[24:27], s71 offen lds
    s_waitcnt lgkmcnt(8)
    v_mfma_f32_32x32x16_bf16 v[16:31], a[224:227], a[8:11], v[16:31]
    ds_read_b64_tr_b16 a[120:121], v194 offset:6144
    ds_read_b64_tr_b16 a[122:123], v194 offset:6656
    s_add_u32 m0, s56, 65536
    s_add_u32 s71, s64, 917504
    buffer_load_dwordx4 v3, s[20:23], s71 offen lds
    v_mfma_f32_32x32x16_bf16 v[32:47], a[228:231], a[8:11], v[32:47]
    ds_read_b64_tr_b16 a[124:125], v195 offset:6144
    ds_read_b64_tr_b16 a[126:127], v195 offset:6656
    s_add_u32 m0, s56, 66560
    s_add_u32 s71, s64, 946176
    buffer_load_dwordx4 v3, s[20:23], s71 offen lds
    s_waitcnt lgkmcnt(8)
    v_mfma_f32_32x32x16_bf16 v[48:63], a[232:235], a[8:11], v[48:63]
    s_waitcnt vmcnt(10)
    s_barrier
    ds_read_b64_tr_b16 a[128:129], v192 offset:16384
    ds_read_b64_tr_b16 a[130:131], v192 offset:16896
    s_add_u32 m0, s56, 73728
    s_add_u32 s71, s64, 917504
    buffer_load_dwordx4 v4, s[24:27], s71 offen lds
    v_mfma_f32_32x32x16_bf16 v[64:79], a[236:239], a[8:11], v[64:79]
    ds_read_b64_tr_b16 a[132:133], v193 offset:16384
    ds_read_b64_tr_b16 a[134:135], v193 offset:16896
    s_add_u32 m0, s56, 74752
    s_add_u32 s71, s64, 946176
    buffer_load_dwordx4 v4, s[24:27], s71 offen lds
    s_waitcnt lgkmcnt(8)
    v_mfma_f32_32x32x16_bf16 v[16:31], a[112:115], a[12:15], v[16:31]
    ds_read_b64_tr_b16 a[136:137], v194 offset:16384
    ds_read_b64_tr_b16 a[138:139], v194 offset:16896
    v_mfma_f32_32x32x16_bf16 v[32:47], a[116:119], a[12:15], v[32:47]
    ds_read_b64_tr_b16 a[140:141], v195 offset:16384
    ds_read_b64_tr_b16 a[142:143], v195 offset:16896
    s_waitcnt lgkmcnt(8)
    v_mfma_f32_32x32x16_bf16 v[48:63], a[120:123], a[12:15], v[48:63]
    ds_read_b64_tr_b16 a[224:225], v192 offset:18432
    ds_read_b64_tr_b16 a[226:227], v192 offset:18944
    v_mfma_f32_32x32x16_bf16 v[64:79], a[124:127], a[12:15], v[64:79]
    ds_read_b64_tr_b16 a[228:229], v193 offset:18432
    ds_read_b64_tr_b16 a[230:231], v193 offset:18944
    s_waitcnt lgkmcnt(8)
    v_mfma_f32_32x32x16_bf16 v[16:31], a[128:131], a[16:19], v[16:31]
    ds_read_b64_tr_b16 a[232:233], v194 offset:18432
    ds_read_b64_tr_b16 a[234:235], v194 offset:18944
    v_mfma_f32_32x32x16_bf16 v[32:47], a[132:135], a[16:19], v[32:47]
    ds_read_b64_tr_b16 a[236:237], v195 offset:18432
    ds_read_b64_tr_b16 a[238:239], v195 offset:18944
    s_waitcnt lgkmcnt(8)
    v_mfma_f32_32x32x16_bf16 v[48:63], a[136:139], a[16:19], v[48:63]
    ds_read_b64_tr_b16 a[112:113], v192 offset:20480
    ds_read_b64_tr_b16 a[114:115], v192 offset:20992
    v_mfma_f32_32x32x16_bf16 v[64:79], a[140:143], a[16:19], v[64:79]
    ds_read_b64_tr_b16 a[116:117], v193 offset:20480
    ds_read_b64_tr_b16 a[118:119], v193 offset:20992
    s_waitcnt lgkmcnt(8)
    v_mfma_f32_32x32x16_bf16 v[16:31], a[224:227], a[20:23], v[16:31]
    ds_read_b64_tr_b16 a[120:121], v194 offset:20480
    ds_read_b64_tr_b16 a[122:123], v194 offset:20992
    v_mfma_f32_32x32x16_bf16 v[32:47], a[228:231], a[20:23], v[32:47]
    ds_read_b64_tr_b16 a[124:125], v195 offset:20480
    ds_read_b64_tr_b16 a[126:127], v195 offset:20992
    s_waitcnt lgkmcnt(8)
    v_mfma_f32_32x32x16_bf16 v[48:63], a[232:235], a[20:23], v[48:63]
    ds_read_b64_tr_b16 a[128:129], v192 offset:22528
    ds_read_b64_tr_b16 a[130:131], v192 offset:23040
    v_mfma_f32_32x32x16_bf16 v[64:79], a[236:239], a[20:23], v[64:79]
    ds_read_b64_tr_b16 a[132:133], v193 offset:22528
    ds_read_b64_tr_b16 a[134:135], v193 offset:23040
    s_waitcnt lgkmcnt(8)
    v_mfma_f32_32x32x16_bf16 v[16:31], a[112:115], a[24:27], v[16:31]
    ds_read_b64_tr_b16 a[136:137], v194 offset:22528
    ds_read_b64_tr_b16 a[138:139], v194 offset:23040
    v_mfma_f32_32x32x16_bf16 v[32:47], a[116:119], a[24:27], v[32:47]
    ds_read_b64_tr_b16 a[140:141], v195 offset:22528
    ds_read_b64_tr_b16 a[142:143], v195 offset:23040
    s_waitcnt lgkmcnt(8)
    v_mfma_f32_32x32x16_bf16 v[48:63], a[120:123], a[24:27], v[48:63]
    s_waitcnt vmcnt(8)
    s_barrier
    ds_read_b64_tr_b16 a[224:225], v192 offset:32768
    ds_read_b64_tr_b16 a[226:227], v192 offset:33280
    s_add_u32 m0, s56, 0
    s_add_u32 s71, s64, 1146880
    buffer_load_dwordx4 v3, s[20:23], s71 offen lds
    v_mfma_f32_32x32x16_bf16 v[64:79], a[124:127], a[24:27], v[64:79]
    ds_read_b64_tr_b16 a[228:229], v193 offset:32768
    ds_read_b64_tr_b16 a[230:231], v193 offset:33280
    s_waitcnt lgkmcnt(8)
    v_mfma_f32_32x32x16_bf16 v[16:31], a[128:131], a[28:31], v[16:31]
    ds_read_b64_tr_b16 a[232:233], v194 offset:32768
    ds_read_b64_tr_b16 a[234:235], v194 offset:33280
    v_mfma_f32_32x32x16_bf16 v[32:47], a[132:135], a[28:31], v[32:47]
    ds_read_b64_tr_b16 a[236:237], v195 offset:32768
    ds_read_b64_tr_b16 a[238:239], v195 offset:33280
    s_add_u32 m0, s56, 1024
    s_add_u32 s71, s64, 1175552
    buffer_load_dwordx4 v3, s[20:23], s71 offen lds
    s_waitcnt lgkmcnt(8)
    v_mfma_f32_32x32x16_bf16 v[48:63], a[136:139], a[28:31], v[48:63]
    ds_read_b64_tr_b16 a[112:113], v192 offset:34816
    ds_read_b64_tr_b16 a[114:115], v192 offset:35328
    ds_read_b32 v15, v15
    v_mfma_f32_32x32x16_bf16 v[64:79], a[140:143], a[28:31], v[64:79]
    ds_read_b64_tr_b16 a[116:117], v193 offset:34816
    ds_read_b64_tr_b16 a[118:119], v193 offset:35328
    s_waitcnt lgkmcnt(2)
    v_mul_f32_e64 v15, v15, v15
    v_mfma_f32_32x32x16_bf16 v[16:31], a[224:227], a[32:35], v[16:31]
    ds_read_b64_tr_b16 a[120:121], v194 offset:34816
    ds_read_b64_tr_b16 a[122:123], v194 offset:35328
    s_add_u32 m0, s56, 8192
    s_add_u32 s71, s64, 1146880
    buffer_load_dwordx4 v4, s[24:27], s71 offen lds
    v_mfma_f32_32x32x16_bf16 v[32:47], a[228:231], a[32:35], v[32:47]
    ds_read_b64_tr_b16 a[124:125], v195 offset:34816
    ds_read_b64_tr_b16 a[126:127], v195 offset:35328
    v_mfma_f32_32x32x16_bf16 v[48:63], a[232:235], a[32:35], v[48:63]
    ds_read_b64_tr_b16 a[128:129], v192 offset:36864
    ds_read_b64_tr_b16 a[130:131], v192 offset:37376
    s_add_u32 m0, s82, 0
    s_mov_b32 s71, s3
    buffer_load_dwordx4 v238, s[28:31], s71 offen lds
    v_mfma_f32_32x32x16_bf16 v[64:79], a[236:239], a[32:35], v[64:79]
    ds_read_b64_tr_b16 a[132:133], v193 offset:36864
    ds_read_b64_tr_b16 a[134:135], v193 offset:37376
    s_add_u32 m0, s56, 9216
    s_add_u32 s71, s64, 1175552
    buffer_load_dwordx4 v4, s[24:27], s71 offen lds
    s_waitcnt lgkmcnt(8)
    v_mfma_f32_32x32x16_bf16 v[16:31], a[112:115], a[36:39], v[16:31]
    ds_read_b64_tr_b16 a[136:137], v194 offset:36864
    ds_read_b64_tr_b16 a[138:139], v194 offset:37376
    v_mfma_f32_32x32x16_bf16 v[32:47], a[116:119], a[36:39], v[32:47]
    ds_read_b64_tr_b16 a[140:141], v195 offset:36864
    ds_read_b64_tr_b16 a[142:143], v195 offset:37376
    s_waitcnt lgkmcnt(8)
    v_mfma_f32_32x32x16_bf16 v[48:63], a[120:123], a[36:39], v[48:63]
    ds_read_b64_tr_b16 a[224:225], v192 offset:38912
    ds_read_b64_tr_b16 a[226:227], v192 offset:39424
    v_mfma_f32_32x32x16_bf16 v[64:79], a[124:127], a[36:39], v[64:79]
    ds_read_b64_tr_b16 a[228:229], v193 offset:38912
    ds_read_b64_tr_b16 a[230:231], v193 offset:39424
    s_add_u32 m0, s82, 1024
    s_add_u32 s71, s3, 7168
    buffer_load_dwordx4 v238, s[28:31], s71 offen lds
    s_waitcnt lgkmcnt(8)
    v_mfma_f32_32x32x16_bf16 v[16:31], a[128:131], a[40:43], v[16:31]
    ds_read_b64_tr_b16 a[232:233], v194 offset:38912
    ds_read_b64_tr_b16 a[234:235], v194 offset:39424
    v_mfma_f32_32x32x16_bf16 v[32:47], a[132:135], a[40:43], v[32:47]
    ds_read_b64_tr_b16 a[236:237], v195 offset:38912
    ds_read_b64_tr_b16 a[238:239], v195 offset:39424
    s_waitcnt lgkmcnt(8)
    v_mfma_f32_32x32x16_bf16 v[48:63], a[136:139], a[40:43], v[48:63]
    s_waitcnt vmcnt(10)
    s_barrier
    ds_read_b64_tr_b16 a[112:113], v192 offset:49152
    ds_read_b64_tr_b16 a[114:115], v192 offset:49664
    s_add_u32 m0, s56, 16384
    s_add_u32 s71, s64, 1376256
    buffer_load_dwordx4 v3, s[20:23], s71 offen lds
    v_mfma_f32_32x32x16_bf16 v[64:79], a[140:143], a[40:43], v[64:79]
    ds_read_b64_tr_b16 a[116:117], v193 offset:49152
    ds_read_b64_tr_b16 a[118:119], v193 offset:49664
    s_add_u32 m0, s82, 2048
    s_add_u32 s71, s3, 14336
    buffer_load_dwordx4 v238, s[28:31], s71 offen lds
    s_waitcnt lgkmcnt(8)
    v_mfma_f32_32x32x16_bf16 v[16:31], a[224:227], a[44:47], v[16:31]
    ds_read_b64_tr_b16 a[120:121], v194 offset:49152
    ds_read_b64_tr_b16 a[122:123], v194 offset:49664
    v_mfma_f32_32x32x16_bf16 v[32:47], a[228:231], a[44:47], v[32:47]
    ds_read_b64_tr_b16 a[124:125], v195 offset:49152
    ds_read_b64_tr_b16 a[126:127], v195 offset:49664
    s_add_u32 m0, s56, 17408
    s_add_u32 s71, s64, 1404928
    buffer_load_dwordx4 v3, s[20:23], s71 offen lds
    s_waitcnt lgkmcnt(8)
    v_mfma_f32_32x32x16_bf16 v[48:63], a[232:235], a[44:47], v[48:63]
    ds_read_b64_tr_b16 a[128:129], v192 offset:51200
    ds_read_b64_tr_b16 a[130:131], v192 offset:51712
    v_mfma_f32_32x32x16_bf16 v[64:79], a[236:239], a[44:47], v[64:79]
    ds_read_b64_tr_b16 a[132:133], v193 offset:51200
    ds_read_b64_tr_b16 a[134:135], v193 offset:51712
    s_waitcnt lgkmcnt(8)
    v_mfma_f32_32x32x16_bf16 v[16:31], a[112:115], a[48:51], v[16:31]
    ds_read_b64_tr_b16 a[136:137], v194 offset:51200
    ds_read_b64_tr_b16 a[138:139], v194 offset:51712
    s_add_u32 m0, s56, 24576
    s_add_u32 s71, s64, 1376256
    buffer_load_dwordx4 v4, s[24:27], s71 offen lds
    v_mfma_f32_32x32x16_bf16 v[32:47], a[116:119], a[48:51], v[32:47]
    ds_read_b64_tr_b16 a[140:141], v195 offset:51200
    ds_read_b64_tr_b16 a[142:143], v195 offset:51712
    s_add_u32 m0, s82, 3072
    s_add_u32 s71, s3, 21504
    buffer_load_dwordx4 v238, s[28:31], s71 offen lds
    s_waitcnt lgkmcnt(8)
    v_mfma_f32_32x32x16_bf16 v[48:63], a[120:123], a[48:51], v[48:63]
    ds_read_b64_tr_b16 a[224:225], v192 offset:53248
    ds_read_b64_tr_b16 a[226:227], v192 offset:53760
    v_mfma_f32_32x32x16_bf16 v[64:79], a[124:127], a[48:51], v[64:79]
    ds_read_b64_tr_b16 a[228:229], v193 offset:53248
    ds_read_b64_tr_b16 a[230:231], v193 offset:53760
    s_add_u32 m0, s56, 25600
    s_add_u32 s71, s64, 1404928
    buffer_load_dwordx4 v4, s[24:27], s71 offen lds
    s_waitcnt lgkmcnt(8)
    v_mfma_f32_32x32x16_bf16 v[16:31], a[128:131], a[52:55], v[16:31]
    ds_read_b64_tr_b16 a[232:233], v194 offset:53248
    ds_read_b64_tr_b16 a[234:235], v194 offset:53760
    v_mfma_f32_32x32x16_bf16 v[32:47], a[132:135], a[52:55], v[32:47]
    ds_read_b64_tr_b16 a[236:237], v195 offset:53248
    ds_read_b64_tr_b16 a[238:239], v195 offset:53760
    s_waitcnt lgkmcnt(8)
    v_mfma_f32_32x32x16_bf16 v[48:63], a[136:139], a[52:55], v[48:63]
    ds_read_b64_tr_b16 a[112:113], v192 offset:55296
    ds_read_b64_tr_b16 a[114:115], v192 offset:55808
    s_add_u32 m0, s82, 4096
    s_add_u32 s71, s3, 28672
    buffer_load_dwordx4 v238, s[28:31], s71 offen lds
    v_mfma_f32_32x32x16_bf16 v[64:79], a[140:143], a[52:55], v[64:79]
    ds_read_b64_tr_b16 a[116:117], v193 offset:55296
    ds_read_b64_tr_b16 a[118:119], v193 offset:55808
    s_waitcnt lgkmcnt(8)
    v_mfma_f32_32x32x16_bf16 v[16:31], a[224:227], a[56:59], v[16:31]
    ds_read_b64_tr_b16 a[120:121], v194 offset:55296
    ds_read_b64_tr_b16 a[122:123], v194 offset:55808
    v_mfma_f32_32x32x16_bf16 v[32:47], a[228:231], a[56:59], v[32:47]
    ds_read_b64_tr_b16 a[124:125], v195 offset:55296
    ds_read_b64_tr_b16 a[126:127], v195 offset:55808
    s_waitcnt lgkmcnt(8)
    v_mfma_f32_32x32x16_bf16 v[48:63], a[232:235], a[56:59], v[48:63]
    s_waitcnt vmcnt(13)
    s_barrier
    ds_read_b64_tr_b16 a[128:129], v196 offset:49152
    ds_read_b64_tr_b16 a[130:131], v196 offset:49664
    s_add_u32 m0, s56, 32768
    s_mov_b32 s71, s65
    buffer_load_dwordx4 v3, s[20:23], s71 offen lds
    v_mfma_f32_32x32x16_bf16 v[64:79], a[236:239], a[56:59], v[64:79]
    ds_read_b64_tr_b16 a[132:133], v197 offset:49152
    ds_read_b64_tr_b16 a[134:135], v197 offset:49664
    s_add_u32 m0, s82, 5120
    s_add_u32 s71, s3, 35840
    buffer_load_dwordx4 v238, s[28:31], s71 offen lds
    s_waitcnt lgkmcnt(8)
    v_mfma_f32_32x32x16_bf16 v[16:31], a[112:115], a[60:63], v[16:31]
    ds_read_b64_tr_b16 a[136:137], v198 offset:49152
    ds_read_b64_tr_b16 a[138:139], v198 offset:49664
    v_mfma_f32_32x32x16_bf16 v[32:47], a[116:119], a[60:63], v[32:47]
    ds_read_b64_tr_b16 a[140:141], v199 offset:49152
    ds_read_b64_tr_b16 a[142:143], v199 offset:49664
    s_add_u32 m0, s56, 33792
    s_add_u32 s71, s65, 28672
    buffer_load_dwordx4 v3, s[20:23], s71 offen lds
    s_waitcnt lgkmcnt(8)
    v_mfma_f32_32x32x16_bf16 v[48:63], a[120:123], a[60:63], v[48:63]
    ds_read_b64_tr_b16 a[224:225], v196 offset:51200
    ds_read_b64_tr_b16 a[226:227], v196 offset:51712
    v_mfma_f32_32x32x16_bf16 v[64:79], a[124:127], a[60:63], v[64:79]
    ds_read_b64_tr_b16 a[228:229], v197 offset:51200
    ds_read_b64_tr_b16 a[230:231], v197 offset:51712
    s_waitcnt lgkmcnt(8)
    v_mfma_f32_32x32x16_bf16 v[16:31], a[128:131], a[64:67], v[16:31]
    ds_read_b64_tr_b16 a[232:233], v198 offset:51200
    ds_read_b64_tr_b16 a[234:235], v198 offset:51712
    s_add_u32 m0, s56, 40960
    s_mov_b32 s71, s65
    buffer_load_dwordx4 v4, s[24:27], s71 offen lds
    v_mfma_f32_32x32x16_bf16 v[32:47], a[132:135], a[64:67], v[32:47]
    ds_read_b64_tr_b16 a[236:237], v199 offset:51200
    ds_read_b64_tr_b16 a[238:239], v199 offset:51712
    s_add_u32 m0, s82, 6144
    s_add_u32 s71, s3, 43008
    buffer_load_dwordx4 v238, s[28:31], s71 offen lds
    s_waitcnt lgkmcnt(8)
    v_mfma_f32_32x32x16_bf16 v[48:63], a[136:139], a[64:67], v[48:63]
    ds_read_b64_tr_b16 a[112:113], v196 offset:53248
    ds_read_b64_tr_b16 a[114:115], v196 offset:53760
    v_mfma_f32_32x32x16_bf16 v[64:79], a[140:143], a[64:67], v[64:79]
    ds_read_b64_tr_b16 a[116:117], v197 offset:53248
    ds_read_b64_tr_b16 a[118:119], v197 offset:53760
    s_add_u32 m0, s56, 41984
    s_add_u32 s71, s65, 28672
    buffer_load_dwordx4 v4, s[24:27], s71 offen lds
    s_waitcnt lgkmcnt(8)
    v_mfma_f32_32x32x16_bf16 v[16:31], a[224:227], a[68:71], v[16:31]
    ds_read_b64_tr_b16 a[120:121], v198 offset:53248
    ds_read_b64_tr_b16 a[122:123], v198 offset:53760
    v_mfma_f32_32x32x16_bf16 v[32:47], a[228:231], a[68:71], v[32:47]
    ds_read_b64_tr_b16 a[124:125], v199 offset:53248
    ds_read_b64_tr_b16 a[126:127], v199 offset:53760
    s_add_u32 m0, s82, 7168
    s_add_u32 s71, s3, 50176
    buffer_load_dwordx4 v238, s[28:31], s71 offen lds
    s_waitcnt lgkmcnt(8)
    v_mfma_f32_32x32x16_bf16 v[48:63], a[232:235], a[68:71], v[48:63]
    ds_read_b64_tr_b16 a[128:129], v196 offset:55296
    ds_read_b64_tr_b16 a[130:131], v196 offset:55808
    v_mfma_f32_32x32x16_bf16 v[64:79], a[236:239], a[68:71], v[64:79]
    ds_read_b64_tr_b16 a[132:133], v197 offset:55296
    ds_read_b64_tr_b16 a[134:135], v197 offset:55808
    s_waitcnt lgkmcnt(8)
    v_mfma_f32_32x32x16_bf16 v[16:31], a[112:115], a[72:75], v[16:31]
    ds_read_b64_tr_b16 a[136:137], v198 offset:55296
    ds_read_b64_tr_b16 a[138:139], v198 offset:55808
    v_mfma_f32_32x32x16_bf16 v[32:47], a[116:119], a[72:75], v[32:47]
    ds_read_b64_tr_b16 a[140:141], v199 offset:55296
    ds_read_b64_tr_b16 a[142:143], v199 offset:55808
    s_add_u32 m0, s82, 8192
    s_add_u32 s71, s3, 57344
    buffer_load_dwordx4 v238, s[28:31], s71 offen lds
    s_waitcnt lgkmcnt(8)
    v_mfma_f32_32x32x16_bf16 v[48:63], a[120:123], a[72:75], v[48:63]
    s_waitcnt vmcnt(16)
    s_barrier
    ds_read_b64_tr_b16 a[224:225], v192 offset:0
    ds_read_b64_tr_b16 a[226:227], v192 offset:512
    s_add_u32 m0, s56, 49152
    s_add_u32 s71, s65, 229376
    buffer_load_dwordx4 v3, s[20:23], s71 offen lds
    v_mfma_f32_32x32x16_bf16 v[64:79], a[124:127], a[72:75], v[64:79]
    ds_read_b64_tr_b16 a[228:229], v193 offset:0
    ds_read_b64_tr_b16 a[230:231], v193 offset:512
    s_waitcnt lgkmcnt(8)
    v_mfma_f32_32x32x16_bf16 v[16:31], a[128:131], a[76:79], v[16:31]
    ds_read_b64_tr_b16 a[232:233], v194 offset:0
    ds_read_b64_tr_b16 a[234:235], v194 offset:512
    v_mfma_f32_32x32x16_bf16 v[32:47], a[132:135], a[76:79], v[32:47]
    ds_read_b64_tr_b16 a[236:237], v195 offset:0
    ds_read_b64_tr_b16 a[238:239], v195 offset:512
    s_add_u32 m0, s56, 50176
    s_add_u32 s71, s65, 258048
    buffer_load_dwordx4 v3, s[20:23], s71 offen lds
    s_waitcnt lgkmcnt(8)
    v_mfma_f32_32x32x16_bf16 v[48:63], a[136:139], a[76:79], v[48:63]
    ds_read_b64_tr_b16 a[112:113], v192 offset:2048
    ds_read_b64_tr_b16 a[114:115], v192 offset:2560
    v_mfma_f32_32x32x16_bf16 v[64:79], a[140:143], a[76:79], v[64:79]
    ds_read_b64_tr_b16 a[116:117], v193 offset:2048
    ds_read_b64_tr_b16 a[118:119], v193 offset:2560
    s_add_u32 m0, s82, 9216
    s_add_u32 s71, s3, 64512
    buffer_load_dwordx4 v238, s[28:31], s71 offen lds
    s_waitcnt lgkmcnt(8)
    v_mfma_f32_32x32x16_bf16 v[16:31], a[224:227], a[80:83], v[16:31]
    ds_read_b64_tr_b16 a[120:121], v194 offset:2048
    ds_read_b64_tr_b16 a[122:123], v194 offset:2560
    s_add_u32 m0, s56, 57344
    s_add_u32 s71, s65, 229376
    buffer_load_dwordx4 v4, s[24:27], s71 offen lds
    v_mfma_f32_32x32x16_bf16 v[32:47], a[228:231], a[80:83], v[32:47]
    ds_read_b64_tr_b16 a[124:125], v195 offset:2048
    ds_read_b64_tr_b16 a[126:127], v195 offset:2560
    s_waitcnt lgkmcnt(8)
    v_mfma_f32_32x32x16_bf16 v[48:63], a[232:235], a[80:83], v[48:63]
    ds_read_b64_tr_b16 a[128:129], v192 offset:4096
    ds_read_b64_tr_b16 a[130:131], v192 offset:4608
    v_mfma_f32_32x32x16_bf16 v[64:79], a[236:239], a[80:83], v[64:79]
    ds_read_b64_tr_b16 a[132:133], v193 offset:4096
    ds_read_b64_tr_b16 a[134:135], v193 offset:4608
    s_add_u32 m0, s56, 58368
    s_add_u32 s71, s65, 258048
    buffer_load_dwordx4 v4, s[24:27], s71 offen lds
    s_waitcnt lgkmcnt(8)
    v_mfma_f32_32x32x16_bf16 v[16:31], a[112:115], a[84:87], v[16:31]
    ds_read_b64_tr_b16 a[136:137], v194 offset:4096
    ds_read_b64_tr_b16 a[138:139], v194 offset:4608
    v_mfma_f32_32x32x16_bf16 v[32:47], a[116:119], a[84:87], v[32:47]
    ds_read_b64_tr_b16 a[140:141], v195 offset:4096
    ds_read_b64_tr_b16 a[142:143], v195 offset:4608
    s_add_u32 m0, s82, 10240
    s_add_u32 s71, s3, 71680
    buffer_load_dwordx4 v238, s[28:31], s71 offen lds
    s_waitcnt lgkmcnt(8)
    v_mfma_f32_32x32x16_bf16 v[48:63], a[120:123], a[84:87], v[48:63]
    ds_read_b64_tr_b16 a[224:225], v192 offset:6144
    ds_read_b64_tr_b16 a[226:227], v192 offset:6656
    v_mfma_f32_32x32x16_bf16 v[64:79], a[124:127], a[84:87], v[64:79]
    ds_read_b64_tr_b16 a[228:229], v193 offset:6144
    ds_read_b64_tr_b16 a[230:231], v193 offset:6656
    s_waitcnt lgkmcnt(8)
    v_mfma_f32_32x32x16_bf16 v[16:31], a[128:131], a[88:91], v[16:31]
    ds_read_b64_tr_b16 a[232:233], v194 offset:6144
    ds_read_b64_tr_b16 a[234:235], v194 offset:6656
    v_mfma_f32_32x32x16_bf16 v[32:47], a[132:135], a[88:91], v[32:47]
    ds_read_b64_tr_b16 a[236:237], v195 offset:6144
    ds_read_b64_tr_b16 a[238:239], v195 offset:6656
    s_add_u32 m0, s82, 11264
    s_add_u32 s71, s3, 78848
    buffer_load_dwordx4 v238, s[28:31], s71 offen lds
    s_waitcnt lgkmcnt(8)
    v_mfma_f32_32x32x16_bf16 v[48:63], a[136:139], a[88:91], v[48:63]
    s_waitcnt vmcnt(16)
    s_barrier
    ds_read_b64_tr_b16 a[112:113], v192 offset:16384
    ds_read_b64_tr_b16 a[114:115], v192 offset:16896
    s_add_u32 m0, s56, 65536
    s_add_u32 s71, s65, 458752
    buffer_load_dwordx4 v3, s[20:23], s71 offen lds
    v_mfma_f32_32x32x16_bf16 v[64:79], a[140:143], a[88:91], v[64:79]
    ds_read_b64_tr_b16 a[116:117], v193 offset:16384
    ds_read_b64_tr_b16 a[118:119], v193 offset:16896
    s_waitcnt lgkmcnt(8)
    v_mfma_f32_32x32x16_bf16 v[16:31], a[224:227], a[92:95], v[16:31]
    ds_read_b64_tr_b16 a[120:121], v194 offset:16384
    ds_read_b64_tr_b16 a[122:123], v194 offset:16896
    v_mfma_f32_32x32x16_bf16 v[32:47], a[228:231], a[92:95], v[32:47]
    ds_read_b64_tr_b16 a[124:125], v195 offset:16384
    ds_read_b64_tr_b16 a[126:127], v195 offset:16896
    s_add_u32 m0, s56, 66560
    s_add_u32 s71, s65, 487424
    buffer_load_dwordx4 v3, s[20:23], s71 offen lds
    s_waitcnt lgkmcnt(8)
    v_mfma_f32_32x32x16_bf16 v[48:63], a[232:235], a[92:95], v[48:63]
    ds_read_b64_tr_b16 a[128:129], v192 offset:18432
    ds_read_b64_tr_b16 a[130:131], v192 offset:18944
    v_mfma_f32_32x32x16_bf16 v[64:79], a[236:239], a[92:95], v[64:79]
    ds_read_b64_tr_b16 a[132:133], v193 offset:18432
    ds_read_b64_tr_b16 a[134:135], v193 offset:18944
    s_add_u32 m0, s82, 12288
    s_add_u32 s71, s3, 86016
    buffer_load_dwordx4 v238, s[28:31], s71 offen lds
    s_waitcnt lgkmcnt(8)
    v_mfma_f32_32x32x16_bf16 v[16:31], a[112:115], a[96:99], v[16:31]
    ds_read_b64_tr_b16 a[136:137], v194 offset:18432
    ds_read_b64_tr_b16 a[138:139], v194 offset:18944
    s_add_u32 m0, s56, 73728
    s_add_u32 s71, s65, 458752
    buffer_load_dwordx4 v4, s[24:27], s71 offen lds
    v_mfma_f32_32x32x16_bf16 v[32:47], a[116:119], a[96:99], v[32:47]
    ds_read_b64_tr_b16 a[140:141], v195 offset:18432
    ds_read_b64_tr_b16 a[142:143], v195 offset:18944
    s_waitcnt lgkmcnt(8)
    v_mfma_f32_32x32x16_bf16 v[48:63], a[120:123], a[96:99], v[48:63]
    ds_read_b64_tr_b16 a[224:225], v192 offset:20480
    ds_read_b64_tr_b16 a[226:227], v192 offset:20992
    v_mfma_f32_32x32x16_bf16 v[64:79], a[124:127], a[96:99], v[64:79]
    ds_read_b64_tr_b16 a[228:229], v193 offset:20480
    ds_read_b64_tr_b16 a[230:231], v193 offset:20992
    s_add_u32 m0, s56, 74752
    s_add_u32 s71, s65, 487424
    buffer_load_dwordx4 v4, s[24:27], s71 offen lds
    s_waitcnt lgkmcnt(8)
    v_mfma_f32_32x32x16_bf16 v[16:31], a[128:131], a[100:103], v[16:31]
    ds_read_b64_tr_b16 a[232:233], v194 offset:20480
    ds_read_b64_tr_b16 a[234:235], v194 offset:20992
    s_add_u32 m0, s82, 13312
    s_add_u32 s71, s3, 93184
    buffer_load_dwordx4 v238, s[28:31], s71 offen lds
    v_mfma_f32_32x32x16_bf16 v[32:47], a[132:135], a[100:103], v[32:47]
    ds_read_b64_tr_b16 a[236:237], v195 offset:20480
    ds_read_b64_tr_b16 a[238:239], v195 offset:20992
    s_waitcnt lgkmcnt(8)
    v_mfma_f32_32x32x16_bf16 v[48:63], a[136:139], a[100:103], v[48:63]
    ds_read_b64_tr_b16 a[112:113], v192 offset:22528
    ds_read_b64_tr_b16 a[114:115], v192 offset:23040
    v_mfma_f32_32x32x16_bf16 v[64:79], a[140:143], a[100:103], v[64:79]
    ds_read_b64_tr_b16 a[116:117], v193 offset:22528
    ds_read_b64_tr_b16 a[118:119], v193 offset:23040
    s_waitcnt lgkmcnt(8)
    v_mfma_f32_32x32x16_bf16 v[16:31], a[224:227], a[104:107], v[16:31]
    ds_read_b64_tr_b16 a[120:121], v194 offset:22528
    ds_read_b64_tr_b16 a[122:123], v194 offset:23040
    s_add_u32 m0, s56, 148480
    s_mov_b32 s71, s93
    buffer_load_dwordx4 v239, s[4:7], s71 offen lds
    v_mfma_f32_32x32x16_bf16 v[32:47], a[228:231], a[104:107], v[32:47]
    ds_read_b64_tr_b16 a[124:125], v195 offset:22528
    ds_read_b64_tr_b16 a[126:127], v195 offset:23040
    s_waitcnt lgkmcnt(8)
    v_mfma_f32_32x32x16_bf16 v[48:63], a[232:235], a[104:107], v[48:63]
    s_waitcnt vmcnt(16)
    s_barrier
    ds_read_b64_tr_b16 a[128:129], v192 offset:32768
    ds_read_b64_tr_b16 a[130:131], v192 offset:33280
    s_add_u32 m0, s56, 0
    s_add_u32 s71, s65, 688128
    buffer_load_dwordx4 v3, s[20:23], s71 offen lds
    v_mfma_f32_32x32x16_bf16 v[64:79], a[236:239], a[104:107], v[64:79]
    ds_read_b64_tr_b16 a[132:133], v193 offset:32768
    ds_read_b64_tr_b16 a[134:135], v193 offset:33280
    s_waitcnt lgkmcnt(8)
    v_mfma_f32_32x32x16_bf16 v[16:31], a[112:115], a[108:111], v[16:31]
    ds_read_b64_tr_b16 a[136:137], v194 offset:32768
    ds_read_b64_tr_b16 a[138:139], v194 offset:33280
    v_mfma_f32_32x32x16_bf16 v[32:47], a[116:119], a[108:111], v[32:47]
    ds_read_b64_tr_b16 a[140:141], v195 offset:32768
    ds_read_b64_tr_b16 a[142:143], v195 offset:33280
    s_add_u32 m0, s56, 1024
    s_add_u32 s71, s65, 716800
    buffer_load_dwordx4 v3, s[20:23], s71 offen lds
    s_waitcnt lgkmcnt(8)
    v_mfma_f32_32x32x16_bf16 v[48:63], a[120:123], a[108:111], v[48:63]
    ds_read_b64_tr_b16 a[224:225], v192 offset:34816
    ds_read_b64_tr_b16 a[226:227], v192 offset:35328
    s_add_u32 m0, s56, 149504
    s_add_u32 s71, s93, 7168
    buffer_load_dwordx4 v239, s[4:7], s71 offen lds
    v_mfma_f32_32x32x16_bf16 v[64:79], a[124:127], a[108:111], v[64:79]
    ds_read_b64_tr_b16 a[228:229], v193 offset:34816
    ds_read_b64_tr_b16 a[230:231], v193 offset:35328
    s_waitcnt lgkmcnt(8)
    v_mfma_f32_32x32x16_bf16 v[80:95], a[128:131], a[0:3], 0
    ds_read_b64_tr_b16 a[232:233], v194 offset:34816
    ds_read_b64_tr_b16 a[234:235], v194 offset:35328
    s_add_u32 m0, s56, 8192
    s_add_u32 s71, s65, 688128
    buffer_load_dwordx4 v4, s[24:27], s71 offen lds
    v_mfma_f32_32x32x16_bf16 v[96:111], a[132:135], a[0:3], 0
    ds_read_b64_tr_b16 a[236:237], v195 offset:34816
    ds_read_b64_tr_b16 a[238:239], v195 offset:35328
    s_waitcnt lgkmcnt(8)
    v_mfma_f32_32x32x16_bf16 v[112:127], a[136:139], a[0:3], 0
    ds_read_b64_tr_b16 a[112:113], v192 offset:36864
    ds_read_b64_tr_b16 a[114:115], v192 offset:37376
    v_mul_f32 v168, v8, v16
    v_mul_f32 v169, v8, v17
    v_mul_f32 v170, v8, v18
    v_mfma_f32_32x32x16_bf16 v[128:143], a[140:143], a[0:3], 0
    ds_read_b64_tr_b16 a[116:117], v193 offset:36864
    ds_read_b64_tr_b16 a[118:119], v193 offset:37376
    s_add_u32 m0, s56, 9216
    s_add_u32 s71, s65, 716800
    buffer_load_dwordx4 v4, s[24:27], s71 offen lds
    s_waitcnt lgkmcnt(8)
    v_mfma_f32_32x32x16_bf16 v[80:95], a[224:227], a[4:7], v[80:95]
    ds_read_b64_tr_b16 a[120:121], v194 offset:36864
    ds_read_b64_tr_b16 a[122:123], v194 offset:37376
    v_mul_f32 v171, v8, v19
    v_mul_f32 v172, v8, v20
    v_mul_f32 v173, v8, v21
    v_mul_f32 v174, v8, v22
    v_mfma_f32_32x32x16_bf16 v[96:111], a[228:231], a[4:7], v[96:111]
    ds_read_b64_tr_b16 a[124:125], v195 offset:36864
    ds_read_b64_tr_b16 a[126:127], v195 offset:37376
    v_mul_f32_e64 v175, v8, v23
    v_exp_f32 v168, v168
    s_waitcnt lgkmcnt(8)
    v_mfma_f32_32x32x16_bf16 v[112:127], a[232:235], a[4:7], v[112:127]
    ds_read_b64_tr_b16 a[128:129], v192 offset:38912
    ds_read_b64_tr_b16 a[130:131], v192 offset:39424
    v_exp_f32 v169, v169
    v_exp_f32 v170, v170
    v_mfma_f32_32x32x16_bf16 v[128:143], a[236:239], a[4:7], v[128:143]
    ds_read_b64_tr_b16 a[132:133], v193 offset:38912
    ds_read_b64_tr_b16 a[134:135], v193 offset:39424
    v_exp_f32_e64 v171, v171
    v_exp_f32 v172, v172
    s_waitcnt lgkmcnt(8)
    v_mfma_f32_32x32x16_bf16 v[80:95], a[112:115], a[8:11], v[80:95]
    ds_read_b64_tr_b16 a[136:137], v194 offset:38912
    ds_read_b64_tr_b16 a[138:139], v194 offset:39424
    v_exp_f32 v173, v173
    v_exp_f32 v174, v174
    v_mfma_f32_32x32x16_bf16 v[96:111], a[116:119], a[8:11], v[96:111]
    ds_read_b64_tr_b16 a[140:141], v195 offset:38912
    ds_read_b64_tr_b16 a[142:143], v195 offset:39424
    v_exp_f32_e64 v175, v175
    v_mul_f32 v16, v16, v24
    s_waitcnt lgkmcnt(8)
    v_mfma_f32_32x32x16_bf16 v[112:127], a[120:123], a[8:11], v[112:127]
    s_waitcnt vmcnt(14)
    s_barrier
    ds_read_b64_tr_b16 a[224:225], v192 offset:49152
    ds_read_b64_tr_b16 a[226:227], v192 offset:49664
    s_add_u32 m0, s56, 16384
    s_add_u32 s71, s65, 917504
    buffer_load_dwordx4 v3, s[20:23], s71 offen lds
    v_mfma_f32_32x32x16_bf16 v[128:143], a[124:127], a[8:11], v[128:143]
    ds_read_b64_tr_b16 a[228:229], v193 offset:49152
    ds_read_b64_tr_b16 a[230:231], v193 offset:49664
    v_mul_f32 v17, v17, v25
    v_mul_f32 v18, v18, v26
    v_mul_f32 v19, v19, v27
    v_mul_f32 v20, v20, v28
    s_waitcnt lgkmcnt(8)
    v_mfma_f32_32x32x16_bf16 v[80:95], a[128:131], a[12:15], v[80:95]
    ds_read_b64_tr_b16 a[232:233], v194 offset:49152
    ds_read_b64_tr_b16 a[234:235], v194 offset:49664
    v_mul_f32 v21, v21, v29
    v_mul_f32 v22, v22, v30
    v_mul_f32 v23, v23, v31
    v_mfma_f32_32x32x16_bf16 v[96:111], a[132:135], a[12:15], v[96:111]
    ds_read_b64_tr_b16 a[236:237], v195 offset:49152
    ds_read_b64_tr_b16 a[238:239], v195 offset:49664
    s_add_u32 m0, s56, 17408
    s_add_u32 s71, s65, 946176
    buffer_load_dwordx4 v3, s[20:23], s71 offen lds
    s_waitcnt lgkmcnt(8)
    v_mfma_f32_32x32x16_bf16 v[112:127], a[136:139], a[12:15], v[112:127]
    ds_read_b64_tr_b16 a[112:113], v192 offset:51200
    ds_read_b64_tr_b16 a[114:115], v192 offset:51712
    v_add_f32 v168, 1.0, v168
    v_add_f32 v169, 1.0, v169
    v_add_f32 v170, 1.0, v170
    v_mfma_f32_32x32x16_bf16 v[128:143], a[140:143], a[12:15], v[128:143]
    ds_read_b64_tr_b16 a[116:117], v193 offset:51200
    ds_read_b64_tr_b16 a[118:119], v193 offset:51712
    v_add_f32 v171, 1.0, v171
    v_add_f32 v172, 1.0, v172
    v_add_f32_e64 v173, 1.0, v173
    v_add_f32 v174, 1.0, v174
    s_waitcnt lgkmcnt(8)
    v_mfma_f32_32x32x16_bf16 v[80:95], a[224:227], a[16:19], v[80:95]
    ds_read_b64_tr_b16 a[120:121], v194 offset:51200
    ds_read_b64_tr_b16 a[122:123], v194 offset:51712
    s_add_u32 m0, s56, 24576
    s_add_u32 s71, s65, 917504
    buffer_load_dwordx4 v4, s[24:27], s71 offen lds
    v_mfma_f32_32x32x16_bf16 v[96:111], a[228:231], a[16:19], v[96:111]
    ds_read_b64_tr_b16 a[124:125], v195 offset:51200
    ds_read_b64_tr_b16 a[126:127], v195 offset:51712
    v_add_f32 v175, 1.0, v175
    v_rcp_f32 v168, v168
    v_rcp_f32 v169, v169
    s_waitcnt lgkmcnt(8)
    v_mfma_f32_32x32x16_bf16 v[112:127], a[232:235], a[16:19], v[112:127]
    ds_read_b64_tr_b16 a[128:129], v192 offset:53248
    ds_read_b64_tr_b16 a[130:131], v192 offset:53760
    v_rcp_f32 v170, v170
    v_mfma_f32_32x32x16_bf16 v[128:143], a[236:239], a[16:19], v[128:143]
    ds_read_b64_tr_b16 a[132:133], v193 offset:53248
    ds_read_b64_tr_b16 a[134:135], v193 offset:53760
    s_add_u32 m0, s56, 25600
    s_add_u32 s71, s65, 946176
    buffer_load_dwordx4 v4, s[24:27], s71 offen lds
    s_waitcnt lgkmcnt(8)
    v_mfma_f32_32x32x16_bf16 v[80:95], a[112:115], a[20:23], v[80:95]
    ds_read_b64_tr_b16 a[136:137], v194 offset:53248
    ds_read_b64_tr_b16 a[138:139], v194 offset:53760
    v_rcp_f32 v171, v171
    v_rcp_f32 v172, v172
    v_mfma_f32_32x32x16_bf16 v[96:111], a[116:119], a[20:23], v[96:111]
    ds_read_b64_tr_b16 a[140:141], v195 offset:53248
    ds_read_b64_tr_b16 a[142:143], v195 offset:53760
    v_rcp_f32_e64 v173, v173
    v_rcp_f32 v174, v174
    s_waitcnt lgkmcnt(8)
    v_mfma_f32_32x32x16_bf16 v[112:127], a[120:123], a[20:23], v[112:127]
    ds_read_b64_tr_b16 a[224:225], v192 offset:55296
    ds_read_b64_tr_b16 a[226:227], v192 offset:55808
    v_rcp_f32 v175, v175
    v_mul_f32 v16, v16, v168
    v_mfma_f32_32x32x16_bf16 v[128:143], a[124:127], a[20:23], v[128:143]
    ds_read_b64_tr_b16 a[228:229], v193 offset:55296
    ds_read_b64_tr_b16 a[230:231], v193 offset:55808
    v_mul_f32 v17, v17, v169
    v_mul_f32 v18, v18, v170
    v_mul_f32_e64 v19, v19, v171
    v_mul_f32 v20, v20, v172
    s_waitcnt lgkmcnt(8)
    v_mfma_f32_32x32x16_bf16 v[80:95], a[128:131], a[24:27], v[80:95]
    ds_read_b64_tr_b16 a[232:233], v194 offset:55296
    ds_read_b64_tr_b16 a[234:235], v194 offset:55808
    v_mul_f32 v21, v21, v173
    v_mul_f32 v22, v22, v174
    v_mul_f32 v23, v23, v175
    v_mfma_f32_32x32x16_bf16 v[96:111], a[132:135], a[24:27], v[96:111]
    ds_read_b64_tr_b16 a[236:237], v195 offset:55296
    ds_read_b64_tr_b16 a[238:239], v195 offset:55808
    v_cvt_pk_bf16_f32 v24, v16, v17
    v_cvt_pk_bf16_f32 v25, v18, v19
    v_cvt_pk_bf16_f32 v26, v20, v21
    v_cvt_pk_bf16_f32 v27, v22, v23
    s_waitcnt lgkmcnt(8)
    v_mfma_f32_32x32x16_bf16 v[112:127], a[136:139], a[24:27], v[112:127]
    s_waitcnt vmcnt(11)
    s_barrier
    ds_read_b64_tr_b16 a[112:113], v196 offset:49152
    ds_read_b64_tr_b16 a[114:115], v196 offset:49664
    s_add_u32 m0, s56, 32768
    s_add_u32 s71, s65, 1146880
    buffer_load_dwordx4 v3, s[20:23], s71 offen lds
    v_mfma_f32_32x32x16_bf16 v[128:143], a[140:143], a[24:27], v[128:143]
    ds_read_b64_tr_b16 a[116:117], v197 offset:49152
    ds_read_b64_tr_b16 a[118:119], v197 offset:49664
    buffer_store_dwordx4 v[24:27], v11, s[40:43], s68 offen offset:0 sc1
    s_waitcnt lgkmcnt(8)
    v_mfma_f32_32x32x16_bf16 v[80:95], a[224:227], a[28:31], v[80:95]
    ds_read_b64_tr_b16 a[120:121], v198 offset:49152
    ds_read_b64_tr_b16 a[122:123], v198 offset:49664
    v_mul_f32 v168, v8, v32
    v_mul_f32 v169, v8, v33
    v_mul_f32 v170, v8, v34
    v_mfma_f32_32x32x16_bf16 v[96:111], a[228:231], a[28:31], v[96:111]
    ds_read_b64_tr_b16 a[124:125], v199 offset:49152
    ds_read_b64_tr_b16 a[126:127], v199 offset:49664
    s_add_u32 m0, s56, 33792
    s_add_u32 s71, s65, 1175552
    buffer_load_dwordx4 v3, s[20:23], s71 offen lds
    s_waitcnt lgkmcnt(8)
    v_mfma_f32_32x32x16_bf16 v[112:127], a[232:235], a[28:31], v[112:127]
    ds_read_b64_tr_b16 a[128:129], v196 offset:51200
    ds_read_b64_tr_b16 a[130:131], v196 offset:51712
    v_mul_f32 v171, v8, v35
    v_mul_f32 v172, v8, v36
    v_mul_f32 v173, v8, v37
    v_mul_f32 v174, v8, v38
    v_mfma_f32_32x32x16_bf16 v[128:143], a[236:239], a[28:31], v[128:143]
    ds_read_b64_tr_b16 a[132:133], v197 offset:51200
    ds_read_b64_tr_b16 a[134:135], v197 offset:51712
    v_mul_f32 v175, v8, v39
    v_exp_f32 v168, v168
    s_waitcnt lgkmcnt(8)
    v_mfma_f32_32x32x16_bf16 v[80:95], a[112:115], a[32:35], v[80:95]
    ds_read_b64_tr_b16 a[136:137], v198 offset:51200
    ds_read_b64_tr_b16 a[138:139], v198 offset:51712
    s_add_u32 m0, s56, 40960
    s_add_u32 s71, s65, 1146880
    buffer_load_dwordx4 v4, s[24:27], s71 offen lds
    v_mfma_f32_32x32x16_bf16 v[96:111], a[116:119], a[32:35], v[96:111]
    ds_read_b64_tr_b16 a[140:141], v199 offset:51200
    ds_read_b64_tr_b16 a[142:143], v199 offset:51712
    v_exp_f32_e64 v169, v169
    v_exp_f32 v170, v170
    s_waitcnt lgkmcnt(8)
    v_mfma_f32_32x32x16_bf16 v[112:127], a[120:123], a[32:35], v[112:127]
    ds_read_b64_tr_b16 a[224:225], v196 offset:53248
    ds_read_b64_tr_b16 a[226:227], v196 offset:53760
    v_exp_f32 v171, v171
    v_exp_f32 v172, v172
    v_mfma_f32_32x32x16_bf16 v[128:143], a[124:127], a[32:35], v[128:143]
    ds_read_b64_tr_b16 a[228:229], v197 offset:53248
    ds_read_b64_tr_b16 a[230:231], v197 offset:53760
    s_add_u32 m0, s56, 41984
    s_add_u32 s71, s65, 1175552
    buffer_load_dwordx4 v4, s[24:27], s71 offen lds
    s_waitcnt lgkmcnt(8)
    v_mfma_f32_32x32x16_bf16 v[80:95], a[128:131], a[36:39], v[80:95]
    ds_read_b64_tr_b16 a[232:233], v198 offset:53248
    ds_read_b64_tr_b16 a[234:235], v198 offset:53760
    v_exp_f32 v173, v173
    v_exp_f32 v174, v174
    v_mfma_f32_32x32x16_bf16 v[96:111], a[132:135], a[36:39], v[96:111]
    ds_read_b64_tr_b16 a[236:237], v199 offset:53248
    ds_read_b64_tr_b16 a[238:239], v199 offset:53760
    v_exp_f32 v175, v175
    v_mul_f32 v32, v32, v40
    s_waitcnt lgkmcnt(8)
    v_mfma_f32_32x32x16_bf16 v[112:127], a[136:139], a[36:39], v[112:127]
    ds_read_b64_tr_b16 a[112:113], v196 offset:55296
    ds_read_b64_tr_b16 a[114:115], v196 offset:55808
    v_mul_f32 v33, v33, v41
    v_mul_f32 v34, v34, v42
    v_mul_f32 v35, v35, v43
    v_mfma_f32_32x32x16_bf16 v[128:143], a[140:143], a[36:39], v[128:143]
    ds_read_b64_tr_b16 a[116:117], v197 offset:55296
    ds_read_b64_tr_b16 a[118:119], v197 offset:55808
    v_mul_f32 v36, v36, v44
    v_mul_f32 v37, v37, v45
    v_mul_f32 v38, v38, v46
    v_mul_f32 v39, v39, v47
    s_waitcnt lgkmcnt(8)
    v_mfma_f32_32x32x16_bf16 v[80:95], a[224:227], a[40:43], v[80:95]
    ds_read_b64_tr_b16 a[120:121], v198 offset:55296
    ds_read_b64_tr_b16 a[122:123], v198 offset:55808
    v_add_f32 v168, 1.0, v168
    v_add_f32 v169, 1.0, v169
    v_add_f32 v170, 1.0, v170
    v_add_f32 v171, 1.0, v171
    v_mfma_f32_32x32x16_bf16 v[96:111], a[228:231], a[40:43], v[96:111]
    ds_read_b64_tr_b16 a[124:125], v199 offset:55296
    ds_read_b64_tr_b16 a[126:127], v199 offset:55808
    v_add_f32 v172, 1.0, v172
    v_add_f32 v173, 1.0, v173
    v_add_f32_e64 v174, 1.0, v174
    v_add_f32 v175, 1.0, v175
    s_waitcnt lgkmcnt(8)
    v_mfma_f32_32x32x16_bf16 v[112:127], a[232:235], a[40:43], v[112:127]
    s_waitcnt vmcnt(9)
    s_barrier
    ds_read_b64_tr_b16 a[128:129], v192 offset:0
    ds_read_b64_tr_b16 a[130:131], v192 offset:512
    s_add_u32 m0, s56, 49152
    s_add_u32 s71, s65, 1376256
    buffer_load_dwordx4 v3, s[20:23], s71 offen lds
    v_mfma_f32_32x32x16_bf16 v[128:143], a[236:239], a[40:43], v[128:143]
    ds_read_b64_tr_b16 a[132:133], v193 offset:0
    ds_read_b64_tr_b16 a[134:135], v193 offset:512
    v_rcp_f32 v168, v168
    v_rcp_f32 v169, v169
    s_waitcnt lgkmcnt(8)
    v_mfma_f32_32x32x16_bf16 v[80:95], a[112:115], a[44:47], v[80:95]
    ds_read_b64_tr_b16 a[136:137], v194 offset:0
    ds_read_b64_tr_b16 a[138:139], v194 offset:512
    v_rcp_f32 v170, v170
    v_mfma_f32_32x32x16_bf16 v[96:111], a[116:119], a[44:47], v[96:111]
    ds_read_b64_tr_b16 a[140:141], v195 offset:0
    ds_read_b64_tr_b16 a[142:143], v195 offset:512
    s_add_u32 m0, s56, 50176
    s_add_u32 s71, s65, 1404928
    buffer_load_dwordx4 v3, s[20:23], s71 offen lds
    s_waitcnt lgkmcnt(8)
    v_mfma_f32_32x32x16_bf16 v[112:127], a[120:123], a[44:47], v[112:127]
    ds_read_b64_tr_b16 a[224:225], v192 offset:2048
    ds_read_b64_tr_b16 a[226:227], v192 offset:2560
    v_rcp_f32 v171, v171
    v_rcp_f32 v172, v172
    v_mfma_f32_32x32x16_bf16 v[128:143], a[124:127], a[44:47], v[128:143]
    ds_read_b64_tr_b16 a[228:229], v193 offset:2048
    ds_read_b64_tr_b16 a[230:231], v193 offset:2560
    v_rcp_f32 v173, v173
    v_rcp_f32 v174, v174
    s_waitcnt lgkmcnt(8)
    v_mfma_f32_32x32x16_bf16 v[80:95], a[128:131], a[48:51], v[80:95]
    ds_read_b64_tr_b16 a[232:233], v194 offset:2048
    ds_read_b64_tr_b16 a[234:235], v194 offset:2560
    s_add_u32 m0, s56, 57344
    s_add_u32 s71, s65, 1376256
    buffer_load_dwordx4 v4, s[24:27], s71 offen lds
    v_mfma_f32_32x32x16_bf16 v[96:111], a[132:135], a[48:51], v[96:111]
    ds_read_b64_tr_b16 a[236:237], v195 offset:2048
    ds_read_b64_tr_b16 a[238:239], v195 offset:2560
    v_rcp_f32 v175, v175
    v_mul_f32 v32, v32, v168
    v_mul_f32 v33, v33, v169
    s_waitcnt lgkmcnt(8)
    v_mfma_f32_32x32x16_bf16 v[112:127], a[136:139], a[48:51], v[112:127]
    ds_read_b64_tr_b16 a[112:113], v192 offset:4096
    ds_read_b64_tr_b16 a[114:115], v192 offset:4608
    v_mul_f32 v34, v34, v170
    v_mul_f32 v35, v35, v171
    v_mul_f32_e64 v36, v36, v172
    v_mfma_f32_32x32x16_bf16 v[128:143], a[140:143], a[48:51], v[128:143]
    ds_read_b64_tr_b16 a[116:117], v193 offset:4096
    ds_read_b64_tr_b16 a[118:119], v193 offset:4608
    s_add_u32 m0, s56, 58368
    s_add_u32 s71, s65, 1404928
    buffer_load_dwordx4 v4, s[24:27], s71 offen lds
    s_waitcnt lgkmcnt(8)
    v_mfma_f32_32x32x16_bf16 v[80:95], a[224:227], a[52:55], v[80:95]
    ds_read_b64_tr_b16 a[120:121], v194 offset:4096
    ds_read_b64_tr_b16 a[122:123], v194 offset:4608
    v_mul_f32 v37, v37, v173
    v_mul_f32 v38, v38, v174
    v_mul_f32 v39, v39, v175
    v_cvt_pk_bf16_f32 v40, v32, v33
    v_mfma_f32_32x32x16_bf16 v[96:111], a[228:231], a[52:55], v[96:111]
    ds_read_b64_tr_b16 a[124:125], v195 offset:4096
    ds_read_b64_tr_b16 a[126:127], v195 offset:4608
    v_cvt_pk_bf16_f32 v41, v34, v35
    v_cvt_pk_bf16_f32 v42, v36, v37
    v_cvt_pk_bf16_f32 v43, v38, v39
    s_waitcnt lgkmcnt(8)
    v_mfma_f32_32x32x16_bf16 v[112:127], a[232:235], a[52:55], v[112:127]
    ds_read_b64_tr_b16 a[128:129], v192 offset:6144
    ds_read_b64_tr_b16 a[130:131], v192 offset:6656
    buffer_store_dwordx4 v[40:43], v11, s[40:43], s68 offen offset:1024 sc1
    v_mfma_f32_32x32x16_bf16 v[128:143], a[236:239], a[52:55], v[128:143]
    ds_read_b64_tr_b16 a[132:133], v193 offset:6144
    ds_read_b64_tr_b16 a[134:135], v193 offset:6656
    v_mul_f32 v168, v8, v48
    v_mul_f32 v169, v8, v49
    v_mul_f32 v170, v8, v50
    v_mul_f32 v171, v8, v51
    s_waitcnt lgkmcnt(8)
    v_mfma_f32_32x32x16_bf16 v[80:95], a[112:115], a[56:59], v[80:95]
    ds_read_b64_tr_b16 a[136:137], v194 offset:6144
    ds_read_b64_tr_b16 a[138:139], v194 offset:6656
    v_mul_f32 v172, v8, v52
    v_mul_f32 v173, v8, v53
    v_mul_f32 v174, v8, v54
    v_mfma_f32_32x32x16_bf16 v[96:111], a[116:119], a[56:59], v[96:111]
    ds_read_b64_tr_b16 a[140:141], v195 offset:6144
    ds_read_b64_tr_b16 a[142:143], v195 offset:6656
    v_mul_f32 v175, v8, v55
    v_exp_f32 v168, v168
    s_waitcnt lgkmcnt(8)
    v_mfma_f32_32x32x16_bf16 v[112:127], a[120:123], a[56:59], v[112:127]
    s_waitcnt vmcnt(10)
    s_barrier
    ds_read_b64_tr_b16 a[224:225], v192 offset:16384
    ds_read_b64_tr_b16 a[226:227], v192 offset:16896
    s_add_u32 m0, s56, 65536
    s_mov_b32 s71, s66
    buffer_load_dwordx4 v5, s[20:23], s71 offen lds
    v_mfma_f32_32x32x16_bf16 v[128:143], a[124:127], a[56:59], v[128:143]
    ds_read_b64_tr_b16 a[228:229], v193 offset:16384
    ds_read_b64_tr_b16 a[230:231], v193 offset:16896
    v_exp_f32 v169, v169
    v_exp_f32 v170, v170
    s_waitcnt lgkmcnt(8)
    v_mfma_f32_32x32x16_bf16 v[80:95], a[128:131], a[60:63], v[80:95]
    ds_read_b64_tr_b16 a[232:233], v194 offset:16384
    ds_read_b64_tr_b16 a[234:235], v194 offset:16896
    v_exp_f32 v171, v171
    v_exp_f32 v172, v172
    v_mfma_f32_32x32x16_bf16 v[96:111], a[132:135], a[60:63], v[96:111]
    ds_read_b64_tr_b16 a[236:237], v195 offset:16384
    ds_read_b64_tr_b16 a[238:239], v195 offset:16896
    s_add_u32 m0, s56, 66560
    s_add_u32 s71, s66, 57344
    buffer_load_dwordx4 v5, s[20:23], s71 offen lds
    s_waitcnt lgkmcnt(8)
    v_mfma_f32_32x32x16_bf16 v[112:127], a[136:139], a[60:63], v[112:127]
    ds_read_b64_tr_b16 a[112:113], v192 offset:18432
    ds_read_b64_tr_b16 a[114:115], v192 offset:18944
    v_exp_f32 v173, v173
    v_exp_f32 v174, v174
    v_mfma_f32_32x32x16_bf16 v[128:143], a[140:143], a[60:63], v[128:143]
    ds_read_b64_tr_b16 a[116:117], v193 offset:18432
    ds_read_b64_tr_b16 a[118:119], v193 offset:18944
    v_exp_f32 v175, v175
    v_mul_f32 v48, v48, v56
    s_waitcnt lgkmcnt(8)
    v_mfma_f32_32x32x16_bf16 v[80:95], a[224:227], a[64:67], v[80:95]
    ds_read_b64_tr_b16 a[120:121], v194 offset:18432
    ds_read_b64_tr_b16 a[122:123], v194 offset:18944
    s_add_u32 m0, s56, 73728
    s_mov_b32 s71, s66
    buffer_load_dwordx4 v6, s[24:27], s71 offen lds
    v_mfma_f32_32x32x16_bf16 v[96:111], a[228:231], a[64:67], v[96:111]
    ds_read_b64_tr_b16 a[124:125], v195 offset:18432
    ds_read_b64_tr_b16 a[126:127], v195 offset:18944
    v_mul_f32 v49, v49, v57
    v_mul_f32 v50, v50, v58
    v_mul_f32 v51, v51, v59
    v_mul_f32 v52, v52, v60
    s_waitcnt lgkmcnt(8)
    v_mfma_f32_32x32x16_bf16 v[112:127], a[232:235], a[64:67], v[112:127]
    ds_read_b64_tr_b16 a[128:129], v192 offset:20480
    ds_read_b64_tr_b16 a[130:131], v192 offset:20992
    v_mul_f32 v53, v53, v61
    v_mul_f32 v54, v54, v62
    v_mul_f32 v55, v55, v63
    v_add_f32 v168, 1.0, v168
    v_mfma_f32_32x32x16_bf16 v[128:143], a[236:239], a[64:67], v[128:143]
    ds_read_b64_tr_b16 a[132:133], v193 offset:20480
    ds_read_b64_tr_b16 a[134:135], v193 offset:20992
    s_add_u32 m0, s56, 74752
    s_add_u32 s71, s66, 57344
    buffer_load_dwordx4 v6, s[24:27], s71 offen lds
    s_waitcnt lgkmcnt(8)
    v_mfma_f32_32x32x16_bf16 v[80:95], a[112:115], a[68:71], v[80:95]
    ds_read_b64_tr_b16 a[136:137], v194 offset:20480
    ds_read_b64_tr_b16 a[138:139], v194 offset:20992
    v_add_f32 v169, 1.0, v169
    v_add_f32 v170, 1.0, v170
    v_add_f32 v171, 1.0, v171
    v_mfma_f32_32x32x16_bf16 v[96:111], a[116:119], a[68:71], v[96:111]
    ds_read_b64_tr_b16 a[140:141], v195 offset:20480
    ds_read_b64_tr_b16 a[142:143], v195 offset:20992
    v_add_f32 v172, 1.0, v172
    v_add_f32 v173, 1.0, v173
    v_add_f32_e64 v174, 1.0, v174
    v_add_f32 v175, 1.0, v175
    s_waitcnt lgkmcnt(8)
    v_mfma_f32_32x32x16_bf16 v[112:127], a[120:123], a[68:71], v[112:127]
    ds_read_b64_tr_b16 a[224:225], v192 offset:22528
    ds_read_b64_tr_b16 a[226:227], v192 offset:23040
    v_rcp_f32 v168, v168
    v_rcp_f32 v169, v169
    v_mfma_f32_32x32x16_bf16 v[128:143], a[124:127], a[68:71], v[128:143]
    ds_read_b64_tr_b16 a[228:229], v193 offset:22528
    ds_read_b64_tr_b16 a[230:231], v193 offset:23040
    v_rcp_f32 v170, v170
    v_rcp_f32 v171, v171
    s_waitcnt lgkmcnt(8)
    v_mfma_f32_32x32x16_bf16 v[80:95], a[128:131], a[72:75], v[80:95]
    ds_read_b64_tr_b16 a[232:233], v194 offset:22528
    ds_read_b64_tr_b16 a[234:235], v194 offset:23040
    v_rcp_f32 v172, v172
    v_mfma_f32_32x32x16_bf16 v[96:111], a[132:135], a[72:75], v[96:111]
    ds_read_b64_tr_b16 a[236:237], v195 offset:22528
    ds_read_b64_tr_b16 a[238:239], v195 offset:23040
    v_rcp_f32 v173, v173
    v_rcp_f32 v174, v174
    s_waitcnt lgkmcnt(8)
    v_mfma_f32_32x32x16_bf16 v[112:127], a[136:139], a[72:75], v[112:127]
    s_waitcnt vmcnt(9)
    s_barrier
    ds_read_b64_tr_b16 a[112:113], v192 offset:32768
    ds_read_b64_tr_b16 a[114:115], v192 offset:33280
    s_add_u32 m0, s56, 0
    s_add_u32 s71, s66, 458752
    buffer_load_dwordx4 v5, s[20:23], s71 offen lds
    v_mfma_f32_32x32x16_bf16 v[128:143], a[140:143], a[72:75], v[128:143]
    ds_read_b64_tr_b16 a[116:117], v193 offset:32768
    ds_read_b64_tr_b16 a[118:119], v193 offset:33280
    v_rcp_f32 v175, v175
    v_mul_f32 v48, v48, v168
    v_mul_f32 v49, v49, v169
    s_waitcnt lgkmcnt(8)
    v_mfma_f32_32x32x16_bf16 v[80:95], a[224:227], a[76:79], v[80:95]
    ds_read_b64_tr_b16 a[120:121], v194 offset:32768
    ds_read_b64_tr_b16 a[122:123], v194 offset:33280
    v_mul_f32 v50, v50, v170
    v_mul_f32 v51, v51, v171
    v_mul_f32 v52, v52, v172
    v_mul_f32 v53, v53, v173
    v_mfma_f32_32x32x16_bf16 v[96:111], a[228:231], a[76:79], v[96:111]
    ds_read_b64_tr_b16 a[124:125], v195 offset:32768
    ds_read_b64_tr_b16 a[126:127], v195 offset:33280
    s_add_u32 m0, s56, 1024
    s_add_u32 s71, s66, 516096
    buffer_load_dwordx4 v5, s[20:23], s71 offen lds
    s_waitcnt lgkmcnt(8)
    v_mfma_f32_32x32x16_bf16 v[112:127], a[232:235], a[76:79], v[112:127]
    ds_read_b64_tr_b16 a[128:129], v192 offset:34816
    ds_read_b64_tr_b16 a[130:131], v192 offset:35328
    v_mul_f32 v54, v54, v174
    v_mul_f32 v55, v55, v175
    v_cvt_pk_bf16_f32 v56, v48, v49
    v_mfma_f32_32x32x16_bf16 v[128:143], a[236:239], a[76:79], v[128:143]
    ds_read_b64_tr_b16 a[132:133], v193 offset:34816
    ds_read_b64_tr_b16 a[134:135], v193 offset:35328
    v_cvt_pk_bf16_f32 v57, v50, v51
    v_cvt_pk_bf16_f32 v58, v52, v53
    v_cvt_pk_bf16_f32 v59, v54, v55
    s_waitcnt lgkmcnt(8)
    v_mfma_f32_32x32x16_bf16 v[80:95], a[112:115], a[80:83], v[80:95]
    ds_read_b64_tr_b16 a[136:137], v194 offset:34816
    ds_read_b64_tr_b16 a[138:139], v194 offset:35328
    s_add_u32 m0, s56, 8192
    s_add_u32 s71, s66, 458752
    buffer_load_dwordx4 v6, s[24:27], s71 offen lds
    v_mfma_f32_32x32x16_bf16 v[96:111], a[116:119], a[80:83], v[96:111]
    ds_read_b64_tr_b16 a[140:141], v195 offset:34816
    ds_read_b64_tr_b16 a[142:143], v195 offset:35328
    buffer_store_dwordx4 v[56:59], v11, s[40:43], s68 offen offset:2048 sc1
    v_mul_f32 v168, v8, v64
    s_waitcnt lgkmcnt(8)
    v_mfma_f32_32x32x16_bf16 v[112:127], a[120:123], a[80:83], v[112:127]
    ds_read_b64_tr_b16 a[224:225], v192 offset:36864
    ds_read_b64_tr_b16 a[226:227], v192 offset:37376
    v_mul_f32 v169, v8, v65
    v_mul_f32 v170, v8, v66
    v_mul_f32_e64 v171, v8, v67
    v_mfma_f32_32x32x16_bf16 v[128:143], a[124:127], a[80:83], v[128:143]
    ds_read_b64_tr_b16 a[228:229], v193 offset:36864
    ds_read_b64_tr_b16 a[230:231], v193 offset:37376
    s_add_u32 m0, s56, 9216
    s_add_u32 s71, s66, 516096
    buffer_load_dwordx4 v6, s[24:27], s71 offen lds
    s_waitcnt lgkmcnt(8)
    v_mfma_f32_32x32x16_bf16 v[80:95], a[128:131], a[84:87], v[80:95]
    ds_read_b64_tr_b16 a[232:233], v194 offset:36864
    ds_read_b64_tr_b16 a[234:235], v194 offset:37376
    v_mul_f32 v172, v8, v68
    v_mul_f32 v173, v8, v69
    v_mul_f32 v174, v8, v70
    v_mfma_f32_32x32x16_bf16 v[96:111], a[132:135], a[84:87], v[96:111]
    ds_read_b64_tr_b16 a[236:237], v195 offset:36864
    ds_read_b64_tr_b16 a[238:239], v195 offset:37376
    v_mul_f32 v175, v8, v71
    v_exp_f32 v168, v168
    v_exp_f32 v169, v169
    s_waitcnt lgkmcnt(8)
    v_mfma_f32_32x32x16_bf16 v[112:127], a[136:139], a[84:87], v[112:127]
    ds_read_b64_tr_b16 a[112:113], v192 offset:38912
    ds_read_b64_tr_b16 a[114:115], v192 offset:39424
    v_exp_f32 v170, v170
    v_mfma_f32_32x32x16_bf16 v[128:143], a[140:143], a[84:87], v[128:143]
    ds_read_b64_tr_b16 a[116:117], v193 offset:38912
    ds_read_b64_tr_b16 a[118:119], v193 offset:39424
    v_exp_f32 v171, v171
    v_exp_f32 v172, v172
    s_waitcnt lgkmcnt(8)
    v_mfma_f32_32x32x16_bf16 v[80:95], a[224:227], a[88:91], v[80:95]
    ds_read_b64_tr_b16 a[120:121], v194 offset:38912
    ds_read_b64_tr_b16 a[122:123], v194 offset:39424
    v_exp_f32 v173, v173
    v_exp_f32 v174, v174
    v_mfma_f32_32x32x16_bf16 v[96:111], a[228:231], a[88:91], v[96:111]
    ds_read_b64_tr_b16 a[124:125], v195 offset:38912
    ds_read_b64_tr_b16 a[126:127], v195 offset:39424
    v_exp_f32 v175, v175
    v_mul_f32 v64, v64, v72
    v_mul_f32 v65, v65, v73
    s_waitcnt lgkmcnt(8)
    v_mfma_f32_32x32x16_bf16 v[112:127], a[232:235], a[88:91], v[112:127]
    s_waitcnt vmcnt(10)
    s_barrier
    ds_read_b64_tr_b16 a[128:129], v192 offset:49152
    ds_read_b64_tr_b16 a[130:131], v192 offset:49664
    s_add_u32 m0, s56, 16384
    s_add_u32 s71, s66, 917504
    buffer_load_dwordx4 v5, s[20:23], s71 offen lds
    v_mfma_f32_32x32x16_bf16 v[128:143], a[236:239], a[88:91], v[128:143]
    ds_read_b64_tr_b16 a[132:133], v193 offset:49152
    ds_read_b64_tr_b16 a[134:135], v193 offset:49664
    v_mul_f32 v66, v66, v74
    v_mul_f32 v67, v67, v75
    v_mul_f32 v68, v68, v76
    v_mul_f32 v69, v69, v77
    s_waitcnt lgkmcnt(8)
    v_mfma_f32_32x32x16_bf16 v[80:95], a[112:115], a[92:95], v[80:95]
    ds_read_b64_tr_b16 a[136:137], v194 offset:49152
    ds_read_b64_tr_b16 a[138:139], v194 offset:49664
    v_mul_f32 v70, v70, v78
    v_mul_f32 v71, v71, v79
    v_add_f32 v168, 1.0, v168
    v_mfma_f32_32x32x16_bf16 v[96:111], a[116:119], a[92:95], v[96:111]
    ds_read_b64_tr_b16 a[140:141], v195 offset:49152
    ds_read_b64_tr_b16 a[142:143], v195 offset:49664
    s_add_u32 m0, s56, 17408
    s_add_u32 s71, s66, 974848
    buffer_load_dwordx4 v5, s[20:23], s71 offen lds
    s_waitcnt lgkmcnt(8)
    v_mfma_f32_32x32x16_bf16 v[112:127], a[120:123], a[92:95], v[112:127]
    ds_read_b64_tr_b16 a[224:225], v192 offset:51200
    ds_read_b64_tr_b16 a[226:227], v192 offset:51712
    v_add_f32 v169, 1.0, v169
    v_add_f32 v170, 1.0, v170
    v_add_f32 v171, 1.0, v171
    v_mfma_f32_32x32x16_bf16 v[128:143], a[124:127], a[92:95], v[128:143]
    ds_read_b64_tr_b16 a[228:229], v193 offset:51200
    ds_read_b64_tr_b16 a[230:231], v193 offset:51712
    v_add_f32 v172, 1.0, v172
    v_add_f32 v173, 1.0, v173
    v_add_f32_e64 v174, 1.0, v174
    v_add_f32 v175, 1.0, v175
    s_waitcnt lgkmcnt(8)
    v_mfma_f32_32x32x16_bf16 v[80:95], a[128:131], a[96:99], v[80:95]
    ds_read_b64_tr_b16 a[232:233], v194 offset:51200
    ds_read_b64_tr_b16 a[234:235], v194 offset:51712
    s_add_u32 m0, s56, 24576
    s_add_u32 s71, s66, 917504
    buffer_load_dwordx4 v6, s[24:27], s71 offen lds
    v_mfma_f32_32x32x16_bf16 v[96:111], a[132:135], a[96:99], v[96:111]
    ds_read_b64_tr_b16 a[236:237], v195 offset:51200
    ds_read_b64_tr_b16 a[238:239], v195 offset:51712
    v_rcp_f32_e64 v168, v168
    v_rcp_f32 v169, v169
    s_waitcnt lgkmcnt(8)
    v_mfma_f32_32x32x16_bf16 v[112:127], a[136:139], a[96:99], v[112:127]
    ds_read_b64_tr_b16 a[112:113], v192 offset:53248
    ds_read_b64_tr_b16 a[114:115], v192 offset:53760
    v_rcp_f32 v170, v170
    v_rcp_f32 v171, v171
    v_mfma_f32_32x32x16_bf16 v[128:143], a[140:143], a[96:99], v[128:143]
    ds_read_b64_tr_b16 a[116:117], v193 offset:53248
    ds_read_b64_tr_b16 a[118:119], v193 offset:53760
    s_add_u32 m0, s56, 25600
    s_add_u32 s71, s66, 974848
    buffer_load_dwordx4 v6, s[24:27], s71 offen lds
    s_waitcnt lgkmcnt(8)
    v_mfma_f32_32x32x16_bf16 v[80:95], a[224:227], a[100:103], v[80:95]
    ds_read_b64_tr_b16 a[120:121], v194 offset:53248
    ds_read_b64_tr_b16 a[122:123], v194 offset:53760
    v_rcp_f32 v172, v172
    v_mfma_f32_32x32x16_bf16 v[96:111], a[228:231], a[100:103], v[96:111]
    ds_read_b64_tr_b16 a[124:125], v195 offset:53248
    ds_read_b64_tr_b16 a[126:127], v195 offset:53760
    v_rcp_f32 v173, v173
    v_rcp_f32 v174, v174
    s_waitcnt lgkmcnt(8)
    v_mfma_f32_32x32x16_bf16 v[112:127], a[232:235], a[100:103], v[112:127]
    ds_read_b64_tr_b16 a[128:129], v192 offset:55296
    ds_read_b64_tr_b16 a[130:131], v192 offset:55808
    v_rcp_f32 v175, v175
    v_mul_f32 v64, v64, v168
    v_mul_f32 v65, v65, v169
    v_mfma_f32_32x32x16_bf16 v[128:143], a[236:239], a[100:103], v[128:143]
    ds_read_b64_tr_b16 a[132:133], v193 offset:55296
    ds_read_b64_tr_b16 a[134:135], v193 offset:55808
    v_mul_f32 v66, v66, v170
    v_mul_f32 v67, v67, v171
    v_mul_f32_e64 v68, v68, v172
    v_mul_f32 v69, v69, v173
    s_waitcnt lgkmcnt(8)
    v_mfma_f32_32x32x16_bf16 v[80:95], a[112:115], a[104:107], v[80:95]
    ds_read_b64_tr_b16 a[136:137], v194 offset:55296
    ds_read_b64_tr_b16 a[138:139], v194 offset:55808
    v_mul_f32 v70, v70, v174
    v_mul_f32 v71, v71, v175
    v_cvt_pk_bf16_f32 v72, v64, v65
    v_mfma_f32_32x32x16_bf16 v[96:111], a[116:119], a[104:107], v[96:111]
    ds_read_b64_tr_b16 a[140:141], v195 offset:55296
    ds_read_b64_tr_b16 a[142:143], v195 offset:55808
    v_cvt_pk_bf16_f32 v73, v66, v67
    v_cvt_pk_bf16_f32 v74, v68, v69
    v_cvt_pk_bf16_f32 v75, v70, v71
    s_waitcnt lgkmcnt(8)
    v_mfma_f32_32x32x16_bf16 v[112:127], a[120:123], a[104:107], v[112:127]
    s_waitcnt vmcnt(9)
    s_barrier
    ds_read_b64_tr_b16 a[224:225], v204 offset:49152
    ds_read_b64_tr_b16 a[226:227], v204 offset:49408
    s_add_u32 m0, s58, 32768
    s_add_u32 s71, s67, 1376256
    buffer_load_dwordx4 v5, s[20:23], s71 offen lds
    v_mfma_f32_32x32x16_bf16 v[128:143], a[124:127], a[104:107], v[128:143]
    ds_read_b64_tr_b16 a[228:229], v205 offset:49152
    ds_read_b64_tr_b16 a[230:231], v205 offset:49408
    buffer_store_dwordx4 v[72:75], v11, s[40:43], s68 offen offset:3072 sc1
    s_waitcnt lgkmcnt(8)
    v_mfma_f32_32x32x16_bf16 v[80:95], a[128:131], a[108:111], v[80:95]
    ds_read_b64_tr_b16 a[232:233], v204 offset:50176
    ds_read_b64_tr_b16 a[234:235], v204 offset:50432
    buffer_load_dword v13, off, s[36:39], s87 sc1
    v_mfma_f32_32x32x16_bf16 v[96:111], a[132:135], a[108:111], v[96:111]
    ds_read_b64_tr_b16 a[236:237], v205 offset:50176
    ds_read_b64_tr_b16 a[238:239], v205 offset:50432
    s_add_u32 m0, s58, 40960
    s_add_u32 s71, s67, 1376256
    buffer_load_dwordx4 v6, s[24:27], s71 offen lds
    s_waitcnt lgkmcnt(8)
    v_mfma_f32_32x32x16_bf16 v[112:127], a[136:139], a[108:111], v[112:127]
    ds_read_b64_tr_b16 a[112:113], v204 offset:51200
    ds_read_b64_tr_b16 a[114:115], v204 offset:51456
    v_mfma_f32_32x32x16_bf16 v[128:143], a[140:143], a[108:111], v[128:143]
    ds_read_b64_tr_b16 a[116:117], v205 offset:51200
    ds_read_b64_tr_b16 a[118:119], v205 offset:51456
    s_waitcnt lgkmcnt(8)
    v_mfma_f32_32x32x16_bf16 v[16:31], a[224:227], a[0:3], 0
    ds_read_b64_tr_b16 a[120:121], v204 offset:52224
    ds_read_b64_tr_b16 a[122:123], v204 offset:52480
    v_mfma_f32_32x32x16_bf16 v[32:47], a[228:231], a[0:3], 0
    ds_read_b64_tr_b16 a[124:125], v205 offset:52224
    ds_read_b64_tr_b16 a[126:127], v205 offset:52480
    v_mul_f32 v168, v8, v80
    v_mul_f32 v169, v8, v81
    v_mul_f32 v170, v8, v82
    v_mul_f32 v171, v8, v83
    v_mul_f32 v172, v8, v84
    v_mul_f32 v173, v8, v85
    v_mul_f32_e64 v174, v8, v86
    v_mul_f32 v175, v8, v87
    s_waitcnt lgkmcnt(8)
    v_mfma_f32_32x32x16_bf16 v[16:31], a[232:235], a[4:7], v[16:31]
    ds_read_b64_tr_b16 a[128:129], v204 offset:53248
    ds_read_b64_tr_b16 a[130:131], v204 offset:53504
    v_exp_f32 v168, v168
    v_exp_f32 v169, v169
    v_exp_f32 v170, v170
    v_exp_f32 v171, v171
    v_mfma_f32_32x32x16_bf16 v[32:47], a[236:239], a[4:7], v[32:47]
    ds_read_b64_tr_b16 a[132:133], v205 offset:53248
    ds_read_b64_tr_b16 a[134:135], v205 offset:53504
    v_exp_f32 v172, v172
    v_exp_f32 v173, v173
    v_exp_f32 v174, v174
    v_exp_f32 v175, v175
    v_mul_f32 v80, v80, v88
    s_waitcnt lgkmcnt(8)
    v_mfma_f32_32x32x16_bf16 v[16:31], a[112:115], a[8:11], v[16:31]
    ds_read_b64_tr_b16 a[136:137], v204 offset:54272
    ds_read_b64_tr_b16 a[138:139], v204 offset:54528
    v_mul_f32 v81, v81, v89
    v_mul_f32 v82, v82, v90
    v_mul_f32 v83, v83, v91
    v_mul_f32 v84, v84, v92
    v_mul_f32 v85, v85, v93
    v_mul_f32 v86, v86, v94
    v_mul_f32 v87, v87, v95
    v_add_f32 v168, 1.0, v168
    v_mfma_f32_32x32x16_bf16 v[32:47], a[116:119], a[8:11], v[32:47]
    ds_read_b64_tr_b16 a[140:141], v205 offset:54272
    ds_read_b64_tr_b16 a[142:143], v205 offset:54528
    v_add_f32 v169, 1.0, v169
    v_add_f32 v170, 1.0, v170
    v_add_f32 v171, 1.0, v171
    v_add_f32 v172, 1.0, v172
    v_add_f32 v173, 1.0, v173
    v_add_f32 v174, 1.0, v174
    v_add_f32 v175, 1.0, v175
    s_waitcnt lgkmcnt(8)
    v_mfma_f32_32x32x16_bf16 v[16:31], a[120:123], a[12:15], v[16:31]
    ds_read_b64_tr_b16 a[224:225], v204 offset:55296
    ds_read_b64_tr_b16 a[226:227], v204 offset:55552
    v_rcp_f32 v168, v168
    v_rcp_f32 v169, v169
    v_rcp_f32 v170, v170
    v_rcp_f32 v171, v171
    v_mfma_f32_32x32x16_bf16 v[32:47], a[124:127], a[12:15], v[32:47]
    ds_read_b64_tr_b16 a[228:229], v205 offset:55296
    ds_read_b64_tr_b16 a[230:231], v205 offset:55552
    v_rcp_f32 v172, v172
    v_rcp_f32 v173, v173
    v_rcp_f32 v174, v174
    v_rcp_f32 v175, v175
    v_mul_f32 v80, v80, v168
    s_waitcnt lgkmcnt(8)
    v_mfma_f32_32x32x16_bf16 v[16:31], a[128:131], a[16:19], v[16:31]
    ds_read_b64_tr_b16 a[232:233], v204 offset:56320
    ds_read_b64_tr_b16 a[234:235], v204 offset:56576
    v_mul_f32 v81, v81, v169
    v_mul_f32 v82, v82, v170
    v_mul_f32 v83, v83, v171
    v_mul_f32 v84, v84, v172
    v_mul_f32 v85, v85, v173
    v_mul_f32 v86, v86, v174
    v_mul_f32_e64 v87, v87, v175
    v_cvt_pk_bf16_f32 v88, v80, v81
    v_mfma_f32_32x32x16_bf16 v[32:47], a[132:135], a[16:19], v[32:47]
    ds_read_b64_tr_b16 a[236:237], v205 offset:56320
    ds_read_b64_tr_b16 a[238:239], v205 offset:56576
    v_cvt_pk_bf16_f32 v89, v82, v83
    v_cvt_pk_bf16_f32 v90, v84, v85
    v_cvt_pk_bf16_f32 v91, v86, v87
    buffer_store_dwordx4 v[88:91], v11, s[40:43], s69 offen offset:0 sc1
    v_mul_f32 v168, v8, v96
    s_waitcnt lgkmcnt(8)
    v_mfma_f32_32x32x16_bf16 v[16:31], a[136:139], a[20:23], v[16:31]
    s_waitcnt vmcnt(9)
    s_barrier
    ds_read_b64_tr_b16 a[112:113], v200 offset:0
    ds_read_b64_tr_b16 a[114:115], v200 offset:256
    s_add_u32 m0, s56, 49152
    s_add_u32 s71, s66, 64
    buffer_load_dwordx4 v5, s[20:23], s71 offen lds
    v_mul_f32 v169, v8, v97
    v_mfma_f32_32x32x16_bf16 v[32:47], a[140:143], a[20:23], v[32:47]
    ds_read_b64_tr_b16 a[116:117], v201 offset:0
    ds_read_b64_tr_b16 a[118:119], v201 offset:256
    v_mul_f32 v170, v8, v98
    v_mul_f32 v171, v8, v99
    v_mul_f32 v172, v8, v100
    v_mul_f32 v173, v8, v101
    v_mul_f32 v174, v8, v102
    v_mul_f32 v175, v8, v103
    v_exp_f32 v168, v168
    s_waitcnt lgkmcnt(8)
    v_mfma_f32_32x32x16_bf16 v[16:31], a[224:227], a[24:27], v[16:31]
    ds_read_b64_tr_b16 a[120:121], v200 offset:1024
    ds_read_b64_tr_b16 a[122:123], v200 offset:1280
    v_exp_f32 v169, v169
    v_exp_f32 v170, v170
    v_exp_f32 v171, v171
    v_exp_f32 v172, v172
    v_mfma_f32_32x32x16_bf16 v[32:47], a[228:231], a[24:27], v[32:47]
    ds_read_b64_tr_b16 a[124:125], v201 offset:1024
    ds_read_b64_tr_b16 a[126:127], v201 offset:1280
    s_add_u32 m0, s56, 50176
    s_add_u32 s71, s66, 57408
    buffer_load_dwordx4 v5, s[20:23], s71 offen lds
    v_exp_f32_e64 v173, v173
    v_exp_f32 v174, v174
    s_waitcnt lgkmcnt(8)
    v_mfma_f32_32x32x16_bf16 v[16:31], a[232:235], a[28:31], v[16:31]
    ds_read_b64_tr_b16 a[128:129], v200 offset:2048
    ds_read_b64_tr_b16 a[130:131], v200 offset:2304
    v_exp_f32 v175, v175
    v_mul_f32 v96, v96, v104
    v_mul_f32 v97, v97, v105
    v_mul_f32 v98, v98, v106
    v_mul_f32 v99, v99, v107
    v_mul_f32 v100, v100, v108
    v_mfma_f32_32x32x16_bf16 v[32:47], a[236:239], a[28:31], v[32:47]
    ds_read_b64_tr_b16 a[132:133], v201 offset:2048
    ds_read_b64_tr_b16 a[134:135], v201 offset:2304
    v_mul_f32 v101, v101, v109
    v_mul_f32 v102, v102, v110
    v_mul_f32 v103, v103, v111
    v_add_f32 v168, 1.0, v168
    v_add_f32 v169, 1.0, v169
    v_add_f32 v170, 1.0, v170
    v_add_f32 v171, 1.0, v171
    v_add_f32 v172, 1.0, v172
    v_add_f32 v173, 1.0, v173
    s_waitcnt lgkmcnt(8)
    v_mfma_f32_32x32x16_bf16 v[16:31], a[112:115], a[32:35], v[16:31]
    ds_read_b64_tr_b16 a[136:137], v200 offset:3072
    ds_read_b64_tr_b16 a[138:139], v200 offset:3328
    s_add_u32 m0, s56, 57344
    s_add_u32 s71, s66, 64
    buffer_load_dwordx4 v6, s[24:27], s71 offen lds
    v_add_f32 v174, 1.0, v174
    v_add_f32 v175, 1.0, v175
    v_mfma_f32_32x32x16_bf16 v[32:47], a[116:119], a[32:35], v[32:47]
    ds_read_b64_tr_b16 a[140:141], v201 offset:3072
    ds_read_b64_tr_b16 a[142:143], v201 offset:3328
    v_rcp_f32 v168, v168
    v_rcp_f32 v169, v169
    v_rcp_f32 v170, v170
    v_rcp_f32 v171, v171
    s_waitcnt lgkmcnt(8)
    v_mfma_f32_32x32x16_bf16 v[16:31], a[120:123], a[36:39], v[16:31]
    ds_read_b64_tr_b16 a[224:225], v200 offset:4096
    ds_read_b64_tr_b16 a[226:227], v200 offset:4352
    v_rcp_f32 v172, v172
    v_rcp_f32 v173, v173
    v_rcp_f32 v174, v174
    v_rcp_f32 v175, v175
    v_mul_f32_e64 v96, v96, v168
    v_mfma_f32_32x32x16_bf16 v[32:47], a[124:127], a[36:39], v[32:47]
    ds_read_b64_tr_b16 a[228:229], v201 offset:4096
    ds_read_b64_tr_b16 a[230:231], v201 offset:4352
    s_add_u32 m0, s56, 58368
    s_add_u32 s71, s66, 57408
    buffer_load_dwordx4 v6, s[24:27], s71 offen lds
    v_mul_f32 v97, v97, v169
    v_mul_f32 v98, v98, v170
    v_mul_f32 v99, v99, v171
    s_waitcnt lgkmcnt(8)
    v_mfma_f32_32x32x16_bf16 v[16:31], a[128:131], a[40:43], v[16:31]
    ds_read_b64_tr_b16 a[232:233], v200 offset:5120
    ds_read_b64_tr_b16 a[234:235], v200 offset:5376
    v_mul_f32 v100, v100, v172
    v_mul_f32 v101, v101, v173
    v_mul_f32 v102, v102, v174
    v_mul_f32 v103, v103, v175
    v_cvt_pk_bf16_f32 v104, v96, v97
    v_cvt_pk_bf16_f32 v105, v98, v99
    v_cvt_pk_bf16_f32 v106, v100, v101
    v_cvt_pk_bf16_f32 v107, v102, v103
    v_mfma_f32_32x32x16_bf16 v[32:47], a[132:135], a[40:43], v[32:47]
    ds_read_b64_tr_b16 a[236:237], v201 offset:5120
    ds_read_b64_tr_b16 a[238:239], v201 offset:5376
    buffer_store_dwordx4 v[104:107], v11, s[40:43], s69 offen offset:1024 sc1
    v_mul_f32 v168, v8, v112
    v_mul_f32 v169, v8, v113
    v_mul_f32_e64 v170, v8, v114
    v_mul_f32 v171, v8, v115
    s_waitcnt lgkmcnt(8)
    v_mfma_f32_32x32x16_bf16 v[16:31], a[136:139], a[44:47], v[16:31]
    ds_read_b64_tr_b16 a[112:113], v200 offset:6144
    ds_read_b64_tr_b16 a[114:115], v200 offset:6400
    v_mul_f32 v172, v8, v116
    v_mul_f32 v173, v8, v117
    v_mul_f32 v174, v8, v118
    v_mul_f32 v175, v8, v119
    v_exp_f32 v168, v168
    v_exp_f32 v169, v169
    v_mfma_f32_32x32x16_bf16 v[32:47], a[140:143], a[44:47], v[32:47]
    ds_read_b64_tr_b16 a[116:117], v201 offset:6144
    ds_read_b64_tr_b16 a[118:119], v201 offset:6400
    v_exp_f32 v170, v170
    v_exp_f32 v171, v171
    v_exp_f32_e64 v172, v172
    v_exp_f32 v173, v173
    s_waitcnt lgkmcnt(8)
    v_mfma_f32_32x32x16_bf16 v[16:31], a[224:227], a[48:51], v[16:31]
    ds_read_b64_tr_b16 a[120:121], v200 offset:7168
    ds_read_b64_tr_b16 a[122:123], v200 offset:7424
    v_exp_f32 v174, v174
    v_exp_f32 v175, v175
    v_mul_f32 v112, v112, v120
    v_mul_f32 v113, v113, v121
    v_mul_f32 v114, v114, v122
    v_mul_f32 v115, v115, v123
    v_mfma_f32_32x32x16_bf16 v[32:47], a[228:231], a[48:51], v[32:47]
    ds_read_b64_tr_b16 a[124:125], v201 offset:7168
    ds_read_b64_tr_b16 a[126:127], v201 offset:7424
    v_mul_f32 v116, v116, v124
    v_mul_f32 v117, v117, v125
    v_mul_f32 v118, v118, v126
    v_mul_f32 v119, v119, v127
    v_add_f32 v168, 1.0, v168
    v_add_f32 v169, 1.0, v169
    v_add_f32 v170, 1.0, v170
    v_add_f32 v171, 1.0, v171
    v_add_f32 v172, 1.0, v172
    s_waitcnt lgkmcnt(8)
    v_mfma_f32_32x32x16_bf16 v[16:31], a[232:235], a[52:55], v[16:31]
    s_waitcnt vmcnt(10)
    s_barrier
    ds_read_b64_tr_b16 a[128:129], v200 offset:16384
    ds_read_b64_tr_b16 a[130:131], v200 offset:16640
    s_add_u32 m0, s56, 65536
    s_add_u32 s71, s66, 458816
    buffer_load_dwordx4 v5, s[20:23], s71 offen lds
    v_mfma_f32_32x32x16_bf16 v[32:47], a[236:239], a[52:55], v[32:47]
    ds_read_b64_tr_b16 a[132:133], v201 offset:16384
    ds_read_b64_tr_b16 a[134:135], v201 offset:16640
    v_add_f32 v173, 1.0, v173
    v_add_f32 v174, 1.0, v174
    v_add_f32 v175, 1.0, v175
    v_rcp_f32 v168, v168
    v_rcp_f32_e64 v169, v169
    v_rcp_f32 v170, v170
    s_waitcnt lgkmcnt(8)
    v_mfma_f32_32x32x16_bf16 v[16:31], a[112:115], a[56:59], v[16:31]
    ds_read_b64_tr_b16 a[136:137], v200 offset:17408
    ds_read_b64_tr_b16 a[138:139], v200 offset:17664
    v_rcp_f32 v171, v171
    v_rcp_f32 v172, v172
    v_rcp_f32 v173, v173
    v_rcp_f32 v174, v174
    v_mfma_f32_32x32x16_bf16 v[32:47], a[116:119], a[56:59], v[32:47]
    ds_read_b64_tr_b16 a[140:141], v201 offset:17408
    ds_read_b64_tr_b16 a[142:143], v201 offset:17664
    s_add_u32 m0, s56, 66560
    s_add_u32 s71, s66, 516160
    buffer_load_dwordx4 v5, s[20:23], s71 offen lds
    v_rcp_f32 v175, v175
    v_mul_f32 v112, v112, v168
    s_waitcnt lgkmcnt(8)
    v_mfma_f32_32x32x16_bf16 v[16:31], a[120:123], a[60:63], v[16:31]
    ds_read_b64_tr_b16 a[224:225], v200 offset:18432
    ds_read_b64_tr_b16 a[226:227], v200 offset:18688
    v_mul_f32 v113, v113, v169
    v_mul_f32 v114, v114, v170
    v_mul_f32 v115, v115, v171
    v_mul_f32 v116, v116, v172
    v_mul_f32 v117, v117, v173
    v_mul_f32 v118, v118, v174
    v_mul_f32 v119, v119, v175
    v_cvt_pk_bf16_f32 v120, v112, v113
    v_mfma_f32_32x32x16_bf16 v[32:47], a[124:127], a[60:63], v[32:47]
    ds_read_b64_tr_b16 a[228:229], v201 offset:18432
    ds_read_b64_tr_b16 a[230:231], v201 offset:18688
    v_cvt_pk_bf16_f32 v121, v114, v115
    v_cvt_pk_bf16_f32 v122, v116, v117
    v_cvt_pk_bf16_f32 v123, v118, v119
    buffer_store_dwordx4 v[120:123], v11, s[40:43], s69 offen offset:2048 sc1
    v_mul_f32 v168, v8, v128
    s_waitcnt lgkmcnt(8)
    v_mfma_f32_32x32x16_bf16 v[16:31], a[128:131], a[64:67], v[16:31]
    ds_read_b64_tr_b16 a[232:233], v200 offset:19456
    ds_read_b64_tr_b16 a[234:235], v200 offset:19712
    s_add_u32 m0, s56, 73728
    s_add_u32 s71, s66, 458816
    buffer_load_dwordx4 v6, s[24:27], s71 offen lds
    v_mul_f32 v169, v8, v129
    v_mul_f32 v170, v8, v130
    v_mul_f32 v171, v8, v131
    v_mfma_f32_32x32x16_bf16 v[32:47], a[132:135], a[64:67], v[32:47]
    ds_read_b64_tr_b16 a[236:237], v201 offset:19456
    ds_read_b64_tr_b16 a[238:239], v201 offset:19712
    v_mul_f32 v172, v8, v132
    v_mul_f32 v173, v8, v133
    v_mul_f32 v174, v8, v134
    v_mul_f32 v175, v8, v135
    v_exp_f32 v168, v168
    v_exp_f32 v169, v169
    s_waitcnt lgkmcnt(8)
    v_mfma_f32_32x32x16_bf16 v[16:31], a[136:139], a[68:71], v[16:31]
    ds_read_b64_tr_b16 a[112:113], v200 offset:20480
    ds_read_b64_tr_b16 a[114:115], v200 offset:20736
    v_exp_f32 v170, v170
    v_exp_f32 v171, v171
    v_exp_f32 v172, v172
    v_exp_f32 v173, v173
    v_mfma_f32_32x32x16_bf16 v[32:47], a[140:143], a[68:71], v[32:47]
    ds_read_b64_tr_b16 a[116:117], v201 offset:20480
    ds_read_b64_tr_b16 a[118:119], v201 offset:20736
    s_add_u32 m0, s56, 74752
    s_add_u32 s71, s66, 516160
    buffer_load_dwordx4 v6, s[24:27], s71 offen lds
    v_exp_f32 v174, v174
    v_exp_f32 v175, v175
    s_waitcnt lgkmcnt(8)
    v_mfma_f32_32x32x16_bf16 v[16:31], a[224:227], a[72:75], v[16:31]
    ds_read_b64_tr_b16 a[120:121], v200 offset:21504
    ds_read_b64_tr_b16 a[122:123], v200 offset:21760
    v_mul_f32 v128, v128, v136
    v_mul_f32 v129, v129, v137
    v_mul_f32 v130, v130, v138
    v_mul_f32 v131, v131, v139
    v_mul_f32 v132, v132, v140
    v_mul_f32 v133, v133, v141
    v_mul_f32 v134, v134, v142
    v_mfma_f32_32x32x16_bf16 v[32:47], a[228:231], a[72:75], v[32:47]
    ds_read_b64_tr_b16 a[124:125], v201 offset:21504
    ds_read_b64_tr_b16 a[126:127], v201 offset:21760
    v_mul_f32 v135, v135, v143
    v_add_f32 v168, 1.0, v168
    v_add_f32 v169, 1.0, v169
    v_add_f32 v170, 1.0, v170
    v_add_f32 v171, 1.0, v171
    v_add_f32 v172, 1.0, v172
    v_add_f32 v173, 1.0, v173
    v_add_f32 v174, 1.0, v174
    v_add_f32 v175, 1.0, v175
    s_waitcnt lgkmcnt(8)
    v_mfma_f32_32x32x16_bf16 v[16:31], a[232:235], a[76:79], v[16:31]
    ds_read_b64_tr_b16 a[128:129], v200 offset:22528
    ds_read_b64_tr_b16 a[130:131], v200 offset:22784
    v_rcp_f32 v168, v168
    v_rcp_f32 v169, v169
    v_rcp_f32 v170, v170
    v_rcp_f32 v171, v171
    v_mfma_f32_32x32x16_bf16 v[32:47], a[236:239], a[76:79], v[32:47]
    ds_read_b64_tr_b16 a[132:133], v201 offset:22528
    ds_read_b64_tr_b16 a[134:135], v201 offset:22784
    v_rcp_f32 v172, v172
    v_rcp_f32 v173, v173
    v_rcp_f32_e64 v174, v174
    v_rcp_f32 v175, v175
    s_waitcnt lgkmcnt(8)
    v_mfma_f32_32x32x16_bf16 v[16:31], a[112:115], a[80:83], v[16:31]
    ds_read_b64_tr_b16 a[136:137], v200 offset:23552
    ds_read_b64_tr_b16 a[138:139], v200 offset:23808
    v_mul_f32 v128, v128, v168
    v_mul_f32 v129, v129, v169
    v_mul_f32 v130, v130, v170
    v_mul_f32 v131, v131, v171
    v_mul_f32 v132, v132, v172
    v_mul_f32 v133, v133, v173
    v_mul_f32 v134, v134, v174
    v_mul_f32 v135, v135, v175
    v_mfma_f32_32x32x16_bf16 v[32:47], a[116:119], a[80:83], v[32:47]
    ds_read_b64_tr_b16 a[140:141], v201 offset:23552
    ds_read_b64_tr_b16 a[142:143], v201 offset:23808
    v_cvt_pk_bf16_f32 v136, v128, v129
    v_cvt_pk_bf16_f32 v137, v130, v131
    v_cvt_pk_bf16_f32 v138, v132, v133
    v_cvt_pk_bf16_f32 v139, v134, v135
    buffer_store_dwordx4 v[136:139], v11, s[40:43], s69 offen offset:3072 sc1
    s_waitcnt lgkmcnt(8)
    v_mfma_f32_32x32x16_bf16 v[16:31], a[120:123], a[84:87], v[16:31]
    s_waitcnt vmcnt(12)
    s_barrier
    ds_read_b64_tr_b16 a[224:225], v200 offset:32768
    ds_read_b64_tr_b16 a[226:227], v200 offset:33024
    s_add_u32 m0, s56, 0
    s_add_u32 s71, s66, 917568
    buffer_load_dwordx4 v5, s[20:23], s71 offen lds
    v_mfma_f32_32x32x16_bf16 v[32:47], a[124:127], a[84:87], v[32:47]
    ds_read_b64_tr_b16 a[228:229], v201 offset:32768
    ds_read_b64_tr_b16 a[230:231], v201 offset:33024
    s_waitcnt lgkmcnt(8)
    v_mfma_f32_32x32x16_bf16 v[16:31], a[128:131], a[88:91], v[16:31]
    ds_read_b64_tr_b16 a[232:233], v200 offset:33792
    ds_read_b64_tr_b16 a[234:235], v200 offset:34048
    v_mfma_f32_32x32x16_bf16 v[32:47], a[132:135], a[88:91], v[32:47]
    ds_read_b64_tr_b16 a[236:237], v201 offset:33792
    ds_read_b64_tr_b16 a[238:239], v201 offset:34048
    s_add_u32 m0, s56, 1024
    s_add_u32 s71, s66, 974912
    buffer_load_dwordx4 v5, s[20:23], s71 offen lds
    s_waitcnt lgkmcnt(8)
    v_mfma_f32_32x32x16_bf16 v[16:31], a[136:139], a[92:95], v[16:31]
    ds_read_b64_tr_b16 a[112:113], v200 offset:34816
    ds_read_b64_tr_b16 a[114:115], v200 offset:35072
    v_mfma_f32_32x32x16_bf16 v[32:47], a[140:143], a[92:95], v[32:47]
    ds_read_b64_tr_b16 a[116:117], v201 offset:34816
    ds_read_b64_tr_b16 a[118:119], v201 offset:35072
    s_waitcnt lgkmcnt(8)
    v_mfma_f32_32x32x16_bf16 v[16:31], a[224:227], a[96:99], v[16:31]
    ds_read_b64_tr_b16 a[120:121], v200 offset:35840
    ds_read_b64_tr_b16 a[122:123], v200 offset:36096
    s_add_u32 m0, s56, 8192
    s_add_u32 s71, s66, 917568
    buffer_load_dwordx4 v6, s[24:27], s71 offen lds
    v_mfma_f32_32x32x16_bf16 v[32:47], a[228:231], a[96:99], v[32:47]
    ds_read_b64_tr_b16 a[124:125], v201 offset:35840
    ds_read_b64_tr_b16 a[126:127], v201 offset:36096
    s_waitcnt lgkmcnt(8)
    v_mfma_f32_32x32x16_bf16 v[16:31], a[232:235], a[100:103], v[16:31]
    s_waitcnt vmcnt(10)
    s_barrier
    ds_read_b64_tr_b16 a[128:129], v200 offset:49152
    ds_read_b64_tr_b16 a[130:131], v200 offset:49408
    v_mfma_f32_32x32x16_bf16 v[32:47], a[236:239], a[100:103], v[32:47]
    ds_read_b64_tr_b16 a[132:133], v201 offset:49152
    ds_read_b64_tr_b16 a[134:135], v201 offset:49408
    s_add_u32 m0, s56, 9216
    s_add_u32 s71, s66, 974912
    buffer_load_dwordx4 v6, s[24:27], s71 offen lds
    s_waitcnt lgkmcnt(8)
    v_mfma_f32_32x32x16_bf16 v[16:31], a[112:115], a[104:107], v[16:31]
    ds_read_b64_tr_b16 a[136:137], v200 offset:50176
    ds_read_b64_tr_b16 a[138:139], v200 offset:50432
    v_mfma_f32_32x32x16_bf16 v[32:47], a[116:119], a[104:107], v[32:47]
    ds_read_b64_tr_b16 a[140:141], v201 offset:50176
    ds_read_b64_tr_b16 a[142:143], v201 offset:50432
    s_waitcnt lgkmcnt(8)
    v_mfma_f32_32x32x16_bf16 v[16:31], a[120:123], a[108:111], v[16:31]
    ds_read_b64_tr_b16 a[224:225], v200 offset:51200
    ds_read_b64_tr_b16 a[226:227], v200 offset:51456
    s_add_u32 m0, s58, 16384
    s_add_u32 s71, s67, 1376320
    buffer_load_dwordx4 v5, s[20:23], s71 offen lds
    v_mfma_f32_32x32x16_bf16 v[32:47], a[124:127], a[108:111], v[32:47]
    ds_read_b64_tr_b16 a[228:229], v201 offset:51200
    ds_read_b64_tr_b16 a[230:231], v201 offset:51456
    s_waitcnt lgkmcnt(8)
    v_mfma_f32_32x32x16_bf16 v[48:63], a[128:131], a[0:3], 0
    ds_read_b64_tr_b16 a[232:233], v200 offset:52224
    ds_read_b64_tr_b16 a[234:235], v200 offset:52480
    v_mfma_f32_32x32x16_bf16 v[64:79], a[132:135], a[0:3], 0
    ds_read_b64_tr_b16 a[236:237], v201 offset:52224
    ds_read_b64_tr_b16 a[238:239], v201 offset:52480
    s_add_u32 m0, s58, 24576
    s_add_u32 s71, s67, 1376320
    buffer_load_dwordx4 v6, s[24:27], s71 offen lds
    s_waitcnt lgkmcnt(8)
    v_mfma_f32_32x32x16_bf16 v[48:63], a[136:139], a[4:7], v[48:63]
    ds_read_b64_tr_b16 a[112:113], v200 offset:53248
    ds_read_b64_tr_b16 a[114:115], v200 offset:53504
    v_mul_f32 v168, v8, v16
    v_mul_f32 v169, v8, v17
    v_mul_f32 v170, v8, v18
    v_mfma_f32_32x32x16_bf16 v[64:79], a[140:143], a[4:7], v[64:79]
    ds_read_b64_tr_b16 a[116:117], v201 offset:53248
    ds_read_b64_tr_b16 a[118:119], v201 offset:53504
    v_mul_f32 v171, v8, v19
    v_mul_f32 v172, v8, v20
    v_mul_f32 v173, v8, v21
    v_mul_f32 v174, v8, v22
    s_waitcnt lgkmcnt(8)
    v_mfma_f32_32x32x16_bf16 v[48:63], a[224:227], a[8:11], v[48:63]
    ds_read_b64_tr_b16 a[120:121], v200 offset:54272
    ds_read_b64_tr_b16 a[122:123], v200 offset:54528
    v_mul_f32 v175, v8, v23
    v_exp_f32 v168, v168
    v_mfma_f32_32x32x16_bf16 v[64:79], a[228:231], a[8:11], v[64:79]
    ds_read_b64_tr_b16 a[124:125], v201 offset:54272
    ds_read_b64_tr_b16 a[126:127], v201 offset:54528
    v_exp_f32 v169, v169
    v_exp_f32 v170, v170
    s_waitcnt lgkmcnt(8)
    v_mfma_f32_32x32x16_bf16 v[48:63], a[232:235], a[12:15], v[48:63]
    ds_read_b64_tr_b16 a[128:129], v200 offset:55296
    ds_read_b64_tr_b16 a[130:131], v200 offset:55552
    v_exp_f32 v171, v171
    v_mfma_f32_32x32x16_bf16 v[64:79], a[236:239], a[12:15], v[64:79]
    ds_read_b64_tr_b16 a[132:133], v201 offset:55296
    ds_read_b64_tr_b16 a[134:135], v201 offset:55552
    v_exp_f32_e64 v172, v172
    v_exp_f32 v173, v173
    s_waitcnt lgkmcnt(8)
    v_mfma_f32_32x32x16_bf16 v[48:63], a[112:115], a[16:19], v[48:63]
    ds_read_b64_tr_b16 a[136:137], v200 offset:56320
    ds_read_b64_tr_b16 a[138:139], v200 offset:56576
    v_exp_f32 v174, v174
    v_exp_f32 v175, v175
    v_mfma_f32_32x32x16_bf16 v[64:79], a[116:119], a[16:19], v[64:79]
    ds_read_b64_tr_b16 a[140:141], v201 offset:56320
    ds_read_b64_tr_b16 a[142:143], v201 offset:56576
    v_mul_f32 v16, v16, v24
    v_mul_f32 v17, v17, v25
    v_mul_f32 v18, v18, v26
    s_waitcnt lgkmcnt(8)
    v_mfma_f32_32x32x16_bf16 v[48:63], a[120:123], a[20:23], v[48:63]
    s_waitcnt vmcnt(6)
    s_barrier
    v_readfirstlane_b32 s52, v13
    s_nop 1
    s_cmp_eq_u32 s52, 1
    s_cbranch_scc1 L_zok_38
    s_mov_b32 s91, 131072
L_zspin_39:
    buffer_load_dword v13, off, s[36:39], s87 sc1
    s_waitcnt vmcnt(0)
    v_readfirstlane_b32 s52, v13
    s_nop 1
    s_cmp_eq_u32 s52, 1
    s_cbranch_scc1 L_zok_38
    s_sub_u32 s91, s91, 1
    s_cmp_eq_u32 s91, 0
    s_cbranch_scc1 L_zok_38
    s_branch L_zspin_39
L_zok_38:
    s_cmp_lg_u32 s44, 0
    s_cbranch_scc1 L_nw0_40
    v_mov_b32 v253, 1
    s_mov_b64 exec, 1
    buffer_atomic_add v253, off, s[40:43], s76 sc1
    s_mov_b64 exec, -1
L_nw0_40:
    ds_read_b64_tr_b16 a[224:225], v204 offset:49152
    ds_read_b64_tr_b16 a[226:227], v204 offset:49408
    s_add_u32 m0, s57, 32768
    s_add_u32 s71, s3, 100352
    buffer_load_dwordx4 v238, s[28:31], s71 offen lds
    v_mfma_f32_32x32x16_bf16 v[64:79], a[124:127], a[20:23], v[64:79]
    ds_read_b64_tr_b16 a[228:229], v205 offset:49152
    ds_read_b64_tr_b16 a[230:231], v205 offset:49408
    v_mul_f32 v19, v19, v27
    v_mul_f32 v20, v20, v28
    v_mul_f32 v21, v21, v29
    v_mul_f32 v22, v22, v30
    s_waitcnt lgkmcnt(8)
    v_mfma_f32_32x32x16_bf16 v[48:63], a[128:131], a[24:27], v[48:63]
    ds_read_b64_tr_b16 a[232:233], v204 offset:50176
    ds_read_b64_tr_b16 a[234:235], v204 offset:50432
    v_mul_f32 v23, v23, v31
    v_add_f32 v168, 1.0, v168
    v_add_f32 v169, 1.0, v169
    v_mfma_f32_32x32x16_bf16 v[64:79], a[132:135], a[24:27], v[64:79]
    ds_read_b64_tr_b16 a[236:237], v205 offset:50176
    ds_read_b64_tr_b16 a[238:239], v205 offset:50432
    s_add_u32 m0, s57, 33792
    s_add_u32 s71, s3, 107520
    buffer_load_dwordx4 v238, s[28:31], s71 offen lds
    s_waitcnt lgkmcnt(8)
    v_mfma_f32_32x32x16_bf16 v[48:63], a[136:139], a[28:31], v[48:63]
    ds_read_b64_tr_b16 a[112:113], v204 offset:51200
    ds_read_b64_tr_b16 a[114:115], v204 offset:51456
    v_add_f32 v170, 1.0, v170
    v_add_f32 v171, 1.0, v171
    v_add_f32 v172, 1.0, v172
    v_mfma_f32_32x32x16_bf16 v[64:79], a[140:143], a[28:31], v[64:79]
    ds_read_b64_tr_b16 a[116:117], v205 offset:51200
    ds_read_b64_tr_b16 a[118:119], v205 offset:51456
    v_add_f32 v173, 1.0, v173
    v_add_f32 v174, 1.0, v174
    v_add_f32_e64 v175, 1.0, v175
    v_rcp_f32 v168, v168
    s_waitcnt lgkmcnt(8)
    v_mfma_f32_32x32x16_bf16 v[48:63], a[224:227], a[32:35], v[48:63]
    ds_read_b64_tr_b16 a[120:121], v204 offset:52224
    ds_read_b64_tr_b16 a[122:123], v204 offset:52480
    s_add_u32 m0, s57, 34816
    s_add_u32 s71, s3, 172032
    buffer_load_dwordx4 v238, s[28:31], s71 offen lds
    v_mfma_f32_32x32x16_bf16 v[64:79], a[228:231], a[32:35], v[64:79]
    ds_read_b64_tr_b16 a[124:125], v205 offset:52224
    ds_read_b64_tr_b16 a[126:127], v205 offset:52480
    v_rcp_f32 v169, v169
    v_rcp_f32 v170, v170
    s_waitcnt lgkmcnt(8)
    v_mfma_f32_32x32x16_bf16 v[48:63], a[232:235], a[36:39], v[48:63]
    ds_read_b64_tr_b16 a[128:129], v204 offset:53248
    ds_read_b64_tr_b16 a[130:131], v204 offset:53504
    v_rcp_f32 v171, v171
    v_mfma_f32_32x32x16_bf16 v[64:79], a[236:239], a[36:39], v[64:79]
    ds_read_b64_tr_b16 a[132:133], v205 offset:53248
    ds_read_b64_tr_b16 a[134:135], v205 offset:53504
    s_add_u32 m0, s57, 35840
    s_add_u32 s71, s3, 179200
    buffer_load_dwordx4 v238, s[28:31], s71 offen lds
    s_waitcnt lgkmcnt(8)
    v_mfma_f32_32x32x16_bf16 v[48:63], a[112:115], a[40:43], v[48:63]
    ds_read_b64_tr_b16 a[136:137], v204 offset:54272
    ds_read_b64_tr_b16 a[138:139], v204 offset:54528
    v_rcp_f32 v172, v172
    v_rcp_f32_e64 v173, v173
    v_mfma_f32_32x32x16_bf16 v[64:79], a[116:119], a[40:43], v[64:79]
    ds_read_b64_tr_b16 a[140:141], v205 offset:54272
    ds_read_b64_tr_b16 a[142:143], v205 offset:54528
    v_rcp_f32 v174, v174
    s_waitcnt lgkmcnt(8)
    v_mfma_f32_32x32x16_bf16 v[48:63], a[120:123], a[44:47], v[48:63]
    ds_read_b64_tr_b16 a[224:225], v204 offset:55296
    ds_read_b64_tr_b16 a[226:227], v204 offset:55552
    v_rcp_f32 v175, v175
    v_mul_f32 v16, v16, v168
    v_mul_f32 v17, v17, v169
    v_mfma_f32_32x32x16_bf16 v[64:79], a[124:127], a[44:47], v[64:79]
    ds_read_b64_tr_b16 a[228:229], v205 offset:55296
    ds_read_b64_tr_b16 a[230:231], v205 offset:55552
    v_mul_f32 v18, v18, v170
    v_mul_f32 v19, v19, v171
    v_mul_f32 v20, v20, v172
    v_mul_f32 v21, v21, v173
    s_waitcnt lgkmcnt(8)
    v_mfma_f32_32x32x16_bf16 v[48:63], a[128:131], a[48:51], v[48:63]
    ds_read_b64_tr_b16 a[232:233], v204 offset:56320
    ds_read_b64_tr_b16 a[234:235], v204 offset:56576
    v_mul_f32 v22, v22, v174
    v_mul_f32 v23, v23, v175
    v_cvt_pk_bf16_f32 v24, v16, v17
    v_mfma_f32_32x32x16_bf16 v[64:79], a[132:135], a[48:51], v[64:79]
    ds_read_b64_tr_b16 a[236:237], v205 offset:56320
    ds_read_b64_tr_b16 a[238:239], v205 offset:56576
    v_cvt_pk_bf16_f32 v25, v18, v19
    v_cvt_pk_bf16_f32 v26, v20, v21
    v_cvt_pk_bf16_f32 v27, v22, v23
    s_waitcnt lgkmcnt(8)
    v_mfma_f32_32x32x16_bf16 v[48:63], a[136:139], a[52:55], v[48:63]
    s_waitcnt vmcnt(6)
    s_barrier
    ds_read_b64_tr_b16 a[112:113], v200 offset:0
    ds_read_b64_tr_b16 a[114:115], v200 offset:256
    s_add_u32 m0, s57, 49152
    s_add_u32 s71, s3, 186368
    buffer_load_dwordx4 v238, s[28:31], s71 offen lds
    v_mfma_f32_32x32x16_bf16 v[64:79], a[140:143], a[52:55], v[64:79]
    ds_read_b64_tr_b16 a[116:117], v201 offset:0
    ds_read_b64_tr_b16 a[118:119], v201 offset:256
    buffer_store_dwordx4 v[24:27], v11, s[40:43], s70 offen offset:0 sc1
    s_waitcnt lgkmcnt(8)
    v_mfma_f32_32x32x16_bf16 v[48:63], a[224:227], a[56:59], v[48:63]
    ds_read_b64_tr_b16 a[120:121], v200 offset:1024
    ds_read_b64_tr_b16 a[122:123], v200 offset:1280
    v_mul_f32 v168, v8, v32
    v_mul_f32 v169, v8, v33
    v_mul_f32 v170, v8, v34
    v_mul_f32 v171, v8, v35
    v_mfma_f32_32x32x16_bf16 v[64:79], a[228:231], a[56:59], v[64:79]
    ds_read_b64_tr_b16 a[124:125], v201 offset:1024
    ds_read_b64_tr_b16 a[126:127], v201 offset:1280
    s_add_u32 m0, s57, 50176
    s_add_u32 s71, s3, 193536
    buffer_load_dwordx4 v238, s[28:31], s71 offen lds
    s_waitcnt lgkmcnt(8)
    v_mfma_f32_32x32x16_bf16 v[48:63], a[232:235], a[60:63], v[48:63]
    ds_read_b64_tr_b16 a[128:129], v200 offset:2048
    ds_read_b64_tr_b16 a[130:131], v200 offset:2304
    v_mul_f32 v172, v8, v36
    v_mul_f32 v173, v8, v37
    v_mul_f32 v174, v8, v38
    v_mfma_f32_32x32x16_bf16 v[64:79], a[236:239], a[60:63], v[64:79]
    ds_read_b64_tr_b16 a[132:133], v201 offset:2048
    ds_read_b64_tr_b16 a[134:135], v201 offset:2304
    v_mul_f32_e64 v175, v8, v39
    v_exp_f32 v168, v168
    s_waitcnt lgkmcnt(8)
    v_mfma_f32_32x32x16_bf16 v[48:63], a[112:115], a[64:67], v[48:63]
    ds_read_b64_tr_b16 a[136:137], v200 offset:3072
    ds_read_b64_tr_b16 a[138:139], v200 offset:3328
    s_add_u32 m0, s57, 51200
    s_add_u32 s71, s3, 200704
    buffer_load_dwordx4 v238, s[28:31], s71 offen lds
    v_mfma_f32_32x32x16_bf16 v[64:79], a[116:119], a[64:67], v[64:79]
    ds_read_b64_tr_b16 a[140:141], v201 offset:3072
    ds_read_b64_tr_b16 a[142:143], v201 offset:3328
    v_exp_f32_e64 v169, v169
    v_exp_f32 v170, v170
    s_waitcnt lgkmcnt(8)
    v_mfma_f32_32x32x16_bf16 v[48:63], a[120:123], a[68:71], v[48:63]
    ds_read_b64_tr_b16 a[224:225], v200 offset:4096
    ds_read_b64_tr_b16 a[226:227], v200 offset:4352
    v_exp_f32 v171, v171
    v_exp_f32 v172, v172
    v_mfma_f32_32x32x16_bf16 v[64:79], a[124:127], a[68:71], v[64:79]
    ds_read_b64_tr_b16 a[228:229], v201 offset:4096
    ds_read_b64_tr_b16 a[230:231], v201 offset:4352
    s_add_u32 m0, s57, 52224
    s_add_u32 s71, s3, 207872
    buffer_load_dwordx4 v238, s[28:31], s71 offen lds
    s_waitcnt lgkmcnt(8)
    v_mfma_f32_32x32x16_bf16 v[48:63], a[128:131], a[72:75], v[48:63]
    ds_read_b64_tr_b16 a[232:233], v200 offset:5120
    ds_read_b64_tr_b16 a[234:235], v200 offset:5376
    v_exp_f32 v173, v173
    v_mfma_f32_32x32x16_bf16 v[64:79], a[132:135], a[72:75], v[64:79]
    ds_read_b64_tr_b16 a[236:237], v201 offset:5120
    ds_read_b64_tr_b16 a[238:239], v201 offset:5376
    v_exp_f32 v174, v174
    v_exp_f32 v175, v175
    s_waitcnt lgkmcnt(8)
    v_mfma_f32_32x32x16_bf16 v[48:63], a[136:139], a[76:79], v[48:63]
    ds_read_b64_tr_b16 a[112:113], v200 offset:6144
    ds_read_b64_tr_b16 a[114:115], v200 offset:6400
    v_mul_f32 v32, v32, v40
    v_mul_f32 v33, v33, v41
    v_mul_f32 v34, v34, v42
    v_mfma_f32_32x32x16_bf16 v[64:79], a[140:143], a[76:79], v[64:79]
    ds_read_b64_tr_b16 a[116:117], v201 offset:6144
    ds_read_b64_tr_b16 a[118:119], v201 offset:6400
    v_mul_f32 v35, v35, v43
    v_mul_f32 v36, v36, v44
    v_mul_f32 v37, v37, v45
    v_mul_f32 v38, v38, v46
    s_waitcnt lgkmcnt(8)
    v_mfma_f32_32x32x16_bf16 v[48:63], a[224:227], a[80:83], v[48:63]
    ds_read_b64_tr_b16 a[120:121], v200 offset:7168
    ds_read_b64_tr_b16 a[122:123], v200 offset:7424
    v_mul_f32 v39, v39, v47
    v_add_f32 v168, 1.0, v168
    v_add_f32 v169, 1.0, v169
    v_mfma_f32_32x32x16_bf16 v[64:79], a[228:231], a[80:83], v[64:79]
    ds_read_b64_tr_b16 a[124:125], v201 offset:7168
    ds_read_b64_tr_b16 a[126:127], v201 offset:7424
    v_add_f32 v170, 1.0, v170
    v_add_f32 v171, 1.0, v171
    v_add_f32_e64 v172, 1.0, v172
    v_add_f32 v173, 1.0, v173
    s_waitcnt lgkmcnt(8)
    v_mfma_f32_32x32x16_bf16 v[48:63], a[232:235], a[84:87], v[48:63]
    s_waitcnt vmcnt(9)
    s_barrier
    ds_read_b64_tr_b16 a[128:129], v200 offset:16384
    ds_read_b64_tr_b16 a[130:131], v200 offset:16640
    s_add_u32 m0, s57, 65536
    s_add_u32 s71, s3, 215040
    buffer_load_dwordx4 v238, s[28:31], s71 offen lds
    v_mfma_f32_32x32x16_bf16 v[64:79], a[236:239], a[84:87], v[64:79]
    ds_read_b64_tr_b16 a[132:133], v201 offset:16384
    ds_read_b64_tr_b16 a[134:135], v201 offset:16640
    v_add_f32 v174, 1.0, v174
    v_add_f32 v175, 1.0, v175
    v_rcp_f32 v168, v168
    s_waitcnt lgkmcnt(8)
    v_mfma_f32_32x32x16_bf16 v[48:63], a[112:115], a[88:91], v[48:63]
    ds_read_b64_tr_b16 a[136:137], v200 offset:17408
    ds_read_b64_tr_b16 a[138:139], v200 offset:17664
    v_rcp_f32 v169, v169
    v_mfma_f32_32x32x16_bf16 v[64:79], a[116:119], a[88:91], v[64:79]
    ds_read_b64_tr_b16 a[140:141], v201 offset:17408
    ds_read_b64_tr_b16 a[142:143], v201 offset:17664
    s_add_u32 m0, s57, 66560
    s_add_u32 s71, s3, 222208
    buffer_load_dwordx4 v238, s[28:31], s71 offen lds
    s_waitcnt lgkmcnt(8)
    v_mfma_f32_32x32x16_bf16 v[48:63], a[120:123], a[92:95], v[48:63]
    ds_read_b64_tr_b16 a[224:225], v200 offset:18432
    ds_read_b64_tr_b16 a[226:227], v200 offset:18688
    v_rcp_f32 v170, v170
    v_rcp_f32 v171, v171
    v_mfma_f32_32x32x16_bf16 v[64:79], a[124:127], a[92:95], v[64:79]
    ds_read_b64_tr_b16 a[228:229], v201 offset:18432
    ds_read_b64_tr_b16 a[230:231], v201 offset:18688
    v_rcp_f32_e64 v172, v172
    v_rcp_f32 v173, v173
    s_waitcnt lgkmcnt(8)
    v_mfma_f32_32x32x16_bf16 v[48:63], a[128:131], a[96:99], v[48:63]
    ds_read_b64_tr_b16 a[232:233], v200 offset:19456
    ds_read_b64_tr_b16 a[234:235], v200 offset:19712
    s_add_u32 m0, s57, 67584
    s_add_u32 s71, s3, 229376
    buffer_load_dwordx4 v238, s[28:31], s71 offen lds
    v_mfma_f32_32x32x16_bf16 v[64:79], a[132:135], a[96:99], v[64:79]
    ds_read_b64_tr_b16 a[236:237], v201 offset:19456
    ds_read_b64_tr_b16 a[238:239], v201 offset:19712
    v_rcp_f32 v174, v174
    v_rcp_f32 v175, v175
    s_waitcnt lgkmcnt(8)
    v_mfma_f32_32x32x16_bf16 v[48:63], a[136:139], a[100:103], v[48:63]
    v_mul_f32 v32, v32, v168
    v_mul_f32 v33, v33, v169
    v_mul_f32 v34, v34, v170
    v_mul_f32 v35, v35, v171
    v_mul_f32 v36, v36, v172
    v_mfma_f32_32x32x16_bf16 v[64:79], a[140:143], a[100:103], v[64:79]
    s_add_u32 m0, s57, 68608
    s_add_u32 s71, s3, 236544
    buffer_load_dwordx4 v238, s[28:31], s71 offen lds
    s_waitcnt lgkmcnt(4)
    v_mfma_f32_32x32x16_bf16 v[48:63], a[224:227], a[104:107], v[48:63]
    v_mul_f32 v37, v37, v173
    v_mul_f32_e64 v38, v38, v174
    v_mul_f32 v39, v39, v175
    v_cvt_pk_bf16_f32 v40, v32, v33
    v_cvt_pk_bf16_f32 v41, v34, v35
    v_mfma_f32_32x32x16_bf16 v[64:79], a[228:231], a[104:107], v[64:79]
    v_cvt_pk_bf16_f32 v42, v36, v37
    v_cvt_pk_bf16_f32 v43, v38, v39
    buffer_store_dwordx4 v[40:43], v11, s[40:43], s70 offen offset:1024 sc1
    s_waitcnt lgkmcnt(0)
    v_mfma_f32_32x32x16_bf16 v[48:63], a[232:235], a[108:111], v[48:63]
    v_mfma_f32_32x32x16_bf16 v[64:79], a[236:239], a[108:111], v[64:79]
    s_barrier
    s_nop 9
    v_pk_mul_f32 v[168:169], v[48:49], v[8:9] op_sel:[0,0] op_sel_hi:[1,0]
    v_pk_mul_f32 v[176:177], v[64:65], v[8:9] op_sel:[0,0] op_sel_hi:[1,0]
    v_pk_mul_f32 v[170:171], v[50:51], v[8:9] op_sel:[0,0] op_sel_hi:[1,0]
    v_pk_mul_f32 v[178:179], v[66:67], v[8:9] op_sel:[0,0] op_sel_hi:[1,0]
    v_pk_mul_f32 v[172:173], v[52:53], v[8:9] op_sel:[0,0] op_sel_hi:[1,0]
    v_pk_mul_f32 v[180:181], v[68:69], v[8:9] op_sel:[0,0] op_sel_hi:[1,0]
    v_pk_mul_f32 v[174:175], v[54:55], v[8:9] op_sel:[0,0] op_sel_hi:[1,0]
    v_pk_mul_f32 v[182:183], v[70:71], v[8:9] op_sel:[0,0] op_sel_hi:[1,0]
    v_exp_f32 v168, v168
    v_exp_f32 v176, v176
    v_exp_f32 v169, v169
    v_exp_f32 v177, v177
    v_exp_f32 v170, v170
    v_exp_f32 v178, v178
    v_exp_f32 v171, v171
    v_exp_f32 v179, v179
    v_exp_f32 v172, v172
    v_exp_f32 v180, v180
    v_exp_f32 v173, v173
    v_exp_f32 v181, v181
    v_exp_f32 v174, v174
    v_exp_f32 v182, v182
    v_exp_f32 v175, v175
    v_exp_f32 v183, v183
    v_pk_mul_f32 v[48:49], v[48:49], v[56:57]
    v_pk_mul_f32 v[64:65], v[64:65], v[72:73]
    v_pk_mul_f32 v[50:51], v[50:51], v[58:59]
    v_pk_mul_f32 v[66:67], v[66:67], v[74:75]
    v_pk_mul_f32 v[52:53], v[52:53], v[60:61]
    v_pk_mul_f32 v[68:69], v[68:69], v[76:77]
    v_pk_mul_f32 v[54:55], v[54:55], v[62:63]
    v_pk_mul_f32 v[70:71], v[70:71], v[78:79]
    v_pk_add_f32 v[168:169], v[168:169], 1.0 op_sel_hi:[1,0]
    v_pk_add_f32 v[176:177], v[176:177], 1.0 op_sel_hi:[1,0]
    v_pk_add_f32 v[170:171], v[170:171], 1.0 op_sel_hi:[1,0]
    v_pk_add_f32 v[178:179], v[178:179], 1.0 op_sel_hi:[1,0]
    v_pk_add_f32 v[172:173], v[172:173], 1.0 op_sel_hi:[1,0]
    v_pk_add_f32 v[180:181], v[180:181], 1.0 op_sel_hi:[1,0]
    v_pk_add_f32 v[174:175], v[174:175], 1.0 op_sel_hi:[1,0]
    v_pk_add_f32 v[182:183], v[182:183], 1.0 op_sel_hi:[1,0]
    v_rcp_f32 v168, v168
    v_rcp_f32 v176, v176
    v_rcp_f32 v169, v169
    v_rcp_f32 v177, v177
    v_rcp_f32 v170, v170
    v_rcp_f32 v178, v178
    v_rcp_f32 v171, v171
    v_rcp_f32 v179, v179
    v_rcp_f32 v172, v172
    v_rcp_f32 v180, v180
    v_rcp_f32 v173, v173
    v_rcp_f32 v181, v181
    v_rcp_f32 v174, v174
    v_rcp_f32 v182, v182
    v_rcp_f32 v175, v175
    v_rcp_f32 v183, v183
    v_pk_mul_f32 v[48:49], v[48:49], v[168:169]
    v_pk_mul_f32 v[64:65], v[64:65], v[176:177]
    v_pk_mul_f32 v[50:51], v[50:51], v[170:171]
    v_pk_mul_f32 v[66:67], v[66:67], v[178:179]
    v_pk_mul_f32 v[52:53], v[52:53], v[172:173]
    v_pk_mul_f32 v[68:69], v[68:69], v[180:181]
    v_pk_mul_f32 v[54:55], v[54:55], v[174:175]
    v_pk_mul_f32 v[70:71], v[70:71], v[182:183]
    v_cvt_pk_bf16_f32 v56, v48, v49
    v_cvt_pk_bf16_f32 v72, v64, v65
    v_cvt_pk_bf16_f32 v57, v50, v51
    v_cvt_pk_bf16_f32 v73, v66, v67
    v_cvt_pk_bf16_f32 v58, v52, v53
    v_cvt_pk_bf16_f32 v74, v68, v69
    v_cvt_pk_bf16_f32 v59, v54, v55
    v_cvt_pk_bf16_f32 v75, v70, v71
    buffer_store_dwordx4 v[56:59], v11, s[40:43], s70 offen offset:2048 sc1
    buffer_store_dwordx4 v[72:75], v11, s[40:43], s70 offen offset:3072 sc1
    buffer_load_dword v143, off, s[40:43], s76 sc1
    s_waitcnt vmcnt(4)
    ds_read_b64_tr_b16 a[0:1], v246 offset:0
    ds_read_b64_tr_b16 a[2:3], v246 offset:1024
    ds_read_b64_tr_b16 a[4:5], v247 offset:0
    ds_read_b64_tr_b16 a[6:7], v247 offset:1024
    ds_read_b64_tr_b16 a[8:9], v246 offset:2048
    ds_read_b64_tr_b16 a[10:11], v246 offset:3072
    s_add_u32 m0, s57, 0
    s_add_u32 s71, s3, 243712
    buffer_load_dwordx4 v238, s[28:31], s71 offen lds
    ds_read_b64_tr_b16 a[12:13], v247 offset:2048
    ds_read_b64_tr_b16 a[14:15], v247 offset:3072
    ds_read_b64_tr_b16 a[16:17], v246 offset:4096
    ds_read_b64_tr_b16 a[18:19], v246 offset:5120
    ds_read_b64_tr_b16 a[20:21], v247 offset:4096
    ds_read_b64_tr_b16 a[22:23], v247 offset:5120
    ds_read_b64_tr_b16 a[24:25], v246 offset:6144
    s_add_u32 m0, s57, 1024
    s_add_u32 s71, s3, 250880
    buffer_load_dwordx4 v238, s[28:31], s71 offen lds
    ds_read_b64_tr_b16 a[26:27], v246 offset:7168
    ds_read_b64_tr_b16 a[28:29], v247 offset:6144
    ds_read_b64_tr_b16 a[30:31], v247 offset:7168
    ds_read_b64_tr_b16 a[32:33], v246 offset:8192
    ds_read_b64_tr_b16 a[34:35], v246 offset:9216
    ds_read_b64_tr_b16 a[36:37], v247 offset:8192
    s_add_u32 m0, s57, 2048
    s_add_u32 s71, s3, 258048
    buffer_load_dwordx4 v238, s[28:31], s71 offen lds
    ds_read_b64_tr_b16 a[38:39], v247 offset:9216
    ds_read_b64_tr_b16 a[40:41], v246 offset:10240
    ds_read_b64_tr_b16 a[42:43], v246 offset:11264
    ds_read_b64_tr_b16 a[44:45], v247 offset:10240
    ds_read_b64_tr_b16 a[46:47], v247 offset:11264
    ds_read_b64_tr_b16 a[48:49], v246 offset:12288
    ds_read_b64_tr_b16 a[50:51], v246 offset:13312
    s_add_u32 m0, s57, 3072
    s_add_u32 s71, s3, 265216
    buffer_load_dwordx4 v238, s[28:31], s71 offen lds
    ds_read_b64_tr_b16 a[52:53], v247 offset:12288
    ds_read_b64_tr_b16 a[54:55], v247 offset:13312
    ds_read_b64_tr_b16 a[56:57], v240 offset:32768
    ds_read_b64_tr_b16 a[58:59], v240 offset:33792
    ds_read_b64_tr_b16 a[60:61], v241 offset:32768
    ds_read_b64_tr_b16 a[62:63], v241 offset:33792
    ds_read_b64_tr_b16 a[64:65], v240 offset:34816
    s_add_u32 m0, s57, 16384
    s_add_u32 s71, s3, 272384
    buffer_load_dwordx4 v238, s[28:31], s71 offen lds
    ds_read_b64_tr_b16 a[66:67], v240 offset:35840
    ds_read_b64_tr_b16 a[68:69], v241 offset:34816
    ds_read_b64_tr_b16 a[70:71], v241 offset:35840
    ds_read_b64_tr_b16 a[72:73], v240 offset:49152
    ds_read_b64_tr_b16 a[74:75], v240 offset:50176
    ds_read_b64_tr_b16 a[76:77], v241 offset:49152
    s_add_u32 m0, s57, 17408
    s_add_u32 s71, s3, 279552
    buffer_load_dwordx4 v238, s[28:31], s71 offen lds
    ds_read_b64_tr_b16 a[78:79], v241 offset:50176
    ds_read_b64_tr_b16 a[80:81], v240 offset:51200
    ds_read_b64_tr_b16 a[82:83], v240 offset:52224
    ds_read_b64_tr_b16 a[84:85], v241 offset:51200
    ds_read_b64_tr_b16 a[86:87], v241 offset:52224
    ds_read_b64_tr_b16 a[88:89], v244 offset:49152
    ds_read_b64_tr_b16 a[90:91], v244 offset:50176
    s_add_u32 m0, s57, 18432
    s_add_u32 s71, s3, 114688
    buffer_load_dwordx4 v238, s[28:31], s71 offen lds
    ds_read_b64_tr_b16 a[92:93], v245 offset:49152
    ds_read_b64_tr_b16 a[94:95], v245 offset:50176
    ds_read_b64_tr_b16 a[96:97], v244 offset:51200
    ds_read_b64_tr_b16 a[98:99], v244 offset:52224
    ds_read_b64_tr_b16 a[100:101], v245 offset:51200
    ds_read_b64_tr_b16 a[102:103], v245 offset:52224
    s_add_u32 m0, s57, 19456
    s_add_u32 s71, s3, 121856
    buffer_load_dwordx4 v238, s[28:31], s71 offen lds
    s_waitcnt vmcnt(9)
    s_waitcnt lgkmcnt(0)
    s_barrier
    s_cmp_lg_u32 s44, 0
    s_cbranch_scc1 L_nw0_41
    v_mov_b32 v253, 1
    s_mov_b64 exec, 1
    buffer_atomic_add v253, off, s[40:43], s75 sc1
    s_mov_b64 exec, -1
L_nw0_41:
    v_add_u32 v7, 16384, v240
    v_add_u32 v8, 16384, v241
    s_waitcnt vmcnt(8)
    v_readfirstlane_b32 s52, v143
    s_nop 1
    s_cmp_eq_u32 s52, 8
    s_cbranch_scc1 L_cok_42
    s_mov_b32 s91, 131072
L_cspin_43:
    buffer_load_dword v143, off, s[40:43], s76 sc1
    s_waitcnt vmcnt(0)
    v_readfirstlane_b32 s52, v143
    s_nop 1
    s_cmp_eq_u32 s52, 8
    s_cbranch_scc1 L_cok_42
    s_sub_u32 s91, s91, 1
    s_cmp_eq_u32 s91, 0
    s_cbranch_scc1 L_cok_42
    s_branch L_cspin_43
L_cok_42:
L_phase2:
    s_waitcnt lgkmcnt(0)
    v_xor_b32 v2, 64, v242
    s_mul_i32 s82, s44, 22528
    s_add_u32 s82, s82, 58368
    s_sub_u32 s50, s82, s57
    v_add_u32 v5, s50, v240
    v_add_u32 v6, s50, v241
    s_xor_b32 s50, s44, 1
    s_lshl_b32 s50, s50, 12
    s_add_u32 s50, s50, 107520
    v_add_u32 v3, s50, v11
    s_add_u32 s50, s57, 107520
    v_add_u32_e64 v4, s50, v11
    s_add_u32 s71, s89, 0
    buffer_load_dwordx4 v[96:99], v11, s[40:43], s71 offen sc1
    s_add_u32 s71, s90, 0
    buffer_load_dwordx4 v[100:103], v11, s[40:43], s71 offen sc1
    s_add_u32 s71, s89, 1024
    buffer_load_dwordx4 v[104:107], v11, s[40:43], s71 offen sc1
    s_add_u32 s71, s90, 1024
    buffer_load_dwordx4 v[108:111], v11, s[40:43], s71 offen sc1
    s_add_u32 s71, s89, 2048
    buffer_load_dwordx4 v[112:115], v11, s[40:43], s71 offen sc1
    s_add_u32 s71, s90, 2048
    buffer_load_dwordx4 v[116:119], v11, s[40:43], s71 offen sc1
    s_add_u32 s71, s89, 3072
    buffer_load_dwordx4 v[120:123], v11, s[40:43], s71 offen sc1
    s_add_u32 s71, s90, 3072
    buffer_load_dwordx4 v[124:127], v11, s[40:43], s71 offen sc1
    s_add_u32 s71, s89, 4096
    buffer_load_dwordx4 v[128:131], v11, s[40:43], s71 offen sc1
    s_add_u32 s71, s90, 4096
    buffer_load_dwordx4 v[132:135], v11, s[40:43], s71 offen sc1
    s_add_u32 s71, s89, 5120
    buffer_load_dwordx4 v[136:139], v11, s[40:43], s71 offen sc1
    s_add_u32 s71, s90, 5120
    buffer_load_dwordx4 v[140:143], v11, s[40:43], s71 offen sc1
    s_add_u32 s71, s89, 6144
    buffer_load_dwordx4 v[144:147], v11, s[40:43], s71 offen sc1
    s_add_u32 s71, s90, 6144
    buffer_load_dwordx4 v[148:151], v11, s[40:43], s71 offen sc1
    s_add_u32 s71, s89, 7168
    buffer_load_dwordx4 v[152:155], v11, s[40:43], s71 offen sc1
    s_add_u32 s71, s90, 7168
    buffer_load_dwordx4 v[156:159], v11, s[40:43], s71 offen sc1
    s_add_u32 s71, s89, 12288
    buffer_load_dwordx4 v[160:163], v11, s[40:43], s71 offen sc1
    s_add_u32 s71, s90, 12288
    buffer_load_dwordx4 v[164:167], v11, s[40:43], s71 offen sc1
    s_add_u32 s71, s89, 13312
    buffer_load_dwordx4 v[168:171], v11, s[40:43], s71 offen sc1
    s_add_u32 s71, s90, 13312
    buffer_load_dwordx4 v[172:175], v11, s[40:43], s71 offen sc1
    s_add_u32 s71, s89, 14336
    buffer_load_dwordx4 v[176:179], v11, s[40:43], s71 offen sc1
    s_add_u32 s71, s90, 14336
    buffer_load_dwordx4 v[180:183], v11, s[40:43], s71 offen sc1
    s_add_u32 s71, s89, 15360
    buffer_load_dwordx4 v[184:187], v11, s[40:43], s71 offen sc1
    s_waitcnt vmcnt(22)
    v_mfma_f32_32x32x16_bf16 v[16:31], a[0:3], v[96:99], 0
    v_mfma_f32_32x32x16_bf16 v[32:47], a[4:7], v[96:99], 0
    ds_read_b64_tr_b16 a[104:105], v240 offset:0
    ds_read_b64_tr_b16 a[106:107], v240 offset:1024
    ds_read_b64_tr_b16 a[108:109], v241 offset:0
    ds_read_b64_tr_b16 a[110:111], v241 offset:1024
    ds_read_b64_tr_b16 a[112:113], v240 offset:2048
    ds_read_b64_tr_b16 a[114:115], v240 offset:3072
    ds_read_b64_tr_b16 a[116:117], v241 offset:2048
    ds_read_b64_tr_b16 a[118:119], v241 offset:3072
    ds_read_b64_tr_b16 a[120:121], v7 offset:0
    ds_read_b64_tr_b16 a[122:123], v7 offset:1024
    ds_read_b64_tr_b16 a[124:125], v8 offset:0
    ds_read_b64_tr_b16 a[126:127], v8 offset:1024
    ds_read_b64_tr_b16 a[128:129], v7 offset:2048
    ds_read_b64_tr_b16 a[130:131], v7 offset:3072
    ds_read_b64_tr_b16 a[132:133], v8 offset:2048
    ds_read_b64_tr_b16 a[134:135], v8 offset:3072
    s_add_u32 s71, s90, 15360
    buffer_load_dwordx4 v[188:191], v11, s[40:43], s71 offen sc1
    s_waitcnt vmcnt(22)
    v_mfma_f32_32x32x16_bf16 v[48:63], a[0:3], v[100:103], 0
    v_mfma_f32_32x32x16_bf16 v[64:79], a[4:7], v[100:103], 0
    s_waitcnt lgkmcnt(0)
    s_barrier
    s_cmp_ge_u32 s46, 4
    s_cbranch_scc1 L_notA_48
    s_cmp_lg_u32 s44, 0
    s_cbranch_scc1 L_nw0_49
    v_mov_b32 v253, 1
    s_mov_b64 exec, 1
    buffer_atomic_add v253, off, s[40:43], s88 sc1
    s_mov_b64 exec, -1
L_nw0_49:
L_notA_48:
    s_add_u32 s71, s89, 16384
    buffer_load_dwordx4 v[192:195], v11, s[40:43], s71 offen sc1
    s_waitcnt vmcnt(22)
    v_mfma_f32_32x32x16_bf16 v[16:31], a[8:11], v[104:107], v[16:31]
    v_mfma_f32_32x32x16_bf16 v[32:47], a[12:15], v[104:107], v[32:47]
    s_add_u32 s71, s90, 16384
    buffer_load_dwordx4 v[196:199], v11, s[40:43], s71 offen sc1
    s_waitcnt vmcnt(22)
    v_mfma_f32_32x32x16_bf16 v[48:63], a[8:11], v[108:111], v[48:63]
    v_mfma_f32_32x32x16_bf16 v[64:79], a[12:15], v[108:111], v[64:79]
    s_add_u32 s71, s89, 17408
    buffer_load_dwordx4 v[200:203], v11, s[40:43], s71 offen sc1
    s_waitcnt vmcnt(22)
    v_mfma_f32_32x32x16_bf16 v[16:31], a[16:19], v[112:115], v[16:31]
    v_mfma_f32_32x32x16_bf16 v[32:47], a[20:23], v[112:115], v[32:47]
    s_add_u32 s71, s90, 17408
    buffer_load_dwordx4 v[204:207], v11, s[40:43], s71 offen sc1
    s_waitcnt vmcnt(22)
    v_mfma_f32_32x32x16_bf16 v[48:63], a[16:19], v[116:119], v[48:63]
    v_mfma_f32_32x32x16_bf16 v[64:79], a[20:23], v[116:119], v[64:79]
    s_add_u32 s71, s89, 18432
    buffer_load_dwordx4 v[208:211], v11, s[40:43], s71 offen sc1
    s_waitcnt vmcnt(22)
    v_mfma_f32_32x32x16_bf16 v[16:31], a[24:27], v[120:123], v[16:31]
    v_mfma_f32_32x32x16_bf16 v[32:47], a[28:31], v[120:123], v[32:47]
    s_add_u32 s71, s90, 18432
    buffer_load_dwordx4 v[212:215], v11, s[40:43], s71 offen sc1
    s_waitcnt vmcnt(22)
    v_mfma_f32_32x32x16_bf16 v[48:63], a[24:27], v[124:127], v[48:63]
    v_mfma_f32_32x32x16_bf16 v[64:79], a[28:31], v[124:127], v[64:79]
    s_add_u32 s71, s89, 19456
    buffer_load_dwordx4 v[216:219], v11, s[40:43], s71 offen sc1
    s_waitcnt vmcnt(22)
    v_mfma_f32_32x32x16_bf16 v[16:31], a[32:35], v[128:131], v[16:31]
    v_mfma_f32_32x32x16_bf16 v[32:47], a[36:39], v[128:131], v[32:47]
    s_add_u32 s71, s90, 19456
    buffer_load_dwordx4 v[220:223], v11, s[40:43], s71 offen sc1
    s_waitcnt vmcnt(22)
    v_mfma_f32_32x32x16_bf16 v[48:63], a[32:35], v[132:135], v[48:63]
    v_mfma_f32_32x32x16_bf16 v[64:79], a[36:39], v[132:135], v[64:79]
    s_add_u32 m0, s82, 0
    s_add_u32 s71, s3, 129024
    buffer_load_dwordx4 v238, s[28:31], s71 offen lds
    s_waitcnt vmcnt(22)
    v_mfma_f32_32x32x16_bf16 v[16:31], a[40:43], v[136:139], v[16:31]
    v_mfma_f32_32x32x16_bf16 v[32:47], a[44:47], v[136:139], v[32:47]
    s_add_u32 m0, s82, 1024
    s_add_u32 s71, s3, 136192
    buffer_load_dwordx4 v238, s[28:31], s71 offen lds
    s_waitcnt vmcnt(22)
    v_mfma_f32_32x32x16_bf16 v[48:63], a[40:43], v[140:143], v[48:63]
    v_mfma_f32_32x32x16_bf16 v[64:79], a[44:47], v[140:143], v[64:79]
    s_add_u32 m0, s82, 2048
    s_add_u32 s71, s3, 143360
    buffer_load_dwordx4 v238, s[28:31], s71 offen lds
    buffer_load_dword v13, off, s[40:43], s75 sc1
    s_waitcnt vmcnt(23)
    v_mfma_f32_32x32x16_bf16 v[16:31], a[48:51], v[144:147], v[16:31]
    v_mfma_f32_32x32x16_bf16 v[32:47], a[52:55], v[144:147], v[32:47]
    s_add_u32 m0, s82, 3072
    s_add_u32 s71, s3, 150528
    buffer_load_dwordx4 v238, s[28:31], s71 offen lds
    s_waitcnt vmcnt(23)
    v_mfma_f32_32x32x16_bf16 v[48:63], a[48:51], v[148:151], v[48:63]
    v_mfma_f32_32x32x16_bf16 v[64:79], a[52:55], v[148:151], v[64:79]
    s_add_u32 m0, s82, 4096
    s_add_u32 s71, s3, 157696
    buffer_load_dwordx4 v238, s[28:31], s71 offen lds
    s_waitcnt vmcnt(23)
    v_mfma_f32_32x32x16_bf16 v[16:31], a[56:59], v[152:155], v[16:31]
    v_mfma_f32_32x32x16_bf16 v[32:47], a[60:63], v[152:155], v[32:47]
    s_add_u32 m0, s82, 5120
    s_add_u32 s71, s3, 164864
    buffer_load_dwordx4 v238, s[28:31], s71 offen lds
    s_waitcnt vmcnt(23)
    v_mfma_f32_32x32x16_bf16 v[48:63], a[56:59], v[156:159], v[48:63]
    v_mfma_f32_32x32x16_bf16 v[64:79], a[60:63], v[156:159], v[64:79]
    s_add_u32 m0, s82, 6144
    s_add_u32 s71, s3, 286720
    buffer_load_dwordx4 v238, s[28:31], s71 offen lds
    s_waitcnt vmcnt(23)
    v_mfma_f32_32x32x16_bf16 v[16:31], a[64:67], v[160:163], v[16:31]
    v_mfma_f32_32x32x16_bf16 v[32:47], a[68:71], v[160:163], v[32:47]
    s_add_u32 m0, s82, 7168
    s_add_u32 s71, s3, 293888
    buffer_load_dwordx4 v238, s[28:31], s71 offen lds
    s_waitcnt vmcnt(23)
    v_mfma_f32_32x32x16_bf16 v[48:63], a[64:67], v[164:167], v[48:63]
    v_mfma_f32_32x32x16_bf16 v[64:79], a[68:71], v[164:167], v[64:79]
    s_add_u32 m0, s82, 8192
    s_add_u32 s71, s3, 301056
    buffer_load_dwordx4 v238, s[28:31], s71 offen lds
    s_waitcnt vmcnt(23)
    v_mfma_f32_32x32x16_bf16 v[16:31], a[72:75], v[168:171], v[16:31]
    v_mfma_f32_32x32x16_bf16 v[32:47], a[76:79], v[168:171], v[32:47]
    s_add_u32 m0, s82, 9216
    s_add_u32 s71, s3, 308224
    buffer_load_dwordx4 v238, s[28:31], s71 offen lds
    s_waitcnt vmcnt(23)
    v_mfma_f32_32x32x16_bf16 v[48:63], a[72:75], v[172:175], v[48:63]
    v_mfma_f32_32x32x16_bf16 v[64:79], a[76:79], v[172:175], v[64:79]
    s_add_u32 m0, s82, 10240
    s_add_u32 s71, s3, 315392
    buffer_load_dwordx4 v238, s[28:31], s71 offen lds
    s_waitcnt vmcnt(23)
    v_mfma_f32_32x32x16_bf16 v[16:31], a[80:83], v[176:179], v[16:31]
    v_mfma_f32_32x32x16_bf16 v[32:47], a[84:87], v[176:179], v[32:47]
    s_add_u32 m0, s82, 11264
    s_add_u32 s71, s3, 322560
    buffer_load_dwordx4 v238, s[28:31], s71 offen lds
    s_waitcnt vmcnt(23)
    v_mfma_f32_32x32x16_bf16 v[48:63], a[80:83], v[180:183], v[48:63]
    v_mfma_f32_32x32x16_bf16 v[64:79], a[84:87], v[180:183], v[64:79]
    s_add_u32 m0, s82, 12288
    s_add_u32 s71, s3, 329728
    buffer_load_dwordx4 v238, s[28:31], s71 offen lds
    s_waitcnt vmcnt(23)
    v_mfma_f32_32x32x16_bf16 v[16:31], a[88:91], v[184:187], v[16:31]
    v_mfma_f32_32x32x16_bf16 v[32:47], a[92:95], v[184:187], v[32:47]
    s_add_u32 m0, s82, 13312
    s_add_u32 s71, s3, 336896
    buffer_load_dwordx4 v238, s[28:31], s71 offen lds
    s_waitcnt vmcnt(23)
    v_mfma_f32_32x32x16_bf16 v[48:63], a[88:91], v[188:191], v[48:63]
    v_mfma_f32_32x32x16_bf16 v[64:79], a[92:95], v[188:191], v[64:79]
    s_add_u32 m0, s82, 14336
    s_add_u32 s71, s49, 1376256
    buffer_load_dwordx4 v238, s[28:31], s71 offen lds
    s_waitcnt vmcnt(23)
    v_mfma_f32_32x32x16_bf16 v[16:31], a[96:99], v[192:195], v[16:31]
    v_mfma_f32_32x32x16_bf16 v[32:47], a[100:103], v[192:195], v[32:47]
    s_add_u32 m0, s82, 15360
    s_add_u32 s71, s49, 1383424
    buffer_load_dwordx4 v238, s[28:31], s71 offen lds
    s_waitcnt vmcnt(23)
    v_mfma_f32_32x32x16_bf16 v[48:63], a[96:99], v[196:199], v[48:63]
    v_mfma_f32_32x32x16_bf16 v[64:79], a[100:103], v[196:199], v[64:79]
    s_add_u32 m0, s82, 16384
    s_add_u32 s71, s49, 1390592
    buffer_load_dwordx4 v238, s[28:31], s71 offen lds
    s_waitcnt vmcnt(23)
    v_mfma_f32_32x32x16_bf16 v[16:31], a[104:107], v[200:203], v[16:31]
    v_mfma_f32_32x32x16_bf16 v[32:47], a[108:111], v[200:203], v[32:47]
    s_add_u32 m0, s82, 17408
    s_add_u32 s71, s49, 1397760
    buffer_load_dwordx4 v238, s[28:31], s71 offen lds
    s_waitcnt vmcnt(23)
    v_mfma_f32_32x32x16_bf16 v[48:63], a[104:107], v[204:207], v[48:63]
    v_mfma_f32_32x32x16_bf16 v[64:79], a[108:111], v[204:207], v[64:79]
    s_add_u32 m0, s82, 18432
    s_add_u32 s71, s49, 1404928
    buffer_load_dwordx4 v238, s[28:31], s71 offen lds
    s_waitcnt vmcnt(23)
    v_mfma_f32_32x32x16_bf16 v[16:31], a[112:115], v[208:211], v[16:31]
    v_mfma_f32_32x32x16_bf16 v[32:47], a[116:119], v[208:211], v[32:47]
    s_add_u32 m0, s82, 19456
    s_add_u32 s71, s49, 1412096
    buffer_load_dwordx4 v238, s[28:31], s71 offen lds
    s_waitcnt vmcnt(23)
    v_mfma_f32_32x32x16_bf16 v[48:63], a[112:115], v[212:215], v[48:63]
    v_mfma_f32_32x32x16_bf16 v[64:79], a[116:119], v[212:215], v[64:79]
    s_add_u32 m0, s82, 20480
    s_add_u32 s71, s49, 1419264
    buffer_load_dwordx4 v238, s[28:31], s71 offen lds
    s_waitcnt vmcnt(23)
    v_mfma_f32_32x32x16_bf16 v[16:31], a[120:123], v[216:219], v[16:31]
    v_mfma_f32_32x32x16_bf16 v[32:47], a[124:127], v[216:219], v[32:47]
    s_add_u32 m0, s82, 21504
    s_add_u32 s71, s49, 1426432
    buffer_load_dwordx4 v238, s[28:31], s71 offen lds
    s_waitcnt vmcnt(23)
    v_mfma_f32_32x32x16_bf16 v[48:63], a[120:123], v[220:223], v[48:63]
    v_mfma_f32_32x32x16_bf16 v[64:79], a[124:127], v[220:223], v[64:79]
    s_waitcnt vmcnt(19)
    v_readfirstlane_b32 s52, v13
    s_nop 1
    s_cmp_eq_u32 s52, 16
    s_cbranch_scc1 L_cok_44
    s_mov_b32 s91, 131072
L_cspin_45:
    buffer_load_dword v13, off, s[40:43], s75 sc1
    s_waitcnt vmcnt(0)
    v_readfirstlane_b32 s52, v13
    s_nop 1
    s_cmp_eq_u32 s52, 16
    s_cbranch_scc1 L_cok_44
    s_sub_u32 s91, s91, 1
    s_cmp_eq_u32 s91, 0
    s_cbranch_scc1 L_cok_44
    s_branch L_cspin_45
L_cok_44:
    s_add_u32 s71, s89, 8192
    buffer_load_dwordx4 v[96:99], v11, s[40:43], s71 offen sc1
    s_add_u32 s71, s90, 8192
    buffer_load_dwordx4 v[100:103], v11, s[40:43], s71 offen sc1
    s_add_u32 s71, s89, 9216
    buffer_load_dwordx4 v[104:107], v11, s[40:43], s71 offen sc1
    s_add_u32 s71, s90, 9216
    buffer_load_dwordx4 v[108:111], v11, s[40:43], s71 offen sc1
    s_add_u32 s71, s89, 10240
    buffer_load_dwordx4 v[112:115], v11, s[40:43], s71 offen sc1
    buffer_load_dword v14, off, s[40:43], s88 sc1
    s_add_u32 s71, s90, 10240
    buffer_load_dwordx4 v[116:119], v11, s[40:43], s71 offen sc1
    s_add_u32 s71, s89, 11264
    buffer_load_dwordx4 v[120:123], v11, s[40:43], s71 offen sc1
    s_add_u32 s71, s90, 11264
    buffer_load_dwordx4 v[124:127], v11, s[40:43], s71 offen sc1
    s_add_u32 s71, s89, 20480
    buffer_load_dwordx4 v[128:131], v11, s[40:43], s71 offen sc1
    s_add_u32 s71, s90, 20480
    buffer_load_dwordx4 v[132:135], v11, s[40:43], s71 offen sc1
    s_add_u32 s71, s89, 21504
    buffer_load_dwordx4 v[136:139], v11, s[40:43], s71 offen sc1
    s_add_u32 s71, s90, 21504
    buffer_load_dwordx4 v[140:143], v11, s[40:43], s71 offen sc1
    s_add_u32 s71, s89, 22528
    buffer_load_dwordx4 v[144:147], v11, s[40:43], s71 offen sc1
    s_add_u32 s71, s90, 22528
    buffer_load_dwordx4 v[148:151], v11, s[40:43], s71 offen sc1
    s_add_u32 s71, s89, 23552
    buffer_load_dwordx4 v[152:155], v11, s[40:43], s71 offen sc1
    s_add_u32 s71, s90, 23552
    buffer_load_dwordx4 v[156:159], v11, s[40:43], s71 offen sc1
    s_add_u32 s71, s84, 98304
    buffer_load_dwordx4 v[160:163], v11, s[40:43], s71 offen sc1
    s_add_u32 s71, s85, 98304
    buffer_load_dwordx4 v[164:167], v11, s[40:43], s71 offen sc1
    s_add_u32 s71, s84, 99328
    buffer_load_dwordx4 v[168:171], v11, s[40:43], s71 offen sc1
    s_add_u32 s71, s85, 99328
    buffer_load_dwordx4 v[172:175], v11, s[40:43], s71 offen sc1
    s_add_u32 s71, s84, 100352
    buffer_load_dwordx4 v[176:179], v11, s[40:43], s71 offen sc1
    s_add_u32 s71, s85, 100352
    buffer_load_dwordx4 v[180:183], v11, s[40:43], s71 offen sc1
    s_add_u32 s71, s84, 101376
    buffer_load_dwordx4 v[184:187], v11, s[40:43], s71 offen sc1
    s_waitcnt vmcnt(24)
    ds_read_b64_tr_b16 a[136:137], v5 offset:0
    ds_read_b64_tr_b16 a[138:139], v5 offset:1024
    ds_read_b64_tr_b16 a[140:141], v6 offset:0
    ds_read_b64_tr_b16 a[142:143], v6 offset:1024
    ds_read_b64_tr_b16 a[144:145], v5 offset:2048
    ds_read_b64_tr_b16 a[146:147], v5 offset:3072
    ds_read_b64_tr_b16 a[148:149], v6 offset:2048
    ds_read_b64_tr_b16 a[150:151], v6 offset:3072
    ds_read_b64_tr_b16 a[152:153], v5 offset:4096
    ds_read_b64_tr_b16 a[154:155], v5 offset:5120
    ds_read_b64_tr_b16 a[156:157], v6 offset:4096
    ds_read_b64_tr_b16 a[158:159], v6 offset:5120
    ds_read_b64_tr_b16 a[160:161], v5 offset:6144
    ds_read_b64_tr_b16 a[162:163], v5 offset:7168
    ds_read_b64_tr_b16 a[164:165], v6 offset:6144
    ds_read_b64_tr_b16 a[166:167], v6 offset:7168
    ds_read_b64_tr_b16 a[168:169], v5 offset:8192
    ds_read_b64_tr_b16 a[170:171], v5 offset:9216
    ds_read_b64_tr_b16 a[172:173], v6 offset:8192
    ds_read_b64_tr_b16 a[174:175], v6 offset:9216
    ds_read_b64_tr_b16 a[176:177], v5 offset:10240
    ds_read_b64_tr_b16 a[178:179], v5 offset:11264
    ds_read_b64_tr_b16 a[180:181], v6 offset:10240
    ds_read_b64_tr_b16 a[182:183], v6 offset:11264
    ds_read_b64_tr_b16 a[184:185], v5 offset:12288
    ds_read_b64_tr_b16 a[186:187], v5 offset:13312
    ds_read_b64_tr_b16 a[188:189], v6 offset:12288
    ds_read_b64_tr_b16 a[190:191], v6 offset:13312
    ds_read_b64_tr_b16 a[192:193], v5 offset:14336
    ds_read_b64_tr_b16 a[194:195], v5 offset:15360
    ds_read_b64_tr_b16 a[196:197], v6 offset:14336
    ds_read_b64_tr_b16 a[198:199], v6 offset:15360
    ds_read_b64_tr_b16 a[200:201], v5 offset:16384
    ds_read_b64_tr_b16 a[202:203], v5 offset:17408
    ds_read_b64_tr_b16 a[204:205], v6 offset:16384
    ds_read_b64_tr_b16 a[206:207], v6 offset:17408
    ds_read_b64_tr_b16 a[208:209], v5 offset:18432
    ds_read_b64_tr_b16 a[210:211], v5 offset:19456
    ds_read_b64_tr_b16 a[212:213], v6 offset:18432
    ds_read_b64_tr_b16 a[214:215], v6 offset:19456
    ds_read_b64_tr_b16 a[216:217], v5 offset:20480
    ds_read_b64_tr_b16 a[218:219], v5 offset:21504
    ds_read_b64_tr_b16 a[220:221], v6 offset:20480
    ds_read_b64_tr_b16 a[222:223], v6 offset:21504
    s_waitcnt vmcnt(23)
    v_mfma_f32_32x32x16_bf16 v[16:31], a[128:131], v[96:99], v[16:31]
    v_mfma_f32_32x32x16_bf16 v[32:47], a[132:135], v[96:99], v[32:47]
    s_add_u32 s71, s85, 101376
    buffer_load_dwordx4 v[188:191], v11, s[40:43], s71 offen sc1
    s_waitcnt vmcnt(23)
    v_mfma_f32_32x32x16_bf16 v[48:63], a[128:131], v[100:103], v[48:63]
    v_mfma_f32_32x32x16_bf16 v[64:79], a[132:135], v[100:103], v[64:79]
    s_add_u32 m0, s58, 0
    s_mov_b32 s71, s59
    buffer_load_dwordx4 v238, s[16:19], s71 offen lds
    s_waitcnt vmcnt(23) lgkmcnt(15)
    v_mfma_f32_32x32x16_bf16 v[16:31], a[136:139], v[104:107], v[16:31]
    v_mfma_f32_32x32x16_bf16 v[32:47], a[140:143], v[104:107], v[32:47]
    s_add_u32 m0, s58, 4096
    s_add_u32 s71, s59, 28672
    buffer_load_dwordx4 v238, s[16:19], s71 offen lds
    s_waitcnt vmcnt(23)
    v_mfma_f32_32x32x16_bf16 v[48:63], a[136:139], v[108:111], v[48:63]
    v_mfma_f32_32x32x16_bf16 v[64:79], a[140:143], v[108:111], v[64:79]
    s_add_u32 m0, s58, 8192
    s_add_u32 s71, s59, 57344
    buffer_load_dwordx4 v238, s[16:19], s71 offen lds
    s_waitcnt vmcnt(23)
    v_mfma_f32_32x32x16_bf16 v[16:31], a[144:147], v[112:115], v[16:31]
    v_mfma_f32_32x32x16_bf16 v[32:47], a[148:151], v[112:115], v[32:47]
    s_add_u32 m0, s58, 12288
    s_add_u32 s71, s59, 86016
    buffer_load_dwordx4 v238, s[16:19], s71 offen lds
    s_waitcnt vmcnt(22)
    v_mfma_f32_32x32x16_bf16 v[48:63], a[144:147], v[116:119], v[48:63]
    v_mfma_f32_32x32x16_bf16 v[64:79], a[148:151], v[116:119], v[64:79]
    s_add_u32 m0, s58, 16384
    s_add_u32 s71, s59, 114688
    buffer_load_dwordx4 v238, s[16:19], s71 offen lds
    s_waitcnt vmcnt(22)
    v_mfma_f32_32x32x16_bf16 v[16:31], a[152:155], v[120:123], v[16:31]
    v_mfma_f32_32x32x16_bf16 v[32:47], a[156:159], v[120:123], v[32:47]
    s_add_u32 m0, s58, 20480
    s_add_u32 s71, s59, 143360
    buffer_load_dwordx4 v238, s[16:19], s71 offen lds
    s_waitcnt vmcnt(22)
    v_mfma_f32_32x32x16_bf16 v[48:63], a[152:155], v[124:127], v[48:63]
    v_mfma_f32_32x32x16_bf16 v[64:79], a[156:159], v[124:127], v[64:79]
    s_add_u32 m0, s58, 24576
    s_add_u32 s71, s59, 172032
    buffer_load_dwordx4 v238, s[16:19], s71 offen lds
    s_waitcnt vmcnt(22)
    v_mfma_f32_32x32x16_bf16 v[16:31], a[160:163], v[128:131], v[16:31]
    v_mfma_f32_32x32x16_bf16 v[32:47], a[164:167], v[128:131], v[32:47]
    s_waitcnt lgkmcnt(0)
    s_barrier
    s_add_u32 m0, s58, 28672
    s_add_u32 s71, s59, 200704
    buffer_load_dwordx4 v238, s[16:19], s71 offen lds
    s_waitcnt vmcnt(22)
    v_mfma_f32_32x32x16_bf16 v[48:63], a[160:163], v[132:135], v[48:63]
    v_mfma_f32_32x32x16_bf16 v[64:79], a[164:167], v[132:135], v[64:79]
    s_add_u32 m0, s58, 32768
    s_add_u32 s71, s59, 229376
    buffer_load_dwordx4 v238, s[16:19], s71 offen lds
    s_waitcnt vmcnt(22)
    v_mfma_f32_32x32x16_bf16 v[16:31], a[168:171], v[136:139], v[16:31]
    v_mfma_f32_32x32x16_bf16 v[32:47], a[172:175], v[136:139], v[32:47]
    s_add_u32 m0, s58, 36864
    s_add_u32 s71, s59, 258048
    buffer_load_dwordx4 v238, s[16:19], s71 offen lds
    s_waitcnt vmcnt(22)
    v_mfma_f32_32x32x16_bf16 v[48:63], a[168:171], v[140:143], v[48:63]
    v_mfma_f32_32x32x16_bf16 v[64:79], a[172:175], v[140:143], v[64:79]
    s_add_u32 m0, s58, 40960
    s_add_u32 s71, s59, 286720
    buffer_load_dwordx4 v238, s[16:19], s71 offen lds
    s_waitcnt vmcnt(22)
    v_mfma_f32_32x32x16_bf16 v[16:31], a[176:179], v[144:147], v[16:31]
    v_mfma_f32_32x32x16_bf16 v[32:47], a[180:183], v[144:147], v[32:47]
    s_add_u32 m0, s58, 45056
    s_add_u32 s71, s59, 315392
    buffer_load_dwordx4 v238, s[16:19], s71 offen lds
    s_waitcnt vmcnt(22)
    v_mfma_f32_32x32x16_bf16 v[48:63], a[176:179], v[148:151], v[48:63]
    v_mfma_f32_32x32x16_bf16 v[64:79], a[180:183], v[148:151], v[64:79]
    s_add_u32 m0, s58, 49152
    s_add_u32 s71, s59, 344064
    buffer_load_dwordx4 v238, s[16:19], s71 offen lds
    s_waitcnt vmcnt(22)
    v_mfma_f32_32x32x16_bf16 v[16:31], a[184:187], v[152:155], v[16:31]
    v_mfma_f32_32x32x16_bf16 v[32:47], a[188:191], v[152:155], v[32:47]
    s_add_u32 m0, s58, 53248
    s_add_u32 s71, s59, 372736
    buffer_load_dwordx4 v238, s[16:19], s71 offen lds
    s_waitcnt vmcnt(22)
    v_mfma_f32_32x32x16_bf16 v[48:63], a[184:187], v[156:159], v[48:63]
    v_mfma_f32_32x32x16_bf16 v[64:79], a[188:191], v[156:159], v[64:79]
    s_add_u32 s50, s92, 401408
    s_mov_b32 m0, 57344
    s_mov_b32 s71, s50
    buffer_load_dwordx4 v238, s[16:19], s71 offen lds
    s_waitcnt vmcnt(22)
    v_mfma_f32_32x32x16_bf16 v[16:31], a[192:195], v[160:163], v[16:31]
    v_mfma_f32_32x32x16_bf16 v[32:47], a[196:199], v[160:163], v[32:47]
    v_readfirstlane_b32 s52, v14
    s_nop 1
    s_cmp_eq_u32 s52, 8
    s_cbranch_scc1 L_cok_46
    s_mov_b32 s91, 131072
L_cspin_47:
    buffer_load_dword v14, off, s[40:43], s88 sc1
    s_waitcnt vmcnt(0)
    v_readfirstlane_b32 s52, v14
    s_nop 1
    s_cmp_eq_u32 s52, 8
    s_cbranch_scc1 L_cok_46
    s_sub_u32 s91, s91, 1
    s_cmp_eq_u32 s91, 0
    s_cbranch_scc1 L_cok_46
    s_branch L_cspin_47
L_cok_46:
    buffer_load_dwordx4 v[192:195], v11, s[40:43], s83 offen offset:0 sc1
    s_waitcnt vmcnt(22)
    v_mfma_f32_32x32x16_bf16 v[48:63], a[192:195], v[164:167], v[48:63]
    v_mfma_f32_32x32x16_bf16 v[64:79], a[196:199], v[164:167], v[64:79]
    buffer_load_dwordx4 v[196:199], v11, s[40:43], s83 offen offset:1024 sc1
    s_waitcnt vmcnt(22)
    v_mfma_f32_32x32x16_bf16 v[16:31], a[200:203], v[168:171], v[16:31]
    v_mfma_f32_32x32x16_bf16 v[32:47], a[204:207], v[168:171], v[32:47]
    buffer_load_dwordx4 v[200:203], v11, s[40:43], s83 offen offset:2048 sc1
    s_waitcnt vmcnt(22)
    v_mfma_f32_32x32x16_bf16 v[48:63], a[200:203], v[172:175], v[48:63]
    v_mfma_f32_32x32x16_bf16 v[64:79], a[204:207], v[172:175], v[64:79]
    buffer_load_dwordx4 v[204:207], v11, s[40:43], s83 offen offset:3072 sc1
    s_waitcnt vmcnt(22)
    v_mfma_f32_32x32x16_bf16 v[16:31], a[208:211], v[176:179], v[16:31]
    v_mfma_f32_32x32x16_bf16 v[32:47], a[212:215], v[176:179], v[32:47]
    s_add_u32 s83, s83, 4096
    buffer_load_dwordx4 v[208:211], v11, s[40:43], s83 offen offset:0 sc1
    s_waitcnt vmcnt(22)
    v_mfma_f32_32x32x16_bf16 v[48:63], a[208:211], v[180:183], v[48:63]
    v_mfma_f32_32x32x16_bf16 v[64:79], a[212:215], v[180:183], v[64:79]
    buffer_load_dwordx4 v[212:215], v11, s[40:43], s83 offen offset:1024 sc1
    s_waitcnt vmcnt(22)
    v_mfma_f32_32x32x16_bf16 v[16:31], a[216:219], v[184:187], v[16:31]
    v_mfma_f32_32x32x16_bf16 v[32:47], a[220:223], v[184:187], v[32:47]
    buffer_load_dwordx4 v[216:219], v11, s[40:43], s83 offen offset:2048 sc1
    s_waitcnt vmcnt(22)
    v_mfma_f32_32x32x16_bf16 v[48:63], a[216:219], v[188:191], v[48:63]
    v_mfma_f32_32x32x16_bf16 v[64:79], a[220:223], v[188:191], v[64:79]
    s_nop 7
    ds_write_b128 v224, v[32:35] offset:0
    ds_write_b128 v224, v[36:39] offset:1024
    buffer_load_dwordx4 v[220:223], v11, s[40:43], s83 offen offset:3072 sc1
    ds_write_b128 v224, v[40:43] offset:2048
    s_add_u32 s83, s83, 4096
    buffer_load_dwordx4 v[96:99], v11, s[40:43], s83 offen offset:0 sc1
    ds_write_b128 v224, v[44:47] offset:3072
    buffer_load_dwordx4 v[100:103], v11, s[40:43], s83 offen offset:1024 sc1
    ds_write_b128 v225, v[48:51] offset:0
    ds_write_b128 v225, v[52:55] offset:1024
    buffer_load_dwordx4 v[104:107], v11, s[40:43], s83 offen offset:2048 sc1
    ds_write_b128 v225, v[56:59] offset:2048
    buffer_load_dwordx4 v[108:111], v11, s[40:43], s83 offen offset:3072 sc1
    ds_write_b128 v225, v[60:63] offset:3072
    s_add_u32 s83, s83, 4096
    buffer_load_dwordx4 v[112:115], v11, s[40:43], s83 offen offset:0 sc1
    ds_write_b128 v226, v[64:67] offset:0
    ds_write_b128 v226, v[68:71] offset:1024
    buffer_load_dwordx4 v[116:119], v11, s[40:43], s83 offen offset:1024 sc1
    ds_write_b128 v226, v[72:75] offset:2048
    buffer_load_dwordx4 v[120:123], v11, s[40:43], s83 offen offset:2048 sc1
    ds_write_b128 v226, v[76:79] offset:3072
    buffer_load_dwordx4 v[124:127], v11, s[40:43], s83 offen offset:3072 sc1
    s_waitcnt vmcnt(16)
    s_waitcnt lgkmcnt(0)
    s_barrier
    ds_read_b128 v[32:35], v227 offset:0
    ds_read_b128 v[36:39], v227 offset:1024
    ds_read_b128 v[40:43], v227 offset:2048
    ds_read_b128 v[44:47], v227 offset:3072
    ds_read_b128 v[48:51], v227 offset:4096
    ds_read_b128 v[52:55], v227 offset:5120
    ds_read_b128 v[56:59], v227 offset:6144
    ds_read_b128 v[60:63], v227 offset:7168
    ds_read_b128 v[64:67], v227 offset:8192
    ds_read_b128 v[68:71], v227 offset:9216
    ds_read_b128 v[72:75], v227 offset:10240
    ds_read_b128 v[76:79], v227 offset:11264
    ds_read_b64_tr_b16 a[0:1], v242 offset:0
    ds_read_b64_tr_b16 a[2:3], v242 offset:1024
    ds_read_b64_tr_b16 a[4:5], v2 offset:0
    ds_read_b64_tr_b16 a[6:7], v2 offset:1024
    ds_read_b64_tr_b16 a[8:9], v242 offset:2048
    ds_read_b64_tr_b16 a[10:11], v242 offset:3072
    ds_read_b64_tr_b16 a[12:13], v2 offset:2048
    ds_read_b64_tr_b16 a[14:15], v2 offset:3072
    s_waitcnt vmcnt(15) lgkmcnt(6)
    v_mfma_f32_32x32x16_bf16 v[80:95], a[0:3], v[192:195], 0
    ds_read_b64_tr_b16 a[16:17], v242 offset:3584
    ds_read_b64_tr_b16 a[18:19], v242 offset:4608
    s_waitcnt lgkmcnt(6)
    v_mfma_f32_32x32x16_bf16 v[128:143], a[4:7], v[192:195], 0
    ds_read_b64_tr_b16 a[20:21], v2 offset:3584
    ds_read_b64_tr_b16 a[22:23], v2 offset:4608
    s_waitcnt vmcnt(14) lgkmcnt(6)
    v_mfma_f32_32x32x16_bf16 v[80:95], a[8:11], v[196:199], v[80:95]
    ds_read_b64_tr_b16 a[24:25], v242 offset:5632
    ds_read_b64_tr_b16 a[26:27], v242 offset:6656
    s_waitcnt lgkmcnt(6)
    v_mfma_f32_32x32x16_bf16 v[128:143], a[12:15], v[196:199], v[128:143]
    ds_read_b64_tr_b16 a[28:29], v2 offset:5632
    ds_read_b64_tr_b16 a[30:31], v2 offset:6656
    s_waitcnt vmcnt(13) lgkmcnt(6)
    v_mfma_f32_32x32x16_bf16 v[80:95], a[16:19], v[200:203], v[80:95]
    ds_read_b64_tr_b16 a[0:1], v242 offset:7168
    ds_read_b64_tr_b16 a[2:3], v242 offset:8192
    s_waitcnt lgkmcnt(6)
    v_mfma_f32_32x32x16_bf16 v[128:143], a[20:23], v[200:203], v[128:143]
    ds_read_b64_tr_b16 a[4:5], v2 offset:7168
    ds_read_b64_tr_b16 a[6:7], v2 offset:8192
    s_waitcnt vmcnt(12) lgkmcnt(6)
    v_mfma_f32_32x32x16_bf16 v[80:95], a[24:27], v[204:207], v[80:95]
    ds_read_b64_tr_b16 a[8:9], v242 offset:9216
    ds_read_b64_tr_b16 a[10:11], v242 offset:10240
    s_waitcnt lgkmcnt(6)
    v_mfma_f32_32x32x16_bf16 v[128:143], a[28:31], v[204:207], v[128:143]
    ds_read_b64_tr_b16 a[12:13], v2 offset:9216
    ds_read_b64_tr_b16 a[14:15], v2 offset:10240
    s_waitcnt vmcnt(11) lgkmcnt(6)
    v_mfma_f32_32x32x16_bf16 v[80:95], a[0:3], v[208:211], v[80:95]
    ds_read_b64_tr_b16 a[16:17], v242 offset:10752
    ds_read_b64_tr_b16 a[18:19], v242 offset:11776
    v_add_f32 v16, v16, v32
    v_add_f32 v17, v17, v33
    s_waitcnt lgkmcnt(6)
    v_mfma_f32_32x32x16_bf16 v[128:143], a[4:7], v[208:211], v[128:143]
    ds_read_b64_tr_b16 a[20:21], v2 offset:10752
    ds_read_b64_tr_b16 a[22:23], v2 offset:11776
    v_add_f32 v18, v18, v34
    v_add_f32 v19, v19, v35
    s_waitcnt vmcnt(10) lgkmcnt(6)
    v_mfma_f32_32x32x16_bf16 v[80:95], a[8:11], v[212:215], v[80:95]
    ds_read_b64_tr_b16 a[24:25], v242 offset:12800
    ds_read_b64_tr_b16 a[26:27], v242 offset:13824
    v_add_f32 v20, v20, v36
    v_add_f32 v21, v21, v37
    s_waitcnt lgkmcnt(6)
    v_mfma_f32_32x32x16_bf16 v[128:143], a[12:15], v[212:215], v[128:143]
    ds_read_b64_tr_b16 a[28:29], v2 offset:12800
    ds_read_b64_tr_b16 a[30:31], v2 offset:13824
    v_add_f32 v22, v22, v38
    v_add_f32 v23, v23, v39
    s_waitcnt vmcnt(9) lgkmcnt(6)
    v_mfma_f32_32x32x16_bf16 v[80:95], a[16:19], v[216:219], v[80:95]
    ds_read_b64_tr_b16 a[0:1], v242 offset:14336
    ds_read_b64_tr_b16 a[2:3], v242 offset:15360
    v_add_f32 v24, v24, v40
    v_add_f32 v25, v25, v41
    s_waitcnt lgkmcnt(6)
    v_mfma_f32_32x32x16_bf16 v[128:143], a[20:23], v[216:219], v[128:143]
    ds_read_b64_tr_b16 a[4:5], v2 offset:14336
    ds_read_b64_tr_b16 a[6:7], v2 offset:15360
    v_add_f32 v26, v26, v42
    v_add_f32 v27, v27, v43
    s_waitcnt vmcnt(8) lgkmcnt(6)
    v_mfma_f32_32x32x16_bf16 v[80:95], a[24:27], v[220:223], v[80:95]
    ds_read_b64_tr_b16 a[8:9], v242 offset:16384
    ds_read_b64_tr_b16 a[10:11], v242 offset:17408
    v_add_f32 v28, v28, v44
    v_add_f32 v29, v29, v45
    s_waitcnt lgkmcnt(6)
    v_mfma_f32_32x32x16_bf16 v[128:143], a[28:31], v[220:223], v[128:143]
    ds_read_b64_tr_b16 a[12:13], v2 offset:16384
    ds_read_b64_tr_b16 a[14:15], v2 offset:17408
    v_add_f32 v30, v30, v46
    v_add_f32 v31, v31, v47
    s_waitcnt vmcnt(7) lgkmcnt(6)
    v_mfma_f32_32x32x16_bf16 v[80:95], a[0:3], v[96:99], v[80:95]
    ds_read_b64_tr_b16 a[16:17], v242 offset:17920
    ds_read_b64_tr_b16 a[18:19], v242 offset:18944
    v_add_f32 v16, v16, v48
    v_add_f32 v17, v17, v49
    s_waitcnt lgkmcnt(6)
    v_mfma_f32_32x32x16_bf16 v[128:143], a[4:7], v[96:99], v[128:143]
    ds_read_b64_tr_b16 a[20:21], v2 offset:17920
    ds_read_b64_tr_b16 a[22:23], v2 offset:18944
    v_add_f32 v18, v18, v50
    v_add_f32 v19, v19, v51
    s_waitcnt vmcnt(6) lgkmcnt(6)
    v_mfma_f32_32x32x16_bf16 v[80:95], a[8:11], v[100:103], v[80:95]
    ds_read_b64_tr_b16 a[24:25], v242 offset:19968
    ds_read_b64_tr_b16 a[26:27], v242 offset:20992
    v_add_f32 v20, v20, v52
    v_add_f32 v21, v21, v53
    s_waitcnt lgkmcnt(6)
    v_mfma_f32_32x32x16_bf16 v[128:143], a[12:15], v[100:103], v[128:143]
    ds_read_b64_tr_b16 a[28:29], v2 offset:19968
    ds_read_b64_tr_b16 a[30:31], v2 offset:20992
    v_add_f32 v22, v22, v54
    v_add_f32 v23, v23, v55
    s_waitcnt vmcnt(5) lgkmcnt(6)
    v_mfma_f32_32x32x16_bf16 v[80:95], a[16:19], v[104:107], v[80:95]
    ds_read_b64_tr_b16 a[0:1], v242 offset:21504
    ds_read_b64_tr_b16 a[2:3], v242 offset:22528
    v_add_f32 v24, v24, v56
    v_add_f32 v25, v25, v57
    s_waitcnt lgkmcnt(6)
    v_mfma_f32_32x32x16_bf16 v[128:143], a[20:23], v[104:107], v[128:143]
    ds_read_b64_tr_b16 a[4:5], v2 offset:21504
    ds_read_b64_tr_b16 a[6:7], v2 offset:22528
    v_add_f32 v26, v26, v58
    v_add_f32 v27, v27, v59
    s_waitcnt vmcnt(4) lgkmcnt(6)
    v_mfma_f32_32x32x16_bf16 v[80:95], a[24:27], v[108:111], v[80:95]
    ds_read_b64_tr_b16 a[8:9], v242 offset:23552
    ds_read_b64_tr_b16 a[10:11], v242 offset:24576
    v_add_f32 v28, v28, v60
    v_add_f32 v29, v29, v61
    s_waitcnt lgkmcnt(6)
    v_mfma_f32_32x32x16_bf16 v[128:143], a[28:31], v[108:111], v[128:143]
    ds_read_b64_tr_b16 a[12:13], v2 offset:23552
    ds_read_b64_tr_b16 a[14:15], v2 offset:24576
    v_add_f32 v30, v30, v62
    v_add_f32 v31, v31, v63
    s_waitcnt vmcnt(3) lgkmcnt(6)
    v_mfma_f32_32x32x16_bf16 v[80:95], a[0:3], v[112:115], v[80:95]
    ds_read_b64_tr_b16 a[16:17], v242 offset:25088
    ds_read_b64_tr_b16 a[18:19], v242 offset:26112
    v_add_f32 v16, v16, v64
    v_add_f32 v17, v17, v65
    s_waitcnt lgkmcnt(6)
    v_mfma_f32_32x32x16_bf16 v[128:143], a[4:7], v[112:115], v[128:143]
    ds_read_b64_tr_b16 a[20:21], v2 offset:25088
    ds_read_b64_tr_b16 a[22:23], v2 offset:26112
    v_add_f32 v18, v18, v66
    v_add_f32 v19, v19, v67
    s_waitcnt vmcnt(2) lgkmcnt(6)
    v_mfma_f32_32x32x16_bf16 v[80:95], a[8:11], v[116:119], v[80:95]
    ds_read_b64_tr_b16 a[24:25], v242 offset:27136
    ds_read_b64_tr_b16 a[26:27], v242 offset:28160
    v_add_f32 v20, v20, v68
    v_add_f32 v21, v21, v69
    s_waitcnt lgkmcnt(6)
    v_mfma_f32_32x32x16_bf16 v[128:143], a[12:15], v[116:119], v[128:143]
    ds_read_b64_tr_b16 a[28:29], v2 offset:27136
    ds_read_b64_tr_b16 a[30:31], v2 offset:28160
    v_add_f32 v22, v22, v70
    v_add_f32 v23, v23, v71
    s_waitcnt vmcnt(1) lgkmcnt(6)
    v_mfma_f32_32x32x16_bf16 v[80:95], a[16:19], v[120:123], v[80:95]
    v_add_f32 v24, v24, v72
    v_add_f32 v25, v25, v73
    s_waitcnt lgkmcnt(4)
    v_mfma_f32_32x32x16_bf16 v[128:143], a[20:23], v[120:123], v[128:143]
    v_add_f32 v26, v26, v74
    v_add_f32 v27, v27, v75
    s_waitcnt vmcnt(0) lgkmcnt(2)
    v_mfma_f32_32x32x16_bf16 v[80:95], a[24:27], v[124:127], v[80:95]
    v_add_f32 v28, v28, v76
    v_add_f32 v29, v29, v77
    s_waitcnt lgkmcnt(0)
    v_mfma_f32_32x32x16_bf16 v[128:143], a[28:31], v[124:127], v[128:143]
    v_add_f32 v30, v30, v78
    v_add_f32 v31, v31, v79
    s_nop 9
    ds_write_b128 v3, v[128:131] offset:0
    ds_write_b128 v3, v[132:135] offset:1024
    ds_write_b128 v3, v[136:139] offset:2048
    ds_write_b128 v3, v[140:143] offset:3072
    ds_read_b64 v[144:145], v228 offset:24576
    ds_read_b64 v[146:147], v229 offset:24576
    ds_read_b64 v[148:149], v230 offset:24576
    ds_read_b64 v[150:151], v231 offset:24576
    s_mov_b32 s96, 0xbfb8aa3b
    s_mov_b32 s97, 0xbfb8aa3b
    v_pk_mul_f32 v[16:17], v[16:17], v[14:15] op_sel:[0,1] op_sel_hi:[1,1]
    v_pk_mul_f32 v[18:19], v[18:19], v[14:15] op_sel:[0,1] op_sel_hi:[1,1]
    v_pk_mul_f32 v[20:21], v[20:21], v[14:15] op_sel:[0,1] op_sel_hi:[1,1]
    v_pk_mul_f32 v[22:23], v[22:23], v[14:15] op_sel:[0,1] op_sel_hi:[1,1]
    v_pk_mul_f32 v[24:25], v[24:25], v[14:15] op_sel:[0,1] op_sel_hi:[1,1]
    v_pk_mul_f32 v[26:27], v[26:27], v[14:15] op_sel:[0,1] op_sel_hi:[1,1]
    v_pk_mul_f32 v[28:29], v[28:29], v[14:15] op_sel:[0,1] op_sel_hi:[1,1]
    v_pk_mul_f32 v[30:31], v[30:31], v[14:15] op_sel:[0,1] op_sel_hi:[1,1]
    s_waitcnt lgkmcnt(0)
    s_barrier
    ds_read_b128 v[128:131], v4 offset:0
    ds_read_b128 v[132:135], v4 offset:1024
    ds_read_b128 v[136:139], v4 offset:2048
    ds_read_b128 v[140:143], v4 offset:3072
    v_pk_mul_f32 v[160:161], v[16:17], s[96:97]
    v_pk_mul_f32 v[162:163], v[18:19], s[96:97]
    v_pk_mul_f32 v[164:165], v[20:21], s[96:97]
    v_pk_mul_f32 v[166:167], v[22:23], s[96:97]
    v_pk_mul_f32 v[168:169], v[24:25], s[96:97]
    v_pk_mul_f32 v[170:171], v[26:27], s[96:97]
    v_pk_mul_f32 v[172:173], v[28:29], s[96:97]
    v_pk_mul_f32 v[174:175], v[30:31], s[96:97]
    v_exp_f32 v160, v160
    v_exp_f32 v161, v161
    v_exp_f32 v162, v162
    v_exp_f32 v163, v163
    v_exp_f32 v164, v164
    v_exp_f32 v165, v165
    v_exp_f32 v166, v166
    v_exp_f32 v167, v167
    v_exp_f32 v168, v168
    v_exp_f32 v169, v169
    v_exp_f32 v170, v170
    v_exp_f32 v171, v171
    v_exp_f32 v172, v172
    v_exp_f32 v173, v173
    v_exp_f32 v174, v174
    v_exp_f32 v175, v175
    s_waitcnt lgkmcnt(3)
    v_pk_add_f32 v[80:81], v[80:81], v[128:129]
    v_pk_add_f32 v[82:83], v[82:83], v[130:131]
    s_waitcnt lgkmcnt(2)
    v_pk_add_f32 v[84:85], v[84:85], v[132:133]
    v_pk_add_f32 v[86:87], v[86:87], v[134:135]
    s_waitcnt lgkmcnt(1)
    v_pk_add_f32 v[88:89], v[88:89], v[136:137]
    v_pk_add_f32 v[90:91], v[90:91], v[138:139]
    s_waitcnt lgkmcnt(0)
    v_pk_add_f32 v[92:93], v[92:93], v[140:141]
    v_pk_add_f32 v[94:95], v[94:95], v[142:143]
    v_pk_add_f32 v[160:161], v[160:161], 1.0 op_sel_hi:[1,0]
    v_pk_add_f32 v[162:163], v[162:163], 1.0 op_sel_hi:[1,0]
    v_pk_add_f32 v[164:165], v[164:165], 1.0 op_sel_hi:[1,0]
    v_pk_add_f32 v[166:167], v[166:167], 1.0 op_sel_hi:[1,0]
    v_pk_add_f32 v[168:169], v[168:169], 1.0 op_sel_hi:[1,0]
    v_pk_add_f32 v[170:171], v[170:171], 1.0 op_sel_hi:[1,0]
    v_pk_add_f32 v[172:173], v[172:173], 1.0 op_sel_hi:[1,0]
    v_pk_add_f32 v[174:175], v[174:175], 1.0 op_sel_hi:[1,0]
    v_pk_mul_f32 v[16:17], v[16:17], v[80:81]
    v_pk_mul_f32 v[18:19], v[18:19], v[82:83]
    v_pk_mul_f32 v[20:21], v[20:21], v[84:85]
    v_pk_mul_f32 v[22:23], v[22:23], v[86:87]
    v_pk_mul_f32 v[24:25], v[24:25], v[88:89]
    v_pk_mul_f32 v[26:27], v[26:27], v[90:91]
    v_pk_mul_f32 v[28:29], v[28:29], v[92:93]
    v_pk_mul_f32 v[30:31], v[30:31], v[94:95]
    v_rcp_f32 v160, v160
    v_rcp_f32 v161, v161
    v_rcp_f32 v162, v162
    v_rcp_f32 v163, v163
    v_rcp_f32 v164, v164
    v_rcp_f32 v165, v165
    v_rcp_f32 v166, v166
    v_rcp_f32 v167, v167
    v_rcp_f32 v168, v168
    v_rcp_f32 v169, v169
    v_rcp_f32 v170, v170
    v_rcp_f32 v171, v171
    v_rcp_f32 v172, v172
    v_rcp_f32 v173, v173
    v_rcp_f32 v174, v174
    v_rcp_f32 v175, v175
    v_lshlrev_b32 v176, 16, v144
    v_and_b32 v177, 0xffff0000, v144
    v_lshlrev_b32 v178, 16, v145
    v_and_b32 v179, 0xffff0000, v145
    v_lshlrev_b32 v180, 16, v146
    v_and_b32 v181, 0xffff0000, v146
    v_lshlrev_b32 v182, 16, v147
    v_and_b32 v183, 0xffff0000, v147
    v_lshlrev_b32 v184, 16, v148
    v_and_b32 v185, 0xffff0000, v148
    v_lshlrev_b32 v186, 16, v149
    v_and_b32 v187, 0xffff0000, v149
    v_lshlrev_b32 v188, 16, v150
    v_and_b32 v189, 0xffff0000, v150
    v_lshlrev_b32 v190, 16, v151
    v_and_b32 v191, 0xffff0000, v151
    v_pk_fma_f32 v[16:17], v[16:17], v[160:161], v[176:177]
    v_pk_fma_f32 v[18:19], v[18:19], v[162:163], v[178:179]
    v_pk_fma_f32 v[20:21], v[20:21], v[164:165], v[180:181]
    v_pk_fma_f32 v[22:23], v[22:23], v[166:167], v[182:183]
    v_pk_fma_f32 v[24:25], v[24:25], v[168:169], v[184:185]
    v_pk_fma_f32 v[26:27], v[26:27], v[170:171], v[186:187]
    v_pk_fma_f32 v[28:29], v[28:29], v[172:173], v[188:189]
    v_pk_fma_f32 v[30:31], v[30:31], v[174:175], v[190:191]
    v_cvt_pk_bf16_f32 v16, v16, v17
    v_cvt_pk_bf16_f32 v17, v18, v19
    v_cvt_pk_bf16_f32 v18, v20, v21
    v_cvt_pk_bf16_f32 v19, v22, v23
    v_cvt_pk_bf16_f32 v20, v24, v25
    v_cvt_pk_bf16_f32 v21, v26, v27
    v_cvt_pk_bf16_f32 v22, v28, v29
    v_cvt_pk_bf16_f32 v23, v30, v31
    ds_write_b64 v228, v[16:17]
    ds_write_b64 v229, v[18:19]
    ds_write_b64 v230, v[20:21]
    ds_write_b64 v231, v[22:23]
    s_waitcnt lgkmcnt(0)
    s_barrier
    ds_read_b128 v[160:163], v248 offset:0
    ds_read_b128 v[164:167], v248 offset:1024
    s_waitcnt lgkmcnt(1)
    buffer_store_dwordx4 v[160:163], v243, s[32:35], s93 offen
    s_add_u32 s93, s93, 7168
    s_waitcnt lgkmcnt(0)
    buffer_store_dwordx4 v[164:167], v243, s[32:35], s93 offen
L_exit:
    s_endpgm

.section .rodata,"a"
.p2align 6
.amdhsa_kernel recurrent_scan__linear_kernel_hedgehog__glu_gated_swiglu__prompt_kernel
  .amdhsa_next_free_vgpr 512
  .amdhsa_next_free_sgpr 102
  .amdhsa_accum_offset 256
  .amdhsa_group_segment_fixed_size 0
  .amdhsa_kernarg_size 88
  .amdhsa_user_sgpr_count 2
  .amdhsa_user_sgpr_kernarg_segment_ptr 1
  .amdhsa_system_sgpr_workgroup_id_x 1
.end_amdhsa_kernel
```
